```python
import torch

def _softmax(x, axis=-1):
    return torch.softmax(x, dim=axis)
def _gelu(x):
    return torch.nn.functional.gelu(x, approximate="tanh")
def _silu(x):
    return torch.nn.functional.silu(x)
def _sigmoid(x):
    return torch.sigmoid(x)
def _layernorm(x, axis=-1, eps=1e-5):
    m = x.mean(dim=axis, keepdim=True)
    v = x.var(dim=axis, keepdim=True, unbiased=False)
    return (x - m) / torch.sqrt(v + eps)
def _scatter_add(tgt, idx, src, axis=0):
    return tgt.clone().index_add_(axis, idx, src)
def _segment_sum(src, seg, n):
    out = torch.zeros((n,) + src.shape[1:], dtype=src.dtype)
    return out.index_add_(0, seg, src)
def _pad(x, pw):
    flat = tuple(v for pair in reversed(pw) for v in pair)
    return torch.nn.functional.pad(x, flat)

kernel_name = 'concat_heads__mha_block_cached__mha_block_cached__near_ridge'

def setup_inputs():

    _w = (lambda a: (lambda t: t.to(torch.bfloat16) if t.is_floating_point() else t)(torch.as_tensor(a)))
    def _A_setup():
        B, Sq, D = 8, 160, 448
        H, Sk, Dh = 16, 512, 256
        return {
            "x": _w((lambda *s: torch.randn(*s, dtype=torch.bfloat16) * 0.8)(B, Sq, D)),
            "k_cache": _w((lambda *s: torch.randn(*s, dtype=torch.bfloat16) * 0.8)(B, H, Sk, Dh)),
            "v_cache": _w((lambda *s: torch.randn(*s, dtype=torch.bfloat16) * 0.05)(B, H, Sk, Dh)),
            "wq": _w((lambda *s: torch.randn(*s, dtype=torch.bfloat16) * 0.8)(D, H * Dh) * (D ** -0.5)),
            "wo": _w((lambda *s: torch.randn(*s, dtype=torch.bfloat16) * 0.05)(H * Dh, D) * ((H * Dh) ** -0.5)),
        }
    _A_in = _A_setup()

    def _B_setup():
        B, Sq, D = 8, 160, 448
        H, Sk, Dh = 16, 512, 256
        return {
            "x": _w((lambda *s: torch.randn(*s, dtype=torch.bfloat16) * 0.8)(B, Sq, D)),
            "k_cache": _w((lambda *s: torch.randn(*s, dtype=torch.bfloat16) * 0.8)(B, H, Sk, Dh)),
            "v_cache": _w((lambda *s: torch.randn(*s, dtype=torch.bfloat16) * 0.05)(B, H, Sk, Dh)),
            "wq": _w((lambda *s: torch.randn(*s, dtype=torch.bfloat16) * 0.8)(D, H * Dh) * (D ** -0.5)),
            "wo": _w((lambda *s: torch.randn(*s, dtype=torch.bfloat16) * 0.05)(H * Dh, D) * ((H * Dh) ** -0.5)),
        }
    _B_in = _B_setup()

    return {
        "A_x": _A_in["x"],
        "A_k_cache": _A_in["k_cache"],
        "A_v_cache": _A_in["v_cache"],
        "A_wq": _A_in["wq"],
        "A_wo": _A_in["wo"],
        "B_x": _B_in["x"],
        "B_k_cache": _B_in["k_cache"],
        "B_v_cache": _B_in["v_cache"],
        "B_wq": _B_in["wq"],
        "B_wo": _B_in["wo"],
    }

def reference(A_x, A_k_cache, A_v_cache, A_wq, A_wo, B_x, B_k_cache, B_v_cache, B_wq, B_wo):
    def _A_ref(x, k_cache, v_cache, wq, wo):
        B, Sq, D = x.shape
        H, Dh = 16, 256
        q = (lambda x, *d: x.permute(*d))((x @ wq).reshape(B, Sq, H, Dh), 0, 2, 1, 3)
        scores = torch.einsum("bhqd,bhkd->bhqk", q, k_cache) * (Dh ** -0.5)
        p = _softmax(scores, axis=-1)
        o = torch.einsum("bhqk,bhkd->bhqd", p, v_cache)
        return (lambda x, *d: x.permute(*d))(o, 0, 2, 1, 3).reshape(B, Sq, H * Dh) @ wo

    def _B_ref(x, k_cache, v_cache, wq, wo):
        B, Sq, D = x.shape
        H, Dh = 16, 256
        q = (lambda x, *d: x.permute(*d))((x @ wq).reshape(B, Sq, H, Dh), 0, 2, 1, 3)
        scores = torch.einsum("bhqd,bhkd->bhqk", q, k_cache) * (Dh ** -0.5)
        p = _softmax(scores, axis=-1)
        o = torch.einsum("bhqk,bhkd->bhqd", p, v_cache)
        return (lambda x, *d: x.permute(*d))(o, 0, 2, 1, 3).reshape(B, Sq, H * Dh) @ wo

    a = _A_ref(A_x, A_k_cache, A_v_cache, A_wq, A_wo)
    b = _B_ref(B_x, B_k_cache, B_v_cache, B_wq, B_wo)
    return torch.concatenate([a, b], axis=-1)
```

```asm
; @launch grid=(256,1,1) block=(256,1,1) lds=163840
.amdgcn_target "amdgcn-amd-amdhsa--gfx950"
.text
.globl concat_heads__mha_block_cached__mha_block_cached__near_ridge_kernel
.p2align 8
.type concat_heads__mha_block_cached__mha_block_cached__near_ridge_kernel,@function
concat_heads__mha_block_cached__mha_block_cached__near_ridge_kernel:
  s_cmp_ge_u32 s2, 0x100
  s_cbranch_scc1 concat_heads__mha_block_cached__mha_block_cached__near_ridge_kernel_done
  s_load_dwordx16 s[36:51], s[0:1], 0
  s_load_dwordx8 s[52:59], s[0:1], 64
  s_load_dwordx2 s[60:61], s[0:1], 96
  v_lshrrev_b32 v1, 6, v0
  v_and_b32 v255, 63, v0
  v_readfirstlane_b32 s3, v1
  s_and_b32 s29, s2, 7
  s_lshr_b32 s30, s2, 3
  s_lshr_b32 s24, s29, 2
  s_and_b32 s25, s29, 3
  s_lshr_b32 s26, s30, 2
  s_and_b32 s27, s30, 3
  s_lshl_b32 s28, s25, 2
  s_add_u32 s28, s28, s27
  s_lshr_b32 s29, s2, 3
  s_lshl_b32 s29, s29, 2
  s_add_u32 s29, s29, s3
  s_cmp_ge_u32 s29, 9
  s_cbranch_scc1 concat_heads__mha_block_cached__mha_block_cached__near_ridge_kernel_ctE
  s_getpc_b64 s[88:89]
concat_heads__mha_block_cached__mha_block_cached__near_ridge_kernel_ctE_pc:
  s_sub_u32 s88, s88, concat_heads__mha_block_cached__mha_block_cached__near_ridge_kernel_ctE_pc-concat_heads__mha_block_cached__mha_block_cached__near_ridge_kernel
  s_subb_u32 s89, s89, 0
  s_lshl_b32 s29, s29, 13
  v_lshlrev_b32 v210, 7, v255
  v_add_u32 v210, s29, v210
  s_mov_b32 s90, concat_heads__mha_block_cached__mha_block_cached__near_ridge_kernel_done-concat_heads__mha_block_cached__mha_block_cached__near_ridge_kernel
  v_min_u32 v210, s90, v210
  global_load_dword v211, v210, s[88:89]
concat_heads__mha_block_cached__mha_block_cached__near_ridge_kernel_ctE:
  v_and_b32 v198, 31, v255
  v_lshrrev_b32 v199, 5, v255
  v_lshrrev_b32 v200, 4, v255
  v_and_b32 v201, 15, v255
  v_lshrrev_b32 v202, 2, v201
  v_and_b32 v203, 3, v255
  v_and_b32 v204, 1, v200
  s_cmp_ge_u32 s3, 2
  s_cbranch_scc1 concat_heads__mha_block_cached__mha_block_cached__near_ridge_kernel_roleb
  v_add_u32 v186, 0, v199
  v_lshlrev_b32 v186, 2, v186
  v_xor_b32 v186, v186, v198
  v_lshlrev_b32 v186, 4, v186
  v_lshl_add_u32 v168, v199, 13, v186
  v_add_u32 v186, 2, v199
  v_lshlrev_b32 v186, 2, v186
  v_xor_b32 v186, v186, v198
  v_lshlrev_b32 v186, 4, v186
  v_lshl_add_u32 v169, v199, 13, v186
  s_lshl_b32 s64, s3, 13
  s_add_u32 s64, s64, 0
  s_lshl_b32 s65, s3, 17
  s_lshl_b32 s67, s27, 1
  s_add_u32 s67, s67, s26
  s_cmp_ge_u32 s67, 7
  s_cselect_b32 s31, 7, 0
  s_sub_u32 s67, s67, s31
  s_lshl_b32 s67, s67, 1
  s_waitcnt lgkmcnt(0)
  s_cmp_eq_u32 s24, 0
  s_cselect_b64 s[12:13], s[36:37], s[46:47]
  s_cselect_b64 s[16:17], s[42:43], s[52:53]
  s_mul_i32 s30, s26, 0x23000
  s_add_u32 s12, s12, s30
  s_addc_u32 s13, s13, 0
  s_lshl_b32 s31, s28, 9
  s_add_u32 s16, s16, s31
  s_addc_u32 s17, s17, 0
  s_and_b32 s13, s13, 0xffff
  s_mov_b32 s15, 0x20000
  s_and_b32 s17, s17, 0xffff
  s_mov_b32 s19, 0x20000
  s_mov_b32 s14, 0x23000
  s_sub_u32 s18, 0x380000, s31
  s_add_u32 s66, s67, 0
  s_cmp_ge_u32 s66, 14
  s_cselect_b32 s31, 14, 0
  s_sub_u32 s66, s66, s31
  s_lshl_b32 s66, s66, 18
  s_add_u32 s66, s66, s65
  s_add_u32 m0, s64, 0
  s_add_u32 s75, s66, 0
  buffer_load_dwordx4 v168, s[16:19], s75 offen lds
  s_add_u32 s74, s66, 0x3c00
  buffer_load_dwordx4 v169, s[16:19], s74 offen offset:1024 lds
  s_add_u32 s75, s66, 0x7800
  buffer_load_dwordx4 v168, s[16:19], s75 offen offset:2048 lds
  s_add_u32 s74, s66, 0xb400
  buffer_load_dwordx4 v169, s[16:19], s74 offen offset:3072 lds
  s_add_u32 m0, s64, 0x1000
  s_add_u32 s75, s66, 0x10000
  buffer_load_dwordx4 v168, s[16:19], s75 offen lds
  s_add_u32 s74, s66, 0x13c00
  buffer_load_dwordx4 v169, s[16:19], s74 offen offset:1024 lds
  s_add_u32 s75, s66, 0x17800
  buffer_load_dwordx4 v168, s[16:19], s75 offen offset:2048 lds
  s_add_u32 s74, s66, 0x1b400
  buffer_load_dwordx4 v169, s[16:19], s74 offen offset:3072 lds
  s_cmp_eq_u32 s24, 0
  s_cselect_b64 s[4:5], s[38:39], s[48:49]
  s_cselect_b64 s[8:9], s[40:41], s[50:51]
  s_lshl_b32 s29, s26, 4
  s_add_u32 s29, s29, s28
  s_lshl_b32 s30, s29, 18
  s_add_u32 s4, s4, s30
  s_addc_u32 s5, s5, 0
  s_add_u32 s8, s8, s30
  s_addc_u32 s9, s9, 0
  s_and_b32 s5, s5, 0xffff
  s_mov_b32 s7, 0x20000
  s_and_b32 s9, s9, 0xffff
  s_mov_b32 s11, 0x20000
  s_mov_b32 s6, 0x40000
  s_mov_b32 s10, 0x40000
  s_mov_b32 s20, s60
  s_and_b32 s21, s61, 0xffff
  s_mov_b32 s22, 0x1400000
  s_mov_b32 s23, 0x20000
  s_lshl_b32 s30, s24, 7
  s_add_u32 s30, s30, s29
  s_mul_i32 s34, s30, 0x14000
  s_cmp_eq_u32 s24, 0
  s_cselect_b64 s[52:53], s[44:45], s[54:55]
  s_mov_b64 s[54:55], s[56:57]
  s_mov_b32 s96, s58
  s_and_b32 s97, s59, 0xffff
  s_mov_b32 s98, 0x100
  s_mov_b32 s99, 0x20000
  s_add_u32 s56, s60, 0x3c00000
  s_addc_u32 s57, s61, 0
  s_and_b32 s57, s57, 0xffff
  s_mov_b32 s58, 0x8000
  s_mov_b32 s59, 0x20000
  s_lshl_b32 s33, s3, 12
  s_lshl_b32 s72, s3, 14
  s_mov_b32 s62, 0x44800000
  s_mov_b32 s73, 0x3db8aa3b
  s_mov_b32 s35, 0
  s_mov_b32 s63, 0
  s_lshl_b32 s29, s3, 11
  s_add_u32 s78, s34, s29
  s_lshr_b32 s29, s3, 1
  s_mul_i32 s29, s29, 0x2800
  s_add_u32 s29, s29, 0x2000
  s_add_u32 s79, s34, s29
  v_mov_b32 v250, 0xff800000
  v_mov_b32 v251, 0xff800000
  v_lshlrev_b32 v186, 3, v199
  v_add_u32 v186, v186, v202
  v_lshlrev_b32 v186, 9, v186
  v_and_b32 v187, 1, v203
  v_lshl_add_u32 v187, v204, 1, v187
  v_lshrrev_b32 v188, 1, v203
  v_lshlrev_b32 v188, 3, v188
  v_add_u32 v186, v186, v188
  v_add_u32 v186, 0, v186
  v_xor_b32 v189, s3, v202
  v_xor_b32 v190, 0, v189
  v_lshl_add_u32 v190, v190, 2, v187
  v_lshl_add_u32 v160, v190, 4, v186
  v_add_u32 v180, 0x10000, v160
  v_xor_b32 v190, 1, v189
  v_lshl_add_u32 v190, v190, 2, v187
  v_lshl_add_u32 v161, v190, 4, v186
  v_add_u32 v181, 0x10000, v161
  v_xor_b32 v190, 2, v189
  v_lshl_add_u32 v190, v190, 2, v187
  v_lshl_add_u32 v162, v190, 4, v186
  v_add_u32 v182, 0x10000, v162
  v_xor_b32 v190, 3, v189
  v_lshl_add_u32 v190, v190, 2, v187
  v_lshl_add_u32 v163, v190, 4, v186
  v_add_u32 v183, 0x10000, v163
  v_lshrrev_b32 v186, 2, v198
  v_and_b32 v186, 3, v186
  v_lshlrev_b32 v187, 6, v198
  s_lshl_b32 s29, s3, 11
  s_add_u32 s29, s29, 0x18000
  v_add_u32 v188, 0, v199
  v_xor_b32 v188, v188, v186
  v_lshl_add_u32 v188, v188, 4, v187
  v_add_u32 v164, s29, v188
  v_add_u32 v166, 0x1a000, v188
  v_add_u32 v188, 2, v199
  v_xor_b32 v188, v188, v186
  v_lshl_add_u32 v188, v188, 4, v187
  v_add_u32 v165, s29, v188
  v_add_u32 v167, 0x1a000, v188
  s_and_b32 s29, s3, 1
  s_lshl_b32 s29, s29, 3
  v_add_u32 v186, 0, v199
  v_add_u32 v186, s29, v186
  v_xor_b32 v186, v186, v198
  v_lshlrev_b32 v186, 4, v186
  v_lshl_add_u32 v240, v199, 9, v186
  v_add_u32 v186, 2, v199
  v_add_u32 v186, s29, v186
  v_xor_b32 v186, v186, v198
  v_lshlrev_b32 v186, 4, v186
  v_lshl_add_u32 v241, v199, 9, v186
  v_add_u32 v186, 4, v199
  v_add_u32 v186, s29, v186
  v_xor_b32 v186, v186, v198
  v_lshlrev_b32 v186, 4, v186
  v_lshl_add_u32 v242, v199, 9, v186
  v_add_u32 v186, 6, v199
  v_add_u32 v186, s29, v186
  v_xor_b32 v186, v186, v198
  v_lshlrev_b32 v186, 4, v186
  v_lshl_add_u32 v243, v199, 9, v186
  v_lshrrev_b32 v186, 3, v255
  v_lshlrev_b32 v186, 9, v186
  v_and_b32 v187, 7, v255
  v_lshlrev_b32 v188, 2, v204
  v_xor_b32 v187, v187, v188
  v_lshlrev_b32 v188, 1, v199
  v_xor_b32 v187, v187, v188
  v_lshl_add_u32 v252, v187, 4, v186
  v_and_b32 v186, 15, v198
  v_lshlrev_b32 v187, 9, v198
  s_xor_b32 s29, s3, 0
  s_lshl_b32 s29, s29, 2
  v_add_u32 v188, 0, v199
  v_add_u32 v188, s29, v188
  v_xor_b32 v188, v188, v186
  v_lshl_add_u32 v232, v188, 4, v187
  v_add_u32 v188, 2, v199
  v_add_u32 v188, s29, v188
  v_xor_b32 v188, v188, v186
  v_lshl_add_u32 v233, v188, 4, v187
  s_xor_b32 s29, s3, 1
  s_lshl_b32 s29, s29, 2
  v_add_u32 v188, 0, v199
  v_add_u32 v188, s29, v188
  v_xor_b32 v188, v188, v186
  v_lshl_add_u32 v234, v188, 4, v187
  v_add_u32 v188, 2, v199
  v_add_u32 v188, s29, v188
  v_xor_b32 v188, v188, v186
  v_lshl_add_u32 v235, v188, 4, v187
  s_xor_b32 s29, s3, 2
  s_lshl_b32 s29, s29, 2
  v_add_u32 v188, 0, v199
  v_add_u32 v188, s29, v188
  v_xor_b32 v188, v188, v186
  v_lshl_add_u32 v236, v188, 4, v187
  v_add_u32 v188, 2, v199
  v_add_u32 v188, s29, v188
  v_xor_b32 v188, v188, v186
  v_lshl_add_u32 v237, v188, 4, v187
  s_xor_b32 s29, s3, 3
  s_lshl_b32 s29, s29, 2
  v_add_u32 v188, 0, v199
  v_add_u32 v188, s29, v188
  v_xor_b32 v188, v188, v186
  v_lshl_add_u32 v238, v188, 4, v187
  v_add_u32 v188, 2, v199
  v_add_u32 v188, s29, v188
  v_xor_b32 v188, v188, v186
  v_lshl_add_u32 v239, v188, 4, v187
  v_lshlrev_b32 v186, 4, v255
  s_lshl_b32 s29, s3, 11
  s_add_u32 s29, s29, 0x20000
  v_add_u32 v194, s29, v186
  s_xor_b32 s29, s3, 0
  s_lshl_b32 s29, s29, 11
  s_add_u32 s29, s29, 0x20000
  v_add_u32 v195, s29, v186
  s_xor_b32 s29, s3, 1
  s_lshl_b32 s29, s29, 11
  s_add_u32 s29, s29, 0x20000
  v_add_u32 v196, s29, v186
  s_xor_b32 s29, s3, 2
  s_lshl_b32 s29, s29, 11
  s_add_u32 s29, s29, 0x20000
  v_add_u32 v197, s29, v186
  s_xor_b32 s29, s3, 3
  s_lshl_b32 s29, s29, 11
  s_add_u32 s29, s29, 0x20000
  v_add_u32 v205, s29, v186
  s_add_u32 s66, s67, 1
  s_cmp_ge_u32 s66, 14
  s_cselect_b32 s31, 14, 0
  s_sub_u32 s66, s66, s31
  s_lshl_b32 s66, s66, 18
  s_add_u32 s66, s66, s65
  s_add_u32 m0, s64, 0x4000
  s_add_u32 s75, s66, 0
  buffer_load_dwordx4 v168, s[16:19], s75 offen lds
  s_add_u32 s74, s66, 0x3c00
  buffer_load_dwordx4 v169, s[16:19], s74 offen offset:1024 lds
  s_add_u32 s75, s66, 0x7800
  buffer_load_dwordx4 v168, s[16:19], s75 offen offset:2048 lds
  s_add_u32 s74, s66, 0xb400
  buffer_load_dwordx4 v169, s[16:19], s74 offen offset:3072 lds
  s_add_u32 m0, s64, 0x5000
  s_add_u32 s75, s66, 0x10000
  buffer_load_dwordx4 v168, s[16:19], s75 offen lds
  s_add_u32 s74, s66, 0x13c00
  buffer_load_dwordx4 v169, s[16:19], s74 offen offset:1024 lds
  s_add_u32 s75, s66, 0x17800
  buffer_load_dwordx4 v168, s[16:19], s75 offen offset:2048 lds
  s_add_u32 s74, s66, 0x1b400
  buffer_load_dwordx4 v169, s[16:19], s74 offen offset:3072 lds
  s_add_u32 s66, s67, 2
  s_cmp_ge_u32 s66, 14
  s_cselect_b32 s31, 14, 0
  s_sub_u32 s66, s66, s31
  s_lshl_b32 s66, s66, 18
  s_add_u32 s66, s66, s65
  s_add_u32 m0, s64, 0x8000
  s_add_u32 s75, s66, 0
  buffer_load_dwordx4 v168, s[16:19], s75 offen lds
  s_add_u32 s74, s66, 0x3c00
  buffer_load_dwordx4 v169, s[16:19], s74 offen offset:1024 lds
  s_add_u32 s75, s66, 0x7800
  buffer_load_dwordx4 v168, s[16:19], s75 offen offset:2048 lds
  s_add_u32 s74, s66, 0xb400
  buffer_load_dwordx4 v169, s[16:19], s74 offen offset:3072 lds
  s_add_u32 m0, s64, 0x9000
  s_add_u32 s75, s66, 0x10000
  buffer_load_dwordx4 v168, s[16:19], s75 offen lds
  s_add_u32 s74, s66, 0x13c00
  buffer_load_dwordx4 v169, s[16:19], s74 offen offset:1024 lds
  s_add_u32 s75, s66, 0x17800
  buffer_load_dwordx4 v168, s[16:19], s75 offen offset:2048 lds
  s_add_u32 s74, s66, 0x1b400
  buffer_load_dwordx4 v169, s[16:19], s74 offen offset:3072 lds
  s_mov_b32 s29, 0x8000
  s_cmp_eq_u32 s3, 1
  s_cselect_b32 s29, 0xc000, s29
  s_cmp_eq_u32 s3, 2
  s_cselect_b32 s29, 0x10000, s29
  s_cmp_eq_u32 s3, 3
  s_cselect_b32 s29, 0x14000, s29
  s_mov_b32 s36, s29
  s_mov_b32 s30, 0xc000
  s_cmp_eq_u32 s3, 1
  s_cselect_b32 s30, 0x8000, s30
  s_cmp_eq_u32 s3, 2
  s_cselect_b32 s30, 0x14000, s30
  s_cmp_eq_u32 s3, 3
  s_cselect_b32 s30, 0x10000, s30
  s_sub_u32 s37, s30, s29
  s_mov_b32 s29, 0x10000
  s_cmp_eq_u32 s3, 1
  s_cselect_b32 s29, 0x14000, s29
  s_cmp_eq_u32 s3, 2
  s_cselect_b32 s29, 0x8000, s29
  s_cmp_eq_u32 s3, 3
  s_cselect_b32 s29, 0xc000, s29
  s_sub_u32 s38, s29, s30
  s_mov_b32 s30, 0x14000
  s_cmp_eq_u32 s3, 1
  s_cselect_b32 s30, 0x10000, s30
  s_cmp_eq_u32 s3, 2
  s_cselect_b32 s30, 0xc000, s30
  s_cmp_eq_u32 s3, 3
  s_cselect_b32 s30, 0x8000, s30
  s_sub_u32 s39, s30, s29
  s_mov_b32 s29, 0x24000
  s_cmp_eq_u32 s3, 1
  s_cselect_b32 s29, 0, s29
  s_cmp_eq_u32 s3, 2
  s_cselect_b32 s29, 0x4000, s29
  s_cmp_eq_u32 s3, 3
  s_cselect_b32 s29, 0x18000, s29
  s_sub_u32 s40, s29, s30
  s_mov_b32 s30, 0
  s_cmp_eq_u32 s3, 1
  s_cselect_b32 s30, 0x24000, s30
  s_cmp_eq_u32 s3, 2
  s_cselect_b32 s30, 0x18000, s30
  s_cmp_eq_u32 s3, 3
  s_cselect_b32 s30, 0x4000, s30
  s_sub_u32 s41, s30, s29
  s_mov_b32 s29, 0x4000
  s_cmp_eq_u32 s3, 1
  s_cselect_b32 s29, 0x18000, s29
  s_cmp_eq_u32 s3, 2
  s_cselect_b32 s29, 0x24000, s29
  s_cmp_eq_u32 s3, 3
  s_cselect_b32 s29, 0, s29
  s_sub_u32 s42, s29, s30
  s_mov_b32 s30, 0x18000
  s_cmp_eq_u32 s3, 1
  s_cselect_b32 s30, 0x4000, s30
  s_cmp_eq_u32 s3, 2
  s_cselect_b32 s30, 0, s30
  s_cmp_eq_u32 s3, 3
  s_cselect_b32 s30, 0x24000, s30
  s_sub_u32 s43, s30, s29
  s_mov_b32 s29, 0x1c000
  s_cmp_eq_u32 s3, 1
  s_cselect_b32 s29, 0x8000, s29
  s_cmp_eq_u32 s3, 2
  s_cselect_b32 s29, 0xc000, s29
  s_cmp_eq_u32 s3, 3
  s_cselect_b32 s29, 0x10000, s29
  s_sub_u32 s44, s29, s30
  s_mov_b32 s30, 0x8000
  s_cmp_eq_u32 s3, 1
  s_cselect_b32 s30, 0x1c000, s30
  s_cmp_eq_u32 s3, 2
  s_cselect_b32 s30, 0x10000, s30
  s_cmp_eq_u32 s3, 3
  s_cselect_b32 s30, 0xc000, s30
  s_sub_u32 s45, s30, s29
  s_mov_b32 s29, 0xc000
  s_cmp_eq_u32 s3, 1
  s_cselect_b32 s29, 0x10000, s29
  s_cmp_eq_u32 s3, 2
  s_cselect_b32 s29, 0x1c000, s29
  s_cmp_eq_u32 s3, 3
  s_cselect_b32 s29, 0x8000, s29
  s_sub_u32 s46, s29, s30
  s_mov_b32 s30, 0x10000
  s_cmp_eq_u32 s3, 1
  s_cselect_b32 s30, 0xc000, s30
  s_cmp_eq_u32 s3, 2
  s_cselect_b32 s30, 0x8000, s30
  s_cmp_eq_u32 s3, 3
  s_cselect_b32 s30, 0x1c000, s30
  s_sub_u32 s47, s30, s29
  s_mov_b32 s29, 0x14000
  s_cmp_eq_u32 s3, 1
  s_cselect_b32 s29, 0x20000, s29
  s_cmp_eq_u32 s3, 2
  s_cselect_b32 s29, 0x24000, s29
  s_cmp_eq_u32 s3, 3
  s_cselect_b32 s29, 0, s29
  s_sub_u32 s48, s29, s30
  s_mov_b32 s30, 0x20000
  s_cmp_eq_u32 s3, 1
  s_cselect_b32 s30, 0x14000, s30
  s_cmp_eq_u32 s3, 2
  s_cselect_b32 s30, 0, s30
  s_cmp_eq_u32 s3, 3
  s_cselect_b32 s30, 0x24000, s30
  s_sub_u32 s49, s30, s29
  s_mov_b32 s29, 0x24000
  s_cmp_eq_u32 s3, 1
  s_cselect_b32 s29, 0, s29
  s_cmp_eq_u32 s3, 2
  s_cselect_b32 s29, 0x14000, s29
  s_cmp_eq_u32 s3, 3
  s_cselect_b32 s29, 0x20000, s29
  s_sub_u32 s50, s29, s30
  s_mov_b32 s30, 0
  s_cmp_eq_u32 s3, 1
  s_cselect_b32 s30, 0x24000, s30
  s_cmp_eq_u32 s3, 2
  s_cselect_b32 s30, 0x20000, s30
  s_cmp_eq_u32 s3, 3
  s_cselect_b32 s30, 0x14000, s30
  s_sub_u32 s51, s30, s29
  s_waitcnt vmcnt(16)
  s_barrier
  ds_read_b128 a[64:67], v164
  ds_read_b64_tr_b16 a[192:193], v160
  ds_read_b64_tr_b16 a[194:195], v160 offset:2048
  ds_read_b128 a[68:71], v166
  ds_read_b64_tr_b16 a[196:197], v161
  ds_read_b64_tr_b16 a[198:199], v161 offset:2048
  ds_read_b64_tr_b16 a[200:201], v162
  ds_read_b64_tr_b16 a[202:203], v162 offset:2048
  ds_read_b64_tr_b16 a[204:205], v163
  ds_read_b64_tr_b16 a[206:207], v163 offset:2048
  ds_read_b64_tr_b16 a[208:209], v160 offset:256
  ds_read_b64_tr_b16 a[210:211], v160 offset:2304
  ds_read_b64_tr_b16 a[212:213], v161 offset:256
  ds_read_b64_tr_b16 a[214:215], v161 offset:2304
  s_waitcnt lgkmcnt(11)
  v_mfma_f32_32x32x16_bf16 v[0:15], a[192:195], a[64:67], 0
  ds_read_b64_tr_b16 a[216:217], v162 offset:256
  ds_read_b64_tr_b16 a[218:219], v162 offset:2304
  s_add_u32 s66, s67, 3
  s_cmp_ge_u32 s66, 14
  s_cselect_b32 s31, 14, 0
  s_waitcnt lgkmcnt(12)
  v_mfma_f32_32x32x16_bf16 v[128:143], a[192:195], a[68:71], 0
  ds_read_b64_tr_b16 a[220:221], v163 offset:256
  ds_read_b64_tr_b16 a[222:223], v163 offset:2304
  s_sub_u32 s66, s66, s31
  s_waitcnt lgkmcnt(12)
  v_mfma_f32_32x32x16_bf16 v[16:31], a[196:199], a[64:67], 0
  ds_read_b128 a[72:75], v165
  ds_read_b64_tr_b16 a[224:225], v160 offset:8192
  ds_read_b64_tr_b16 a[226:227], v160 offset:10240
  s_lshl_b32 s66, s66, 18
  s_waitcnt lgkmcnt(13)
  v_mfma_f32_32x32x16_bf16 v[32:47], a[200:203], a[64:67], 0
  ds_read_b128 a[76:79], v167
  s_add_u32 s66, s66, s65
  s_add_u32 m0, s64, 0xc000
  s_add_u32 s75, s66, 0
  s_waitcnt lgkmcnt(12)
  v_mfma_f32_32x32x16_bf16 v[48:63], a[204:207], a[64:67], 0
  ds_read_b64_tr_b16 a[228:229], v161 offset:8192
  ds_read_b64_tr_b16 a[230:231], v161 offset:10240
  buffer_load_dwordx4 v168, s[16:19], s75 offen lds
  s_add_u32 s74, s66, 0x3c00
  s_waitcnt lgkmcnt(12)
  v_mfma_f32_32x32x16_bf16 v[64:79], a[208:211], a[64:67], 0
  ds_read_b64_tr_b16 a[232:233], v162 offset:8192
  ds_read_b64_tr_b16 a[234:235], v162 offset:10240
  buffer_load_dwordx4 v169, s[16:19], s74 offen offset:1024 lds
  s_add_u32 s75, s66, 0x7800
  v_mfma_f32_32x32x16_bf16 v[144:159], a[208:211], a[68:71], 0
  ds_read_b64_tr_b16 a[236:237], v163 offset:8192
  ds_read_b64_tr_b16 a[238:239], v163 offset:10240
  buffer_load_dwordx4 v168, s[16:19], s75 offen offset:2048 lds
  s_waitcnt lgkmcnt(14)
  v_mfma_f32_32x32x16_bf16 v[80:95], a[212:215], a[64:67], 0
  ds_read_b64_tr_b16 a[240:241], v160 offset:8448
  ds_read_b64_tr_b16 a[242:243], v160 offset:10496
  s_add_u32 s74, s66, 0xb400
  buffer_load_dwordx4 v169, s[16:19], s74 offen offset:3072 lds
  s_waitcnt lgkmcnt(12)
  v_mfma_f32_32x32x16_bf16 v[96:111], a[216:219], a[64:67], 0
  s_add_u32 m0, s64, 0xd000
  s_add_u32 s75, s66, 0x10000
  buffer_load_dwordx4 v168, s[16:19], s75 offen lds
  v_mfma_f32_32x32x16_bf16 v[112:127], a[220:223], a[64:67], 0
  ds_read_b64_tr_b16 a[244:245], v161 offset:8448
  ds_read_b64_tr_b16 a[246:247], v161 offset:10496
  s_add_u32 s74, s66, 0x13c00
  buffer_load_dwordx4 v169, s[16:19], s74 offen offset:1024 lds
  s_waitcnt lgkmcnt(10)
  v_mfma_f32_32x32x16_bf16 v[0:15], a[224:227], a[72:75], v[0:15]
  ds_read_b64_tr_b16 a[248:249], v162 offset:8448
  ds_read_b64_tr_b16 a[250:251], v162 offset:10496
  s_add_u32 s75, s66, 0x17800
  buffer_load_dwordx4 v168, s[16:19], s75 offen offset:2048 lds
  v_mfma_f32_32x32x16_bf16 v[128:143], a[224:227], a[76:79], v[128:143]
  ds_read_b64_tr_b16 a[252:253], v163 offset:8448
  ds_read_b64_tr_b16 a[254:255], v163 offset:10496
  s_add_u32 s74, s66, 0x1b400
  buffer_load_dwordx4 v169, s[16:19], s74 offen offset:3072 lds
  s_waitcnt lgkmcnt(10)
  v_mfma_f32_32x32x16_bf16 v[16:31], a[228:231], a[72:75], v[16:31]
  v_mfma_f32_32x32x16_bf16 v[32:47], a[232:235], a[72:75], v[32:47]
  s_waitcnt vmcnt(16)
  s_waitcnt lgkmcnt(0)
  s_barrier
  ds_read_b128 a[80:83], v164 offset:10240
  ds_read_b64_tr_b16 a[192:193], v160 offset:16384
  ds_read_b64_tr_b16 a[194:195], v160 offset:18432
  ds_read_b128 a[84:87], v166 offset:10240
  v_mfma_f32_32x32x16_bf16 v[48:63], a[236:239], a[72:75], v[48:63]
  ds_read_b64_tr_b16 a[196:197], v161 offset:16384
  ds_read_b64_tr_b16 a[198:199], v161 offset:18432
  s_add_u32 s66, s67, 4
  s_cmp_ge_u32 s66, 14
  s_cselect_b32 s31, 14, 0
  v_mfma_f32_32x32x16_bf16 v[64:79], a[240:243], a[72:75], v[64:79]
  ds_read_b64_tr_b16 a[200:201], v162 offset:16384
  ds_read_b64_tr_b16 a[202:203], v162 offset:18432
  s_sub_u32 s66, s66, s31
  s_lshl_b32 s66, s66, 18
  v_mfma_f32_32x32x16_bf16 v[144:159], a[240:243], a[76:79], v[144:159]
  ds_read_b64_tr_b16 a[204:205], v163 offset:16384
  ds_read_b64_tr_b16 a[206:207], v163 offset:18432
  s_add_u32 s66, s66, s65
  s_add_u32 m0, s64, 0x10000
  s_add_u32 s75, s66, 0
  v_mfma_f32_32x32x16_bf16 v[80:95], a[244:247], a[72:75], v[80:95]
  ds_read_b64_tr_b16 a[208:209], v160 offset:16640
  ds_read_b64_tr_b16 a[210:211], v160 offset:18688
  buffer_load_dwordx4 v168, s[16:19], s75 offen lds
  s_add_u32 s74, s66, 0x3c00
  buffer_load_dwordx4 v169, s[16:19], s74 offen offset:1024 lds
  v_mfma_f32_32x32x16_bf16 v[96:111], a[248:251], a[72:75], v[96:111]
  s_add_u32 s75, s66, 0x7800
  buffer_load_dwordx4 v168, s[16:19], s75 offen offset:2048 lds
  s_add_u32 s74, s66, 0xb400
  buffer_load_dwordx4 v169, s[16:19], s74 offen offset:3072 lds
  v_mfma_f32_32x32x16_bf16 v[112:127], a[252:255], a[72:75], v[112:127]
  ds_read_b64_tr_b16 a[212:213], v161 offset:16640
  ds_read_b64_tr_b16 a[214:215], v161 offset:18688
  s_add_u32 m0, s64, 0x11000
  s_add_u32 s75, s66, 0x10000
  s_waitcnt lgkmcnt(10)
  v_mfma_f32_32x32x16_bf16 v[0:15], a[192:195], a[80:83], v[0:15]
  ds_read_b64_tr_b16 a[216:217], v162 offset:16640
  ds_read_b64_tr_b16 a[218:219], v162 offset:18688
  buffer_load_dwordx4 v168, s[16:19], s75 offen lds
  s_add_u32 s74, s66, 0x13c00
  buffer_load_dwordx4 v169, s[16:19], s74 offen offset:1024 lds
  v_mfma_f32_32x32x16_bf16 v[128:143], a[192:195], a[84:87], v[128:143]
  ds_read_b64_tr_b16 a[220:221], v163 offset:16640
  ds_read_b64_tr_b16 a[222:223], v163 offset:18688
  s_add_u32 s75, s66, 0x17800
  buffer_load_dwordx4 v168, s[16:19], s75 offen offset:2048 lds
  s_add_u32 s74, s66, 0x1b400
  s_waitcnt lgkmcnt(10)
  v_mfma_f32_32x32x16_bf16 v[16:31], a[196:199], a[80:83], v[16:31]
  ds_read_b128 a[88:91], v165 offset:10240
  ds_read_b64_tr_b16 a[224:225], v160 offset:24576
  ds_read_b64_tr_b16 a[226:227], v160 offset:26624
  buffer_load_dwordx4 v169, s[16:19], s74 offen offset:3072 lds
  s_add_u32 s66, s67, 5
  v_mfma_f32_32x32x16_bf16 v[32:47], a[200:203], a[80:83], v[32:47]
  ds_read_b128 a[92:95], v167 offset:10240
  s_cmp_ge_u32 s66, 14
  s_cselect_b32 s31, 14, 0
  s_sub_u32 s66, s66, s31
  s_waitcnt lgkmcnt(10)
  v_mfma_f32_32x32x16_bf16 v[48:63], a[204:207], a[80:83], v[48:63]
  ds_read_b64_tr_b16 a[228:229], v161 offset:24576
  ds_read_b64_tr_b16 a[230:231], v161 offset:26624
  s_lshl_b32 s66, s66, 18
  s_add_u32 s66, s66, s65
  s_add_u32 m0, s64, 0x14000
  v_mfma_f32_32x32x16_bf16 v[64:79], a[208:211], a[80:83], v[64:79]
  ds_read_b64_tr_b16 a[232:233], v162 offset:24576
  ds_read_b64_tr_b16 a[234:235], v162 offset:26624
  s_add_u32 s75, s66, 0
  buffer_load_dwordx4 v168, s[16:19], s75 offen lds
  s_waitcnt lgkmcnt(12)
  v_mfma_f32_32x32x16_bf16 v[144:159], a[208:211], a[84:87], v[144:159]
  ds_read_b64_tr_b16 a[236:237], v163 offset:24576
  ds_read_b64_tr_b16 a[238:239], v163 offset:26624
  s_add_u32 s74, s66, 0x3c00
  buffer_load_dwordx4 v169, s[16:19], s74 offen offset:1024 lds
  s_add_u32 s75, s66, 0x7800
  v_mfma_f32_32x32x16_bf16 v[80:95], a[212:215], a[80:83], v[80:95]
  ds_read_b64_tr_b16 a[240:241], v160 offset:24832
  ds_read_b64_tr_b16 a[242:243], v160 offset:26880
  buffer_load_dwordx4 v168, s[16:19], s75 offen offset:2048 lds
  s_add_u32 s74, s66, 0xb400
  buffer_load_dwordx4 v169, s[16:19], s74 offen offset:3072 lds
  s_waitcnt lgkmcnt(12)
  v_mfma_f32_32x32x16_bf16 v[96:111], a[216:219], a[80:83], v[96:111]
  s_add_u32 m0, s64, 0x15000
  s_add_u32 s75, s66, 0x10000
  buffer_load_dwordx4 v168, s[16:19], s75 offen lds
  s_add_u32 s74, s66, 0x13c00
  v_mfma_f32_32x32x16_bf16 v[112:127], a[220:223], a[80:83], v[112:127]
  ds_read_b64_tr_b16 a[244:245], v161 offset:24832
  ds_read_b64_tr_b16 a[246:247], v161 offset:26880
  buffer_load_dwordx4 v169, s[16:19], s74 offen offset:1024 lds
  s_add_u32 s75, s66, 0x17800
  s_waitcnt lgkmcnt(10)
  v_mfma_f32_32x32x16_bf16 v[0:15], a[224:227], a[88:91], v[0:15]
  ds_read_b64_tr_b16 a[248:249], v162 offset:24832
  ds_read_b64_tr_b16 a[250:251], v162 offset:26880
  buffer_load_dwordx4 v168, s[16:19], s75 offen offset:2048 lds
  s_add_u32 s74, s66, 0x1b400
  buffer_load_dwordx4 v169, s[16:19], s74 offen offset:3072 lds
  v_mfma_f32_32x32x16_bf16 v[128:143], a[224:227], a[92:95], v[128:143]
  ds_read_b64_tr_b16 a[252:253], v163 offset:24832
  ds_read_b64_tr_b16 a[254:255], v163 offset:26880
  s_waitcnt lgkmcnt(10)
  v_mfma_f32_32x32x16_bf16 v[16:31], a[228:231], a[88:91], v[16:31]
  v_mfma_f32_32x32x16_bf16 v[32:47], a[232:235], a[88:91], v[32:47]
  s_waitcnt vmcnt(24)
  s_waitcnt lgkmcnt(0)
  s_barrier
  ds_read_b128 a[96:99], v164 offset:20480
  ds_read_b64_tr_b16 a[192:193], v160 offset:32768
  ds_read_b64_tr_b16 a[194:195], v160 offset:34816
  ds_read_b128 a[100:103], v166 offset:20480
  v_mfma_f32_32x32x16_bf16 v[48:63], a[236:239], a[88:91], v[48:63]
  ds_read_b64_tr_b16 a[196:197], v161 offset:32768
  ds_read_b64_tr_b16 a[198:199], v161 offset:34816
  s_add_u32 s66, s67, 6
  s_cmp_ge_u32 s66, 14
  s_cselect_b32 s31, 14, 0
  v_mfma_f32_32x32x16_bf16 v[64:79], a[240:243], a[88:91], v[64:79]
  ds_read_b64_tr_b16 a[200:201], v162 offset:32768
  ds_read_b64_tr_b16 a[202:203], v162 offset:34816
  s_sub_u32 s66, s66, s31
  v_mfma_f32_32x32x16_bf16 v[144:159], a[240:243], a[92:95], v[144:159]
  ds_read_b64_tr_b16 a[204:205], v163 offset:32768
  ds_read_b64_tr_b16 a[206:207], v163 offset:34816
  s_lshl_b32 s66, s66, 18
  s_add_u32 s66, s66, s65
  v_mfma_f32_32x32x16_bf16 v[80:95], a[244:247], a[88:91], v[80:95]
  ds_read_b64_tr_b16 a[208:209], v160 offset:33024
  ds_read_b64_tr_b16 a[210:211], v160 offset:35072
  s_add_u32 m0, s64, 0
  s_add_u32 s75, s66, 0
  v_mfma_f32_32x32x16_bf16 v[96:111], a[248:251], a[88:91], v[96:111]
  buffer_load_dwordx4 v168, s[16:19], s75 offen lds
  s_add_u32 s74, s66, 0x3c00
  buffer_load_dwordx4 v169, s[16:19], s74 offen offset:1024 lds
  v_mfma_f32_32x32x16_bf16 v[112:127], a[252:255], a[88:91], v[112:127]
  ds_read_b64_tr_b16 a[212:213], v161 offset:33024
  ds_read_b64_tr_b16 a[214:215], v161 offset:35072
  s_add_u32 s75, s66, 0x7800
  buffer_load_dwordx4 v168, s[16:19], s75 offen offset:2048 lds
  s_waitcnt lgkmcnt(10)
  v_mfma_f32_32x32x16_bf16 v[0:15], a[192:195], a[96:99], v[0:15]
  ds_read_b64_tr_b16 a[216:217], v162 offset:33024
  ds_read_b64_tr_b16 a[218:219], v162 offset:35072
  s_add_u32 s74, s66, 0xb400
  v_mfma_f32_32x32x16_bf16 v[128:143], a[192:195], a[100:103], v[128:143]
  ds_read_b64_tr_b16 a[220:221], v163 offset:33024
  ds_read_b64_tr_b16 a[222:223], v163 offset:35072
  buffer_load_dwordx4 v169, s[16:19], s74 offen offset:3072 lds
  s_add_u32 m0, s64, 0x1000
  s_waitcnt lgkmcnt(10)
  v_mfma_f32_32x32x16_bf16 v[16:31], a[196:199], a[96:99], v[16:31]
  ds_read_b128 a[104:107], v165 offset:20480
  ds_read_b64_tr_b16 a[224:225], v160 offset:40960
  ds_read_b64_tr_b16 a[226:227], v160 offset:43008
  s_add_u32 s75, s66, 0x10000
  buffer_load_dwordx4 v168, s[16:19], s75 offen lds
  v_mfma_f32_32x32x16_bf16 v[32:47], a[200:203], a[96:99], v[32:47]
  ds_read_b128 a[108:111], v167 offset:20480
  s_add_u32 s74, s66, 0x13c00
  buffer_load_dwordx4 v169, s[16:19], s74 offen offset:1024 lds
  s_waitcnt lgkmcnt(10)
  v_mfma_f32_32x32x16_bf16 v[48:63], a[204:207], a[96:99], v[48:63]
  ds_read_b64_tr_b16 a[228:229], v161 offset:40960
  ds_read_b64_tr_b16 a[230:231], v161 offset:43008
  s_add_u32 s75, s66, 0x17800
  buffer_load_dwordx4 v168, s[16:19], s75 offen offset:2048 lds
  v_mfma_f32_32x32x16_bf16 v[64:79], a[208:211], a[96:99], v[64:79]
  ds_read_b64_tr_b16 a[232:233], v162 offset:40960
  ds_read_b64_tr_b16 a[234:235], v162 offset:43008
  s_add_u32 s74, s66, 0x1b400
  buffer_load_dwordx4 v169, s[16:19], s74 offen offset:3072 lds
  s_waitcnt lgkmcnt(12)
  v_mfma_f32_32x32x16_bf16 v[144:159], a[208:211], a[100:103], v[144:159]
  ds_read_b64_tr_b16 a[236:237], v163 offset:40960
  ds_read_b64_tr_b16 a[238:239], v163 offset:43008
  v_mfma_f32_32x32x16_bf16 v[80:95], a[212:215], a[96:99], v[80:95]
  ds_read_b64_tr_b16 a[240:241], v160 offset:41216
  ds_read_b64_tr_b16 a[242:243], v160 offset:43264
  s_waitcnt lgkmcnt(12)
  v_mfma_f32_32x32x16_bf16 v[96:111], a[216:219], a[96:99], v[96:111]
  v_mfma_f32_32x32x16_bf16 v[112:127], a[220:223], a[96:99], v[112:127]
  ds_read_b64_tr_b16 a[244:245], v161 offset:41216
  ds_read_b64_tr_b16 a[246:247], v161 offset:43264
  s_waitcnt lgkmcnt(10)
  v_mfma_f32_32x32x16_bf16 v[0:15], a[224:227], a[104:107], v[0:15]
  ds_read_b64_tr_b16 a[248:249], v162 offset:41216
  ds_read_b64_tr_b16 a[250:251], v162 offset:43264
  v_mfma_f32_32x32x16_bf16 v[128:143], a[224:227], a[108:111], v[128:143]
  ds_read_b64_tr_b16 a[252:253], v163 offset:41216
  ds_read_b64_tr_b16 a[254:255], v163 offset:43264
  s_waitcnt lgkmcnt(10)
  v_mfma_f32_32x32x16_bf16 v[16:31], a[228:231], a[104:107], v[16:31]
  v_mfma_f32_32x32x16_bf16 v[32:47], a[232:235], a[104:107], v[32:47]
  s_waitcnt vmcnt(24)
  s_waitcnt lgkmcnt(0)
  s_barrier
  ds_read_b128 a[64:67], v164 offset:30720
  ds_read_b64_tr_b16 a[192:193], v160 offset:49152
  ds_read_b64_tr_b16 a[194:195], v160 offset:51200
  ds_read_b128 a[68:71], v166 offset:30720
  v_mfma_f32_32x32x16_bf16 v[48:63], a[236:239], a[104:107], v[48:63]
  ds_read_b64_tr_b16 a[196:197], v161 offset:49152
  ds_read_b64_tr_b16 a[198:199], v161 offset:51200
  s_add_u32 s66, s67, 7
  s_cmp_ge_u32 s66, 14
  s_cselect_b32 s31, 14, 0
  v_mfma_f32_32x32x16_bf16 v[64:79], a[240:243], a[104:107], v[64:79]
  ds_read_b64_tr_b16 a[200:201], v162 offset:49152
  ds_read_b64_tr_b16 a[202:203], v162 offset:51200
  s_sub_u32 s66, s66, s31
  s_lshl_b32 s66, s66, 18
  v_mfma_f32_32x32x16_bf16 v[144:159], a[240:243], a[108:111], v[144:159]
  ds_read_b64_tr_b16 a[204:205], v163 offset:49152
  ds_read_b64_tr_b16 a[206:207], v163 offset:51200
  s_add_u32 s66, s66, s65
  s_add_u32 m0, s64, 0x4000
  s_add_u32 s75, s66, 0
  v_mfma_f32_32x32x16_bf16 v[80:95], a[244:247], a[104:107], v[80:95]
  ds_read_b64_tr_b16 a[208:209], v160 offset:49408
  ds_read_b64_tr_b16 a[210:211], v160 offset:51456
  buffer_load_dwordx4 v168, s[16:19], s75 offen lds
  s_add_u32 s74, s66, 0x3c00
  buffer_load_dwordx4 v169, s[16:19], s74 offen offset:1024 lds
  v_mfma_f32_32x32x16_bf16 v[96:111], a[248:251], a[104:107], v[96:111]
  s_add_u32 s75, s66, 0x7800
  buffer_load_dwordx4 v168, s[16:19], s75 offen offset:2048 lds
  s_add_u32 s74, s66, 0xb400
  buffer_load_dwordx4 v169, s[16:19], s74 offen offset:3072 lds
  v_mfma_f32_32x32x16_bf16 v[112:127], a[252:255], a[104:107], v[112:127]
  ds_read_b64_tr_b16 a[212:213], v161 offset:49408
  ds_read_b64_tr_b16 a[214:215], v161 offset:51456
  s_add_u32 m0, s64, 0x5000
  s_add_u32 s75, s66, 0x10000
  s_waitcnt lgkmcnt(10)
  v_mfma_f32_32x32x16_bf16 v[0:15], a[192:195], a[64:67], v[0:15]
  ds_read_b64_tr_b16 a[216:217], v162 offset:49408
  ds_read_b64_tr_b16 a[218:219], v162 offset:51456
  buffer_load_dwordx4 v168, s[16:19], s75 offen lds
  s_add_u32 s74, s66, 0x13c00
  buffer_load_dwordx4 v169, s[16:19], s74 offen offset:1024 lds
  v_mfma_f32_32x32x16_bf16 v[128:143], a[192:195], a[68:71], v[128:143]
  ds_read_b64_tr_b16 a[220:221], v163 offset:49408
  ds_read_b64_tr_b16 a[222:223], v163 offset:51456
  s_add_u32 s75, s66, 0x17800
  buffer_load_dwordx4 v168, s[16:19], s75 offen offset:2048 lds
  s_add_u32 s74, s66, 0x1b400
  s_waitcnt lgkmcnt(10)
  v_mfma_f32_32x32x16_bf16 v[16:31], a[196:199], a[64:67], v[16:31]
  ds_read_b128 a[72:75], v165 offset:30720
  ds_read_b64_tr_b16 a[224:225], v160 offset:57344
  ds_read_b64_tr_b16 a[226:227], v160 offset:59392
  buffer_load_dwordx4 v169, s[16:19], s74 offen offset:3072 lds
  s_add_u32 s66, s67, 8
  v_mfma_f32_32x32x16_bf16 v[32:47], a[200:203], a[64:67], v[32:47]
  ds_read_b128 a[76:79], v167 offset:30720
  s_cmp_ge_u32 s66, 14
  s_cselect_b32 s31, 14, 0
  s_sub_u32 s66, s66, s31
  s_waitcnt lgkmcnt(10)
  v_mfma_f32_32x32x16_bf16 v[48:63], a[204:207], a[64:67], v[48:63]
  ds_read_b64_tr_b16 a[228:229], v161 offset:57344
  ds_read_b64_tr_b16 a[230:231], v161 offset:59392
  s_lshl_b32 s66, s66, 18
  s_add_u32 s66, s66, s65
  s_add_u32 m0, s64, 0x8000
  v_mfma_f32_32x32x16_bf16 v[64:79], a[208:211], a[64:67], v[64:79]
  ds_read_b64_tr_b16 a[232:233], v162 offset:57344
  ds_read_b64_tr_b16 a[234:235], v162 offset:59392
  s_add_u32 s75, s66, 0
  buffer_load_dwordx4 v168, s[16:19], s75 offen lds
  s_waitcnt lgkmcnt(12)
  v_mfma_f32_32x32x16_bf16 v[144:159], a[208:211], a[68:71], v[144:159]
  ds_read_b64_tr_b16 a[236:237], v163 offset:57344
  ds_read_b64_tr_b16 a[238:239], v163 offset:59392
  s_add_u32 s74, s66, 0x3c00
  buffer_load_dwordx4 v169, s[16:19], s74 offen offset:1024 lds
  s_add_u32 s75, s66, 0x7800
  v_mfma_f32_32x32x16_bf16 v[80:95], a[212:215], a[64:67], v[80:95]
  ds_read_b64_tr_b16 a[240:241], v160 offset:57600
  ds_read_b64_tr_b16 a[242:243], v160 offset:59648
  buffer_load_dwordx4 v168, s[16:19], s75 offen offset:2048 lds
  s_add_u32 s74, s66, 0xb400
  buffer_load_dwordx4 v169, s[16:19], s74 offen offset:3072 lds
  s_waitcnt lgkmcnt(12)
  v_mfma_f32_32x32x16_bf16 v[96:111], a[216:219], a[64:67], v[96:111]
  s_add_u32 m0, s64, 0x9000
  s_add_u32 s75, s66, 0x10000
  buffer_load_dwordx4 v168, s[16:19], s75 offen lds
  s_add_u32 s74, s66, 0x13c00
  v_mfma_f32_32x32x16_bf16 v[112:127], a[220:223], a[64:67], v[112:127]
  ds_read_b64_tr_b16 a[244:245], v161 offset:57600
  ds_read_b64_tr_b16 a[246:247], v161 offset:59648
  buffer_load_dwordx4 v169, s[16:19], s74 offen offset:1024 lds
  s_add_u32 s75, s66, 0x17800
  s_waitcnt lgkmcnt(10)
  v_mfma_f32_32x32x16_bf16 v[0:15], a[224:227], a[72:75], v[0:15]
  ds_read_b64_tr_b16 a[248:249], v162 offset:57600
  ds_read_b64_tr_b16 a[250:251], v162 offset:59648
  buffer_load_dwordx4 v168, s[16:19], s75 offen offset:2048 lds
  s_add_u32 s74, s66, 0x1b400
  buffer_load_dwordx4 v169, s[16:19], s74 offen offset:3072 lds
  v_mfma_f32_32x32x16_bf16 v[128:143], a[224:227], a[76:79], v[128:143]
  ds_read_b64_tr_b16 a[252:253], v163 offset:57600
  ds_read_b64_tr_b16 a[254:255], v163 offset:59648
  s_waitcnt lgkmcnt(10)
  v_mfma_f32_32x32x16_bf16 v[16:31], a[228:231], a[72:75], v[16:31]
  v_mfma_f32_32x32x16_bf16 v[32:47], a[232:235], a[72:75], v[32:47]
  s_waitcnt vmcnt(32)
  s_waitcnt lgkmcnt(0)
  s_barrier
  ds_read_b128 a[80:83], v164 offset:40960
  ds_read_b64_tr_b16 a[192:193], v180
  ds_read_b64_tr_b16 a[194:195], v180 offset:2048
  ds_read_b128 a[84:87], v166 offset:40960
  v_mfma_f32_32x32x16_bf16 v[48:63], a[236:239], a[72:75], v[48:63]
  ds_read_b64_tr_b16 a[196:197], v181
  ds_read_b64_tr_b16 a[198:199], v181 offset:2048
  s_add_u32 s66, s67, 9
  s_cmp_ge_u32 s66, 14
  s_cselect_b32 s31, 14, 0
  v_mfma_f32_32x32x16_bf16 v[64:79], a[240:243], a[72:75], v[64:79]
  ds_read_b64_tr_b16 a[200:201], v182
  ds_read_b64_tr_b16 a[202:203], v182 offset:2048
  s_sub_u32 s66, s66, s31
  v_mfma_f32_32x32x16_bf16 v[144:159], a[240:243], a[76:79], v[144:159]
  ds_read_b64_tr_b16 a[204:205], v183
  ds_read_b64_tr_b16 a[206:207], v183 offset:2048
  s_lshl_b32 s66, s66, 18
  s_add_u32 s66, s66, s65
  v_mfma_f32_32x32x16_bf16 v[80:95], a[244:247], a[72:75], v[80:95]
  ds_read_b64_tr_b16 a[208:209], v180 offset:256
  ds_read_b64_tr_b16 a[210:211], v180 offset:2304
  s_add_u32 m0, s64, 0xc000
  s_add_u32 s75, s66, 0
  v_mfma_f32_32x32x16_bf16 v[96:111], a[248:251], a[72:75], v[96:111]
  buffer_load_dwordx4 v168, s[16:19], s75 offen lds
  s_add_u32 s74, s66, 0x3c00
  buffer_load_dwordx4 v169, s[16:19], s74 offen offset:1024 lds
  v_mfma_f32_32x32x16_bf16 v[112:127], a[252:255], a[72:75], v[112:127]
  ds_read_b64_tr_b16 a[212:213], v181 offset:256
  ds_read_b64_tr_b16 a[214:215], v181 offset:2304
  s_add_u32 s75, s66, 0x7800
  buffer_load_dwordx4 v168, s[16:19], s75 offen offset:2048 lds
  s_waitcnt lgkmcnt(10)
  v_mfma_f32_32x32x16_bf16 v[0:15], a[192:195], a[80:83], v[0:15]
  ds_read_b64_tr_b16 a[216:217], v182 offset:256
  ds_read_b64_tr_b16 a[218:219], v182 offset:2304
  s_add_u32 s74, s66, 0xb400
  v_mfma_f32_32x32x16_bf16 v[128:143], a[192:195], a[84:87], v[128:143]
  ds_read_b64_tr_b16 a[220:221], v183 offset:256
  ds_read_b64_tr_b16 a[222:223], v183 offset:2304
  buffer_load_dwordx4 v169, s[16:19], s74 offen offset:3072 lds
  s_add_u32 m0, s64, 0xd000
  s_waitcnt lgkmcnt(10)
  v_mfma_f32_32x32x16_bf16 v[16:31], a[196:199], a[80:83], v[16:31]
  ds_read_b128 a[88:91], v165 offset:40960
  ds_read_b64_tr_b16 a[224:225], v180 offset:8192
  ds_read_b64_tr_b16 a[226:227], v180 offset:10240
  s_add_u32 s75, s66, 0x10000
  buffer_load_dwordx4 v168, s[16:19], s75 offen lds
  v_mfma_f32_32x32x16_bf16 v[32:47], a[200:203], a[80:83], v[32:47]
  ds_read_b128 a[92:95], v167 offset:40960
  s_add_u32 s74, s66, 0x13c00
  buffer_load_dwordx4 v169, s[16:19], s74 offen offset:1024 lds
  s_waitcnt lgkmcnt(10)
  v_mfma_f32_32x32x16_bf16 v[48:63], a[204:207], a[80:83], v[48:63]
  ds_read_b64_tr_b16 a[228:229], v181 offset:8192
  ds_read_b64_tr_b16 a[230:231], v181 offset:10240
  s_add_u32 s75, s66, 0x17800
  buffer_load_dwordx4 v168, s[16:19], s75 offen offset:2048 lds
  v_mfma_f32_32x32x16_bf16 v[64:79], a[208:211], a[80:83], v[64:79]
  ds_read_b64_tr_b16 a[232:233], v182 offset:8192
  ds_read_b64_tr_b16 a[234:235], v182 offset:10240
  s_add_u32 s74, s66, 0x1b400
  buffer_load_dwordx4 v169, s[16:19], s74 offen offset:3072 lds
  s_waitcnt lgkmcnt(12)
  v_mfma_f32_32x32x16_bf16 v[144:159], a[208:211], a[84:87], v[144:159]
  ds_read_b64_tr_b16 a[236:237], v183 offset:8192
  ds_read_b64_tr_b16 a[238:239], v183 offset:10240
  v_mfma_f32_32x32x16_bf16 v[80:95], a[212:215], a[80:83], v[80:95]
  ds_read_b64_tr_b16 a[240:241], v180 offset:8448
  ds_read_b64_tr_b16 a[242:243], v180 offset:10496
  s_waitcnt lgkmcnt(12)
  v_mfma_f32_32x32x16_bf16 v[96:111], a[216:219], a[80:83], v[96:111]
  v_mfma_f32_32x32x16_bf16 v[112:127], a[220:223], a[80:83], v[112:127]
  ds_read_b64_tr_b16 a[244:245], v181 offset:8448
  ds_read_b64_tr_b16 a[246:247], v181 offset:10496
  s_waitcnt lgkmcnt(10)
  v_mfma_f32_32x32x16_bf16 v[0:15], a[224:227], a[88:91], v[0:15]
  ds_read_b64_tr_b16 a[248:249], v182 offset:8448
  ds_read_b64_tr_b16 a[250:251], v182 offset:10496
  v_mfma_f32_32x32x16_bf16 v[128:143], a[224:227], a[92:95], v[128:143]
  ds_read_b64_tr_b16 a[252:253], v183 offset:8448
  ds_read_b64_tr_b16 a[254:255], v183 offset:10496
  s_waitcnt lgkmcnt(10)
  v_mfma_f32_32x32x16_bf16 v[16:31], a[228:231], a[88:91], v[16:31]
  v_mfma_f32_32x32x16_bf16 v[32:47], a[232:235], a[88:91], v[32:47]
  s_waitcnt vmcnt(32)
  s_waitcnt lgkmcnt(0)
  s_barrier
  ds_read_b128 a[96:99], v164 offset:51200
  ds_read_b64_tr_b16 a[192:193], v180 offset:16384
  ds_read_b64_tr_b16 a[194:195], v180 offset:18432
  ds_read_b128 a[100:103], v166 offset:51200
  v_mfma_f32_32x32x16_bf16 v[48:63], a[236:239], a[88:91], v[48:63]
  ds_read_b64_tr_b16 a[196:197], v181 offset:16384
  ds_read_b64_tr_b16 a[198:199], v181 offset:18432
  s_add_u32 s66, s67, 10
  s_cmp_ge_u32 s66, 14
  s_cselect_b32 s31, 14, 0
  v_mfma_f32_32x32x16_bf16 v[64:79], a[240:243], a[88:91], v[64:79]
  ds_read_b64_tr_b16 a[200:201], v182 offset:16384
  ds_read_b64_tr_b16 a[202:203], v182 offset:18432
  s_sub_u32 s66, s66, s31
  v_mfma_f32_32x32x16_bf16 v[144:159], a[240:243], a[92:95], v[144:159]
  ds_read_b64_tr_b16 a[204:205], v183 offset:16384
  ds_read_b64_tr_b16 a[206:207], v183 offset:18432
  s_lshl_b32 s66, s66, 18
  s_add_u32 s66, s66, s65
  v_mfma_f32_32x32x16_bf16 v[80:95], a[244:247], a[88:91], v[80:95]
  ds_read_b64_tr_b16 a[208:209], v180 offset:16640
  ds_read_b64_tr_b16 a[210:211], v180 offset:18688
  s_add_u32 m0, s64, 0x10000
  s_add_u32 s75, s66, 0
  v_mfma_f32_32x32x16_bf16 v[96:111], a[248:251], a[88:91], v[96:111]
  buffer_load_dwordx4 v168, s[16:19], s75 offen lds
  s_add_u32 s74, s66, 0x3c00
  buffer_load_dwordx4 v169, s[16:19], s74 offen offset:1024 lds
  v_mfma_f32_32x32x16_bf16 v[112:127], a[252:255], a[88:91], v[112:127]
  ds_read_b64_tr_b16 a[212:213], v181 offset:16640
  ds_read_b64_tr_b16 a[214:215], v181 offset:18688
  s_add_u32 s75, s66, 0x7800
  buffer_load_dwordx4 v168, s[16:19], s75 offen offset:2048 lds
  s_waitcnt lgkmcnt(10)
  v_mfma_f32_32x32x16_bf16 v[0:15], a[192:195], a[96:99], v[0:15]
  ds_read_b64_tr_b16 a[216:217], v182 offset:16640
  ds_read_b64_tr_b16 a[218:219], v182 offset:18688
  s_add_u32 s74, s66, 0xb400
  v_mfma_f32_32x32x16_bf16 v[128:143], a[192:195], a[100:103], v[128:143]
  ds_read_b64_tr_b16 a[220:221], v183 offset:16640
  ds_read_b64_tr_b16 a[222:223], v183 offset:18688
  buffer_load_dwordx4 v169, s[16:19], s74 offen offset:3072 lds
  s_add_u32 m0, s64, 0x11000
  s_waitcnt lgkmcnt(10)
  v_mfma_f32_32x32x16_bf16 v[16:31], a[196:199], a[96:99], v[16:31]
  ds_read_b128 a[104:107], v165 offset:51200
  ds_read_b64_tr_b16 a[224:225], v180 offset:24576
  ds_read_b64_tr_b16 a[226:227], v180 offset:26624
  s_add_u32 s75, s66, 0x10000
  buffer_load_dwordx4 v168, s[16:19], s75 offen lds
  v_mfma_f32_32x32x16_bf16 v[32:47], a[200:203], a[96:99], v[32:47]
  ds_read_b128 a[108:111], v167 offset:51200
  s_add_u32 s74, s66, 0x13c00
  buffer_load_dwordx4 v169, s[16:19], s74 offen offset:1024 lds
  s_waitcnt lgkmcnt(10)
  v_mfma_f32_32x32x16_bf16 v[48:63], a[204:207], a[96:99], v[48:63]
  ds_read_b64_tr_b16 a[228:229], v181 offset:24576
  ds_read_b64_tr_b16 a[230:231], v181 offset:26624
  s_add_u32 s75, s66, 0x17800
  buffer_load_dwordx4 v168, s[16:19], s75 offen offset:2048 lds
  v_mfma_f32_32x32x16_bf16 v[64:79], a[208:211], a[96:99], v[64:79]
  ds_read_b64_tr_b16 a[232:233], v182 offset:24576
  ds_read_b64_tr_b16 a[234:235], v182 offset:26624
  s_add_u32 s74, s66, 0x1b400
  buffer_load_dwordx4 v169, s[16:19], s74 offen offset:3072 lds
  s_waitcnt lgkmcnt(12)
  v_mfma_f32_32x32x16_bf16 v[144:159], a[208:211], a[100:103], v[144:159]
  ds_read_b64_tr_b16 a[236:237], v183 offset:24576
  ds_read_b64_tr_b16 a[238:239], v183 offset:26624
  v_mfma_f32_32x32x16_bf16 v[80:95], a[212:215], a[96:99], v[80:95]
  ds_read_b64_tr_b16 a[240:241], v180 offset:24832
  ds_read_b64_tr_b16 a[242:243], v180 offset:26880
  s_waitcnt lgkmcnt(12)
  v_mfma_f32_32x32x16_bf16 v[96:111], a[216:219], a[96:99], v[96:111]
  v_mfma_f32_32x32x16_bf16 v[112:127], a[220:223], a[96:99], v[112:127]
  ds_read_b64_tr_b16 a[244:245], v181 offset:24832
  ds_read_b64_tr_b16 a[246:247], v181 offset:26880
  s_waitcnt lgkmcnt(10)
  v_mfma_f32_32x32x16_bf16 v[0:15], a[224:227], a[104:107], v[0:15]
  ds_read_b64_tr_b16 a[248:249], v182 offset:24832
  ds_read_b64_tr_b16 a[250:251], v182 offset:26880
  v_mfma_f32_32x32x16_bf16 v[128:143], a[224:227], a[108:111], v[128:143]
  ds_read_b64_tr_b16 a[252:253], v183 offset:24832
  ds_read_b64_tr_b16 a[254:255], v183 offset:26880
  s_waitcnt lgkmcnt(10)
  v_mfma_f32_32x32x16_bf16 v[16:31], a[228:231], a[104:107], v[16:31]
  v_mfma_f32_32x32x16_bf16 v[32:47], a[232:235], a[104:107], v[32:47]
  s_waitcnt vmcnt(32)
  s_waitcnt lgkmcnt(0)
  s_barrier
  ds_read_b128 a[64:67], v164
  ds_read_b64_tr_b16 a[192:193], v160
  ds_read_b64_tr_b16 a[194:195], v160 offset:2048
  ds_read_b128 a[68:71], v166
  v_mfma_f32_32x32x16_bf16 v[48:63], a[236:239], a[104:107], v[48:63]
  ds_read_b64_tr_b16 a[196:197], v161
  ds_read_b64_tr_b16 a[198:199], v161 offset:2048
  s_add_u32 s66, s67, 11
  s_cmp_ge_u32 s66, 14
  s_cselect_b32 s31, 14, 0
  v_mfma_f32_32x32x16_bf16 v[64:79], a[240:243], a[104:107], v[64:79]
  ds_read_b64_tr_b16 a[200:201], v162
  ds_read_b64_tr_b16 a[202:203], v162 offset:2048
  s_sub_u32 s66, s66, s31
  v_mfma_f32_32x32x16_bf16 v[144:159], a[240:243], a[108:111], v[144:159]
  ds_read_b64_tr_b16 a[204:205], v163
  ds_read_b64_tr_b16 a[206:207], v163 offset:2048
  s_lshl_b32 s66, s66, 18
  s_add_u32 s66, s66, s65
  v_mfma_f32_32x32x16_bf16 v[80:95], a[244:247], a[104:107], v[80:95]
  ds_read_b64_tr_b16 a[208:209], v160 offset:256
  ds_read_b64_tr_b16 a[210:211], v160 offset:2304
  s_add_u32 m0, s64, 0x14000
  s_add_u32 s75, s66, 0
  v_mfma_f32_32x32x16_bf16 v[96:111], a[248:251], a[104:107], v[96:111]
  buffer_load_dwordx4 v168, s[16:19], s75 offen lds
  s_add_u32 s74, s66, 0x3c00
  buffer_load_dwordx4 v169, s[16:19], s74 offen offset:1024 lds
  v_mfma_f32_32x32x16_bf16 v[112:127], a[252:255], a[104:107], v[112:127]
  ds_read_b64_tr_b16 a[212:213], v161 offset:256
  ds_read_b64_tr_b16 a[214:215], v161 offset:2304
  s_add_u32 s75, s66, 0x7800
  buffer_load_dwordx4 v168, s[16:19], s75 offen offset:2048 lds
  s_waitcnt lgkmcnt(10)
  v_mfma_f32_32x32x16_bf16 v[0:15], a[192:195], a[64:67], v[0:15]
  ds_read_b64_tr_b16 a[216:217], v162 offset:256
  ds_read_b64_tr_b16 a[218:219], v162 offset:2304
  s_add_u32 s74, s66, 0xb400
  v_mfma_f32_32x32x16_bf16 v[128:143], a[192:195], a[68:71], v[128:143]
  ds_read_b64_tr_b16 a[220:221], v163 offset:256
  ds_read_b64_tr_b16 a[222:223], v163 offset:2304
  buffer_load_dwordx4 v169, s[16:19], s74 offen offset:3072 lds
  s_add_u32 m0, s64, 0x15000
  s_waitcnt lgkmcnt(10)
  v_mfma_f32_32x32x16_bf16 v[16:31], a[196:199], a[64:67], v[16:31]
  ds_read_b128 a[72:75], v165
  ds_read_b64_tr_b16 a[224:225], v160 offset:8192
  ds_read_b64_tr_b16 a[226:227], v160 offset:10240
  s_add_u32 s75, s66, 0x10000
  buffer_load_dwordx4 v168, s[16:19], s75 offen lds
  v_mfma_f32_32x32x16_bf16 v[32:47], a[200:203], a[64:67], v[32:47]
  ds_read_b128 a[76:79], v167
  s_add_u32 s74, s66, 0x13c00
  buffer_load_dwordx4 v169, s[16:19], s74 offen offset:1024 lds
  s_waitcnt lgkmcnt(10)
  v_mfma_f32_32x32x16_bf16 v[48:63], a[204:207], a[64:67], v[48:63]
  ds_read_b64_tr_b16 a[228:229], v161 offset:8192
  ds_read_b64_tr_b16 a[230:231], v161 offset:10240
  s_add_u32 s75, s66, 0x17800
  buffer_load_dwordx4 v168, s[16:19], s75 offen offset:2048 lds
  v_mfma_f32_32x32x16_bf16 v[64:79], a[208:211], a[64:67], v[64:79]
  ds_read_b64_tr_b16 a[232:233], v162 offset:8192
  ds_read_b64_tr_b16 a[234:235], v162 offset:10240
  s_add_u32 s74, s66, 0x1b400
  buffer_load_dwordx4 v169, s[16:19], s74 offen offset:3072 lds
  s_waitcnt lgkmcnt(12)
  v_mfma_f32_32x32x16_bf16 v[144:159], a[208:211], a[68:71], v[144:159]
  ds_read_b64_tr_b16 a[236:237], v163 offset:8192
  ds_read_b64_tr_b16 a[238:239], v163 offset:10240
  v_mfma_f32_32x32x16_bf16 v[80:95], a[212:215], a[64:67], v[80:95]
  ds_read_b64_tr_b16 a[240:241], v160 offset:8448
  ds_read_b64_tr_b16 a[242:243], v160 offset:10496
  s_waitcnt lgkmcnt(12)
  v_mfma_f32_32x32x16_bf16 v[96:111], a[216:219], a[64:67], v[96:111]
  v_mfma_f32_32x32x16_bf16 v[112:127], a[220:223], a[64:67], v[112:127]
  ds_read_b64_tr_b16 a[244:245], v161 offset:8448
  ds_read_b64_tr_b16 a[246:247], v161 offset:10496
  s_waitcnt lgkmcnt(10)
  v_mfma_f32_32x32x16_bf16 v[0:15], a[224:227], a[72:75], v[0:15]
  ds_read_b64_tr_b16 a[248:249], v162 offset:8448
  ds_read_b64_tr_b16 a[250:251], v162 offset:10496
  v_mfma_f32_32x32x16_bf16 v[128:143], a[224:227], a[76:79], v[128:143]
  ds_read_b64_tr_b16 a[252:253], v163 offset:8448
  ds_read_b64_tr_b16 a[254:255], v163 offset:10496
  s_waitcnt lgkmcnt(10)
  v_mfma_f32_32x32x16_bf16 v[16:31], a[228:231], a[72:75], v[16:31]
  v_mfma_f32_32x32x16_bf16 v[32:47], a[232:235], a[72:75], v[32:47]
  s_waitcnt vmcnt(32)
  s_waitcnt lgkmcnt(0)
  s_barrier
  ds_read_b128 a[80:83], v164 offset:10240
  ds_read_b64_tr_b16 a[192:193], v160 offset:16384
  ds_read_b64_tr_b16 a[194:195], v160 offset:18432
  ds_read_b128 a[84:87], v166 offset:10240
  v_mfma_f32_32x32x16_bf16 v[48:63], a[236:239], a[72:75], v[48:63]
  ds_read_b64_tr_b16 a[196:197], v161 offset:16384
  ds_read_b64_tr_b16 a[198:199], v161 offset:18432
  s_add_u32 s66, s67, 12
  s_cmp_ge_u32 s66, 14
  s_cselect_b32 s31, 14, 0
  v_mfma_f32_32x32x16_bf16 v[64:79], a[240:243], a[72:75], v[64:79]
  ds_read_b64_tr_b16 a[200:201], v162 offset:16384
  ds_read_b64_tr_b16 a[202:203], v162 offset:18432
  s_sub_u32 s66, s66, s31
  v_mfma_f32_32x32x16_bf16 v[144:159], a[240:243], a[76:79], v[144:159]
  ds_read_b64_tr_b16 a[204:205], v163 offset:16384
  ds_read_b64_tr_b16 a[206:207], v163 offset:18432
  s_lshl_b32 s66, s66, 18
  s_add_u32 s66, s66, s65
  v_mfma_f32_32x32x16_bf16 v[80:95], a[244:247], a[72:75], v[80:95]
  ds_read_b64_tr_b16 a[208:209], v160 offset:16640
  ds_read_b64_tr_b16 a[210:211], v160 offset:18688
  s_add_u32 m0, s64, 0
  s_add_u32 s75, s66, 0
  v_mfma_f32_32x32x16_bf16 v[96:111], a[248:251], a[72:75], v[96:111]
  buffer_load_dwordx4 v168, s[16:19], s75 offen lds
  s_add_u32 s74, s66, 0x3c00
  buffer_load_dwordx4 v169, s[16:19], s74 offen offset:1024 lds
  v_mfma_f32_32x32x16_bf16 v[112:127], a[252:255], a[72:75], v[112:127]
  ds_read_b64_tr_b16 a[212:213], v161 offset:16640
  ds_read_b64_tr_b16 a[214:215], v161 offset:18688
  s_add_u32 s75, s66, 0x7800
  buffer_load_dwordx4 v168, s[16:19], s75 offen offset:2048 lds
  s_waitcnt lgkmcnt(10)
  v_mfma_f32_32x32x16_bf16 v[0:15], a[192:195], a[80:83], v[0:15]
  ds_read_b64_tr_b16 a[216:217], v162 offset:16640
  ds_read_b64_tr_b16 a[218:219], v162 offset:18688
  s_add_u32 s74, s66, 0xb400
  v_mfma_f32_32x32x16_bf16 v[128:143], a[192:195], a[84:87], v[128:143]
  ds_read_b64_tr_b16 a[220:221], v163 offset:16640
  ds_read_b64_tr_b16 a[222:223], v163 offset:18688
  buffer_load_dwordx4 v169, s[16:19], s74 offen offset:3072 lds
  s_add_u32 m0, s64, 0x1000
  s_waitcnt lgkmcnt(10)
  v_mfma_f32_32x32x16_bf16 v[16:31], a[196:199], a[80:83], v[16:31]
  ds_read_b128 a[88:91], v165 offset:10240
  ds_read_b64_tr_b16 a[224:225], v160 offset:24576
  ds_read_b64_tr_b16 a[226:227], v160 offset:26624
  s_add_u32 s75, s66, 0x10000
  buffer_load_dwordx4 v168, s[16:19], s75 offen lds
  v_mfma_f32_32x32x16_bf16 v[32:47], a[200:203], a[80:83], v[32:47]
  ds_read_b128 a[92:95], v167 offset:10240
  s_add_u32 s74, s66, 0x13c00
  buffer_load_dwordx4 v169, s[16:19], s74 offen offset:1024 lds
  s_waitcnt lgkmcnt(10)
  v_mfma_f32_32x32x16_bf16 v[48:63], a[204:207], a[80:83], v[48:63]
  ds_read_b64_tr_b16 a[228:229], v161 offset:24576
  ds_read_b64_tr_b16 a[230:231], v161 offset:26624
  s_add_u32 s75, s66, 0x17800
  buffer_load_dwordx4 v168, s[16:19], s75 offen offset:2048 lds
  v_mfma_f32_32x32x16_bf16 v[64:79], a[208:211], a[80:83], v[64:79]
  ds_read_b64_tr_b16 a[232:233], v162 offset:24576
  ds_read_b64_tr_b16 a[234:235], v162 offset:26624
  s_add_u32 s74, s66, 0x1b400
  buffer_load_dwordx4 v169, s[16:19], s74 offen offset:3072 lds
  s_waitcnt lgkmcnt(12)
  v_mfma_f32_32x32x16_bf16 v[144:159], a[208:211], a[84:87], v[144:159]
  ds_read_b64_tr_b16 a[236:237], v163 offset:24576
  ds_read_b64_tr_b16 a[238:239], v163 offset:26624
  v_mfma_f32_32x32x16_bf16 v[80:95], a[212:215], a[80:83], v[80:95]
  ds_read_b64_tr_b16 a[240:241], v160 offset:24832
  ds_read_b64_tr_b16 a[242:243], v160 offset:26880
  s_waitcnt lgkmcnt(12)
  v_mfma_f32_32x32x16_bf16 v[96:111], a[216:219], a[80:83], v[96:111]
  v_mfma_f32_32x32x16_bf16 v[112:127], a[220:223], a[80:83], v[112:127]
  ds_read_b64_tr_b16 a[244:245], v161 offset:24832
  ds_read_b64_tr_b16 a[246:247], v161 offset:26880
  s_waitcnt lgkmcnt(10)
  v_mfma_f32_32x32x16_bf16 v[0:15], a[224:227], a[88:91], v[0:15]
  ds_read_b64_tr_b16 a[248:249], v162 offset:24832
  ds_read_b64_tr_b16 a[250:251], v162 offset:26880
  v_mfma_f32_32x32x16_bf16 v[128:143], a[224:227], a[92:95], v[128:143]
  ds_read_b64_tr_b16 a[252:253], v163 offset:24832
  ds_read_b64_tr_b16 a[254:255], v163 offset:26880
  s_waitcnt lgkmcnt(10)
  v_mfma_f32_32x32x16_bf16 v[16:31], a[228:231], a[88:91], v[16:31]
  v_mfma_f32_32x32x16_bf16 v[32:47], a[232:235], a[88:91], v[32:47]
  s_waitcnt vmcnt(32)
  s_waitcnt lgkmcnt(0)
  s_barrier
  ds_read_b128 a[96:99], v164 offset:20480
  ds_read_b64_tr_b16 a[192:193], v160 offset:32768
  ds_read_b64_tr_b16 a[194:195], v160 offset:34816
  ds_read_b128 a[100:103], v166 offset:20480
  v_mfma_f32_32x32x16_bf16 v[48:63], a[236:239], a[88:91], v[48:63]
  ds_read_b64_tr_b16 a[196:197], v161 offset:32768
  ds_read_b64_tr_b16 a[198:199], v161 offset:34816
  s_add_u32 s66, s67, 13
  s_cmp_ge_u32 s66, 14
  s_cselect_b32 s31, 14, 0
  v_mfma_f32_32x32x16_bf16 v[64:79], a[240:243], a[88:91], v[64:79]
  ds_read_b64_tr_b16 a[200:201], v162 offset:32768
  ds_read_b64_tr_b16 a[202:203], v162 offset:34816
  s_sub_u32 s66, s66, s31
  v_mfma_f32_32x32x16_bf16 v[144:159], a[240:243], a[92:95], v[144:159]
  ds_read_b64_tr_b16 a[204:205], v163 offset:32768
  ds_read_b64_tr_b16 a[206:207], v163 offset:34816
  s_lshl_b32 s66, s66, 18
  s_add_u32 s66, s66, s65
  v_mfma_f32_32x32x16_bf16 v[80:95], a[244:247], a[88:91], v[80:95]
  ds_read_b64_tr_b16 a[208:209], v160 offset:33024
  ds_read_b64_tr_b16 a[210:211], v160 offset:35072
  s_add_u32 m0, s64, 0x4000
  s_add_u32 s75, s66, 0
  v_mfma_f32_32x32x16_bf16 v[96:111], a[248:251], a[88:91], v[96:111]
  buffer_load_dwordx4 v168, s[16:19], s75 offen lds
  s_add_u32 s74, s66, 0x3c00
  buffer_load_dwordx4 v169, s[16:19], s74 offen offset:1024 lds
  v_mfma_f32_32x32x16_bf16 v[112:127], a[252:255], a[88:91], v[112:127]
  ds_read_b64_tr_b16 a[212:213], v161 offset:33024
  ds_read_b64_tr_b16 a[214:215], v161 offset:35072
  s_add_u32 s75, s66, 0x7800
  buffer_load_dwordx4 v168, s[16:19], s75 offen offset:2048 lds
  s_waitcnt lgkmcnt(10)
  v_mfma_f32_32x32x16_bf16 v[0:15], a[192:195], a[96:99], v[0:15]
  ds_read_b64_tr_b16 a[216:217], v162 offset:33024
  ds_read_b64_tr_b16 a[218:219], v162 offset:35072
  s_add_u32 s74, s66, 0xb400
  v_mfma_f32_32x32x16_bf16 v[128:143], a[192:195], a[100:103], v[128:143]
  ds_read_b64_tr_b16 a[220:221], v163 offset:33024
  ds_read_b64_tr_b16 a[222:223], v163 offset:35072
  buffer_load_dwordx4 v169, s[16:19], s74 offen offset:3072 lds
  s_add_u32 m0, s64, 0x5000
  s_waitcnt lgkmcnt(10)
  v_mfma_f32_32x32x16_bf16 v[16:31], a[196:199], a[96:99], v[16:31]
  ds_read_b128 a[104:107], v165 offset:20480
  ds_read_b64_tr_b16 a[224:225], v160 offset:40960
  ds_read_b64_tr_b16 a[226:227], v160 offset:43008
  s_add_u32 s75, s66, 0x10000
  buffer_load_dwordx4 v168, s[16:19], s75 offen lds
  v_mfma_f32_32x32x16_bf16 v[32:47], a[200:203], a[96:99], v[32:47]
  ds_read_b128 a[108:111], v167 offset:20480
  s_add_u32 s74, s66, 0x13c00
  buffer_load_dwordx4 v169, s[16:19], s74 offen offset:1024 lds
  s_waitcnt lgkmcnt(10)
  v_mfma_f32_32x32x16_bf16 v[48:63], a[204:207], a[96:99], v[48:63]
  ds_read_b64_tr_b16 a[228:229], v161 offset:40960
  ds_read_b64_tr_b16 a[230:231], v161 offset:43008
  s_add_u32 s75, s66, 0x17800
  buffer_load_dwordx4 v168, s[16:19], s75 offen offset:2048 lds
  v_mfma_f32_32x32x16_bf16 v[64:79], a[208:211], a[96:99], v[64:79]
  ds_read_b64_tr_b16 a[232:233], v162 offset:40960
  ds_read_b64_tr_b16 a[234:235], v162 offset:43008
  s_add_u32 s74, s66, 0x1b400
  buffer_load_dwordx4 v169, s[16:19], s74 offen offset:3072 lds
  s_waitcnt lgkmcnt(12)
  v_mfma_f32_32x32x16_bf16 v[144:159], a[208:211], a[100:103], v[144:159]
  ds_read_b64_tr_b16 a[236:237], v163 offset:40960
  ds_read_b64_tr_b16 a[238:239], v163 offset:43008
  v_mfma_f32_32x32x16_bf16 v[80:95], a[212:215], a[96:99], v[80:95]
  ds_read_b64_tr_b16 a[240:241], v160 offset:41216
  ds_read_b64_tr_b16 a[242:243], v160 offset:43264
  s_waitcnt lgkmcnt(12)
  v_mfma_f32_32x32x16_bf16 v[96:111], a[216:219], a[96:99], v[96:111]
  v_mfma_f32_32x32x16_bf16 v[112:127], a[220:223], a[96:99], v[112:127]
  ds_read_b64_tr_b16 a[244:245], v161 offset:41216
  ds_read_b64_tr_b16 a[246:247], v161 offset:43264
  s_waitcnt lgkmcnt(10)
  v_mfma_f32_32x32x16_bf16 v[0:15], a[224:227], a[104:107], v[0:15]
  ds_read_b64_tr_b16 a[248:249], v162 offset:41216
  ds_read_b64_tr_b16 a[250:251], v162 offset:43264
  v_mfma_f32_32x32x16_bf16 v[128:143], a[224:227], a[108:111], v[128:143]
  ds_read_b64_tr_b16 a[252:253], v163 offset:41216
  ds_read_b64_tr_b16 a[254:255], v163 offset:43264
  s_waitcnt lgkmcnt(10)
  v_mfma_f32_32x32x16_bf16 v[16:31], a[228:231], a[104:107], v[16:31]
  v_mfma_f32_32x32x16_bf16 v[32:47], a[232:235], a[104:107], v[32:47]
  s_waitcnt vmcnt(32)
  s_waitcnt lgkmcnt(0)
  s_barrier
  ds_read_b128 a[64:67], v164 offset:30720
  ds_read_b64_tr_b16 a[192:193], v160 offset:49152
  ds_read_b64_tr_b16 a[194:195], v160 offset:51200
  ds_read_b128 a[68:71], v166 offset:30720
  v_mfma_f32_32x32x16_bf16 v[48:63], a[236:239], a[104:107], v[48:63]
  ds_read_b64_tr_b16 a[196:197], v161 offset:49152
  ds_read_b64_tr_b16 a[198:199], v161 offset:51200
  s_add_u32 m0, s33, 0x8000
  v_mfma_f32_32x32x16_bf16 v[64:79], a[240:243], a[104:107], v[64:79]
  ds_read_b64_tr_b16 a[200:201], v162 offset:49152
  ds_read_b64_tr_b16 a[202:203], v162 offset:51200
  s_add_u32 s75, s33, 0
  v_mfma_f32_32x32x16_bf16 v[144:159], a[240:243], a[108:111], v[144:159]
  ds_read_b64_tr_b16 a[204:205], v163 offset:49152
  ds_read_b64_tr_b16 a[206:207], v163 offset:51200
  buffer_load_dwordx4 v240, s[4:7], s75 offen nt lds
  v_mfma_f32_32x32x16_bf16 v[80:95], a[244:247], a[104:107], v[80:95]
  ds_read_b64_tr_b16 a[208:209], v160 offset:49408
  ds_read_b64_tr_b16 a[210:211], v160 offset:51456
  buffer_load_dwordx4 v241, s[4:7], s75 offen offset:1024 nt lds
  v_mfma_f32_32x32x16_bf16 v[96:111], a[248:251], a[104:107], v[96:111]
  buffer_load_dwordx4 v242, s[4:7], s75 offen offset:2048 nt lds
  buffer_load_dwordx4 v243, s[4:7], s75 offen offset:3072 nt lds
  v_mfma_f32_32x32x16_bf16 v[112:127], a[252:255], a[104:107], v[112:127]
  ds_read_b64_tr_b16 a[212:213], v161 offset:49408
  ds_read_b64_tr_b16 a[214:215], v161 offset:51456
  s_waitcnt lgkmcnt(10)
  v_mfma_f32_32x32x16_bf16 v[0:15], a[192:195], a[64:67], v[0:15]
  ds_read_b64_tr_b16 a[216:217], v162 offset:49408
  ds_read_b64_tr_b16 a[218:219], v162 offset:51456
  v_mfma_f32_32x32x16_bf16 v[128:143], a[192:195], a[68:71], v[128:143]
  ds_read_b64_tr_b16 a[220:221], v163 offset:49408
  ds_read_b64_tr_b16 a[222:223], v163 offset:51456
  s_waitcnt lgkmcnt(10)
  v_mfma_f32_32x32x16_bf16 v[16:31], a[196:199], a[64:67], v[16:31]
  ds_read_b128 a[72:75], v165 offset:30720
  ds_read_b64_tr_b16 a[224:225], v160 offset:57344
  ds_read_b64_tr_b16 a[226:227], v160 offset:59392
  v_mfma_f32_32x32x16_bf16 v[32:47], a[200:203], a[64:67], v[32:47]
  ds_read_b128 a[76:79], v167 offset:30720
  s_waitcnt lgkmcnt(10)
  v_mfma_f32_32x32x16_bf16 v[48:63], a[204:207], a[64:67], v[48:63]
  ds_read_b64_tr_b16 a[228:229], v161 offset:57344
  ds_read_b64_tr_b16 a[230:231], v161 offset:59392
  v_mfma_f32_32x32x16_bf16 v[64:79], a[208:211], a[64:67], v[64:79]
  ds_read_b64_tr_b16 a[232:233], v162 offset:57344
  ds_read_b64_tr_b16 a[234:235], v162 offset:59392
  s_waitcnt lgkmcnt(12)
  v_mfma_f32_32x32x16_bf16 v[144:159], a[208:211], a[68:71], v[144:159]
  ds_read_b64_tr_b16 a[236:237], v163 offset:57344
  ds_read_b64_tr_b16 a[238:239], v163 offset:59392
  v_mfma_f32_32x32x16_bf16 v[80:95], a[212:215], a[64:67], v[80:95]
  ds_read_b64_tr_b16 a[240:241], v160 offset:57600
  ds_read_b64_tr_b16 a[242:243], v160 offset:59648
  s_waitcnt lgkmcnt(12)
  v_mfma_f32_32x32x16_bf16 v[96:111], a[216:219], a[64:67], v[96:111]
  v_mfma_f32_32x32x16_bf16 v[112:127], a[220:223], a[64:67], v[112:127]
  ds_read_b64_tr_b16 a[244:245], v161 offset:57600
  ds_read_b64_tr_b16 a[246:247], v161 offset:59648
  s_waitcnt lgkmcnt(10)
  v_mfma_f32_32x32x16_bf16 v[0:15], a[224:227], a[72:75], v[0:15]
  ds_read_b64_tr_b16 a[248:249], v162 offset:57600
  ds_read_b64_tr_b16 a[250:251], v162 offset:59648
  v_mfma_f32_32x32x16_bf16 v[128:143], a[224:227], a[76:79], v[128:143]
  ds_read_b64_tr_b16 a[252:253], v163 offset:57600
  ds_read_b64_tr_b16 a[254:255], v163 offset:59648
  s_waitcnt lgkmcnt(10)
  v_mfma_f32_32x32x16_bf16 v[16:31], a[228:231], a[72:75], v[16:31]
  v_mfma_f32_32x32x16_bf16 v[32:47], a[232:235], a[72:75], v[32:47]
  s_waitcnt vmcnt(28)
  s_waitcnt lgkmcnt(0)
  s_barrier
  ds_read_b128 a[80:83], v164 offset:40960
  ds_read_b64_tr_b16 a[192:193], v180
  ds_read_b64_tr_b16 a[194:195], v180 offset:2048
  ds_read_b128 a[84:87], v166 offset:40960
  v_mfma_f32_32x32x16_bf16 v[48:63], a[236:239], a[72:75], v[48:63]
  ds_read_b64_tr_b16 a[196:197], v181
  ds_read_b64_tr_b16 a[198:199], v181 offset:2048
  s_add_u32 m0, s33, 0xc000
  v_mfma_f32_32x32x16_bf16 v[64:79], a[240:243], a[72:75], v[64:79]
  ds_read_b64_tr_b16 a[200:201], v182
  ds_read_b64_tr_b16 a[202:203], v182 offset:2048
  s_add_u32 s74, s33, 0x4000
  v_mfma_f32_32x32x16_bf16 v[144:159], a[240:243], a[76:79], v[144:159]
  ds_read_b64_tr_b16 a[204:205], v183
  ds_read_b64_tr_b16 a[206:207], v183 offset:2048
  buffer_load_dwordx4 v240, s[4:7], s74 offen nt lds
  v_mfma_f32_32x32x16_bf16 v[80:95], a[244:247], a[72:75], v[80:95]
  ds_read_b64_tr_b16 a[208:209], v180 offset:256
  ds_read_b64_tr_b16 a[210:211], v180 offset:2304
  buffer_load_dwordx4 v241, s[4:7], s74 offen offset:1024 nt lds
  v_mfma_f32_32x32x16_bf16 v[96:111], a[248:251], a[72:75], v[96:111]
  buffer_load_dwordx4 v242, s[4:7], s74 offen offset:2048 nt lds
  buffer_load_dwordx4 v243, s[4:7], s74 offen offset:3072 nt lds
  v_mfma_f32_32x32x16_bf16 v[112:127], a[252:255], a[72:75], v[112:127]
  ds_read_b64_tr_b16 a[212:213], v181 offset:256
  ds_read_b64_tr_b16 a[214:215], v181 offset:2304
  s_waitcnt lgkmcnt(10)
  v_mfma_f32_32x32x16_bf16 v[0:15], a[192:195], a[80:83], v[0:15]
  ds_read_b64_tr_b16 a[216:217], v182 offset:256
  ds_read_b64_tr_b16 a[218:219], v182 offset:2304
  v_mfma_f32_32x32x16_bf16 v[128:143], a[192:195], a[84:87], v[128:143]
  ds_read_b64_tr_b16 a[220:221], v183 offset:256
  ds_read_b64_tr_b16 a[222:223], v183 offset:2304
  s_waitcnt lgkmcnt(10)
  v_mfma_f32_32x32x16_bf16 v[16:31], a[196:199], a[80:83], v[16:31]
  ds_read_b128 a[88:91], v165 offset:40960
  ds_read_b64_tr_b16 a[224:225], v180 offset:8192
  ds_read_b64_tr_b16 a[226:227], v180 offset:10240
  v_mfma_f32_32x32x16_bf16 v[32:47], a[200:203], a[80:83], v[32:47]
  ds_read_b128 a[92:95], v167 offset:40960
  s_waitcnt lgkmcnt(10)
  v_mfma_f32_32x32x16_bf16 v[48:63], a[204:207], a[80:83], v[48:63]
  ds_read_b64_tr_b16 a[228:229], v181 offset:8192
  ds_read_b64_tr_b16 a[230:231], v181 offset:10240
  v_mfma_f32_32x32x16_bf16 v[64:79], a[208:211], a[80:83], v[64:79]
  ds_read_b64_tr_b16 a[232:233], v182 offset:8192
  ds_read_b64_tr_b16 a[234:235], v182 offset:10240
  s_waitcnt lgkmcnt(12)
  v_mfma_f32_32x32x16_bf16 v[144:159], a[208:211], a[84:87], v[144:159]
  ds_read_b64_tr_b16 a[236:237], v183 offset:8192
  ds_read_b64_tr_b16 a[238:239], v183 offset:10240
  v_mfma_f32_32x32x16_bf16 v[80:95], a[212:215], a[80:83], v[80:95]
  ds_read_b64_tr_b16 a[240:241], v180 offset:8448
  ds_read_b64_tr_b16 a[242:243], v180 offset:10496
  s_waitcnt lgkmcnt(12)
  v_mfma_f32_32x32x16_bf16 v[96:111], a[216:219], a[80:83], v[96:111]
  v_mfma_f32_32x32x16_bf16 v[112:127], a[220:223], a[80:83], v[112:127]
  ds_read_b64_tr_b16 a[244:245], v181 offset:8448
  ds_read_b64_tr_b16 a[246:247], v181 offset:10496
  s_waitcnt lgkmcnt(10)
  v_mfma_f32_32x32x16_bf16 v[0:15], a[224:227], a[88:91], v[0:15]
  ds_read_b64_tr_b16 a[248:249], v182 offset:8448
  ds_read_b64_tr_b16 a[250:251], v182 offset:10496
  v_mfma_f32_32x32x16_bf16 v[128:143], a[224:227], a[92:95], v[128:143]
  ds_read_b64_tr_b16 a[252:253], v183 offset:8448
  ds_read_b64_tr_b16 a[254:255], v183 offset:10496
  s_waitcnt lgkmcnt(10)
  v_mfma_f32_32x32x16_bf16 v[16:31], a[228:231], a[88:91], v[16:31]
  v_mfma_f32_32x32x16_bf16 v[32:47], a[232:235], a[88:91], v[32:47]
  s_waitcnt vmcnt(24)
  s_waitcnt lgkmcnt(0)
  s_barrier
  ds_read_b128 a[96:99], v164 offset:51200
  ds_read_b64_tr_b16 a[192:193], v180 offset:16384
  ds_read_b64_tr_b16 a[194:195], v180 offset:18432
  ds_read_b128 a[100:103], v166 offset:51200
  v_mfma_f32_32x32x16_bf16 v[48:63], a[236:239], a[88:91], v[48:63]
  ds_read_b64_tr_b16 a[196:197], v181 offset:16384
  ds_read_b64_tr_b16 a[198:199], v181 offset:18432
  s_add_u32 m0, s33, 0x10000
  v_mfma_f32_32x32x16_bf16 v[64:79], a[240:243], a[88:91], v[64:79]
  ds_read_b64_tr_b16 a[200:201], v182 offset:16384
  ds_read_b64_tr_b16 a[202:203], v182 offset:18432
  s_add_u32 s75, s33, 0x8000
  v_mfma_f32_32x32x16_bf16 v[144:159], a[240:243], a[92:95], v[144:159]
  ds_read_b64_tr_b16 a[204:205], v183 offset:16384
  ds_read_b64_tr_b16 a[206:207], v183 offset:18432
  buffer_load_dwordx4 v240, s[4:7], s75 offen nt lds
  v_mfma_f32_32x32x16_bf16 v[80:95], a[244:247], a[88:91], v[80:95]
  ds_read_b64_tr_b16 a[208:209], v180 offset:16640
  ds_read_b64_tr_b16 a[210:211], v180 offset:18688
  buffer_load_dwordx4 v241, s[4:7], s75 offen offset:1024 nt lds
  v_mfma_f32_32x32x16_bf16 v[96:111], a[248:251], a[88:91], v[96:111]
  buffer_load_dwordx4 v242, s[4:7], s75 offen offset:2048 nt lds
  buffer_load_dwordx4 v243, s[4:7], s75 offen offset:3072 nt lds
  v_mfma_f32_32x32x16_bf16 v[112:127], a[252:255], a[88:91], v[112:127]
  ds_read_b64_tr_b16 a[212:213], v181 offset:16640
  ds_read_b64_tr_b16 a[214:215], v181 offset:18688
  s_waitcnt lgkmcnt(10)
  v_mfma_f32_32x32x16_bf16 v[0:15], a[192:195], a[96:99], v[0:15]
  ds_read_b64_tr_b16 a[216:217], v182 offset:16640
  ds_read_b64_tr_b16 a[218:219], v182 offset:18688
  v_mfma_f32_32x32x16_bf16 v[128:143], a[192:195], a[100:103], v[128:143]
  ds_read_b64_tr_b16 a[220:221], v183 offset:16640
  ds_read_b64_tr_b16 a[222:223], v183 offset:18688
  s_waitcnt lgkmcnt(10)
  v_mfma_f32_32x32x16_bf16 v[16:31], a[196:199], a[96:99], v[16:31]
  ds_read_b128 a[104:107], v165 offset:51200
  ds_read_b64_tr_b16 a[224:225], v180 offset:24576
  ds_read_b64_tr_b16 a[226:227], v180 offset:26624
  v_mfma_f32_32x32x16_bf16 v[32:47], a[200:203], a[96:99], v[32:47]
  ds_read_b128 a[108:111], v167 offset:51200
  s_waitcnt lgkmcnt(10)
  v_mfma_f32_32x32x16_bf16 v[48:63], a[204:207], a[96:99], v[48:63]
  ds_read_b64_tr_b16 a[228:229], v181 offset:24576
  ds_read_b64_tr_b16 a[230:231], v181 offset:26624
  v_mfma_f32_32x32x16_bf16 v[64:79], a[208:211], a[96:99], v[64:79]
  ds_read_b64_tr_b16 a[232:233], v182 offset:24576
  ds_read_b64_tr_b16 a[234:235], v182 offset:26624
  s_waitcnt lgkmcnt(12)
  v_mfma_f32_32x32x16_bf16 v[144:159], a[208:211], a[100:103], v[144:159]
  ds_read_b64_tr_b16 a[236:237], v183 offset:24576
  ds_read_b64_tr_b16 a[238:239], v183 offset:26624
  v_mfma_f32_32x32x16_bf16 v[80:95], a[212:215], a[96:99], v[80:95]
  ds_read_b64_tr_b16 a[240:241], v180 offset:24832
  ds_read_b64_tr_b16 a[242:243], v180 offset:26880
  s_waitcnt lgkmcnt(12)
  v_mfma_f32_32x32x16_bf16 v[96:111], a[216:219], a[96:99], v[96:111]
  v_mfma_f32_32x32x16_bf16 v[112:127], a[220:223], a[96:99], v[112:127]
  ds_read_b64_tr_b16 a[244:245], v181 offset:24832
  ds_read_b64_tr_b16 a[246:247], v181 offset:26880
  s_waitcnt lgkmcnt(10)
  v_mfma_f32_32x32x16_bf16 v[0:15], a[224:227], a[104:107], v[0:15]
  ds_read_b64_tr_b16 a[248:249], v182 offset:24832
  ds_read_b64_tr_b16 a[250:251], v182 offset:26880
  v_mfma_f32_32x32x16_bf16 v[128:143], a[224:227], a[108:111], v[128:143]
  ds_read_b64_tr_b16 a[252:253], v183 offset:24832
  ds_read_b64_tr_b16 a[254:255], v183 offset:26880
  s_waitcnt lgkmcnt(10)
  v_mfma_f32_32x32x16_bf16 v[16:31], a[228:231], a[104:107], v[16:31]
  v_mfma_f32_32x32x16_bf16 v[32:47], a[232:235], a[104:107], v[32:47]
  s_waitcnt vmcnt(20)
  s_waitcnt vmcnt(12)
  s_waitcnt lgkmcnt(0)
  s_branch concat_heads__mha_block_cached__mha_block_cached__near_ridge_kernel_common
concat_heads__mha_block_cached__mha_block_cached__near_ridge_kernel_roleb:
  v_lshrrev_b32 v186, 2, v255
  v_mul_u32_u24 v186, 0x380, v186
  v_xor_b32 v187, v203, v200
  v_lshl_add_u32 v170, v187, 4, v186
  s_and_b32 s29, s3, 1
  s_mul_i32 s66, s29, 0x1400
  s_add_u32 s66, s66, 0x18000
  s_mul_i32 s67, s29, 0x11800
  s_lshl_b32 s64, s27, 1
  s_add_u32 s64, s64, s26
  s_cmp_ge_u32 s64, 7
  s_cselect_b32 s31, 7, 0
  s_sub_u32 s64, s64, s31
  s_lshl_b32 s64, s64, 1
  s_waitcnt lgkmcnt(0)
  s_cmp_eq_u32 s24, 0
  s_cselect_b64 s[12:13], s[36:37], s[46:47]
  s_cselect_b64 s[16:17], s[42:43], s[52:53]
  s_mul_i32 s30, s26, 0x23000
  s_add_u32 s12, s12, s30
  s_addc_u32 s13, s13, 0
  s_lshl_b32 s31, s28, 9
  s_add_u32 s16, s16, s31
  s_addc_u32 s17, s17, 0
  s_and_b32 s13, s13, 0xffff
  s_mov_b32 s15, 0x20000
  s_and_b32 s17, s17, 0xffff
  s_mov_b32 s19, 0x20000
  s_mov_b32 s14, 0x23000
  s_sub_u32 s18, 0x380000, s31
  s_add_u32 s65, s64, 0
  s_cmp_ge_u32 s65, 14
  s_cselect_b32 s31, 14, 0
  s_sub_u32 s65, s65, s31
  s_lshl_b32 s65, s65, 6
  s_add_u32 s65, s65, s67
  s_add_u32 m0, s66, 0
  s_mov_b32 s75, s65
  buffer_load_dwordx4 v170, s[12:15], s75 offen lds
  s_add_u32 s74, s65, 0x3400
  buffer_load_dwordx4 v170, s[12:15], s74 offen offset:1024 lds
  s_add_u32 s75, s65, 0x6800
  buffer_load_dwordx4 v170, s[12:15], s75 offen offset:2048 lds
  s_add_u32 s74, s65, 0x9c00
  buffer_load_dwordx4 v170, s[12:15], s74 offen offset:3072 lds
  s_add_u32 m0, s66, 0x1000
  s_add_u32 s75, s65, 0xe000
  buffer_load_dwordx4 v170, s[12:15], s75 offen lds
  s_cmp_eq_u32 s24, 0
  s_cselect_b64 s[4:5], s[38:39], s[48:49]
  s_cselect_b64 s[8:9], s[40:41], s[50:51]
  s_lshl_b32 s29, s26, 4
  s_add_u32 s29, s29, s28
  s_lshl_b32 s30, s29, 18
  s_add_u32 s4, s4, s30
  s_addc_u32 s5, s5, 0
  s_add_u32 s8, s8, s30
  s_addc_u32 s9, s9, 0
  s_and_b32 s5, s5, 0xffff
  s_mov_b32 s7, 0x20000
  s_and_b32 s9, s9, 0xffff
  s_mov_b32 s11, 0x20000
  s_mov_b32 s6, 0x40000
  s_mov_b32 s10, 0x40000
  s_mov_b32 s20, s60
  s_and_b32 s21, s61, 0xffff
  s_mov_b32 s22, 0x1400000
  s_mov_b32 s23, 0x20000
  s_lshl_b32 s30, s24, 7
  s_add_u32 s30, s30, s29
  s_mul_i32 s34, s30, 0x14000
  s_cmp_eq_u32 s24, 0
  s_cselect_b64 s[52:53], s[44:45], s[54:55]
  s_mov_b64 s[54:55], s[56:57]
  s_mov_b32 s96, s58
  s_and_b32 s97, s59, 0xffff
  s_mov_b32 s98, 0x100
  s_mov_b32 s99, 0x20000
  s_add_u32 s56, s60, 0x3c00000
  s_addc_u32 s57, s61, 0
  s_and_b32 s57, s57, 0xffff
  s_mov_b32 s58, 0x8000
  s_mov_b32 s59, 0x20000
  s_lshl_b32 s33, s3, 12
  s_lshl_b32 s72, s3, 14
  s_mov_b32 s62, 0x44800000
  s_mov_b32 s73, 0x3db8aa3b
  s_mov_b32 s35, 0
  s_mov_b32 s63, 0
  s_lshl_b32 s29, s3, 11
  s_add_u32 s78, s34, s29
  s_lshr_b32 s29, s3, 1
  s_mul_i32 s29, s29, 0x2800
  s_add_u32 s29, s29, 0x2000
  s_add_u32 s79, s34, s29
  v_mov_b32 v250, 0xff800000
  v_mov_b32 v251, 0xff800000
  s_lshl_b32 s29, s24, 3
  s_add_u32 s29, s29, s26
  s_lshl_b32 s29, s29, 2
  s_add_u32 s29, s29, s25
  s_lshl_b32 s29, s29, 2
  s_add_u32 s29, s29, s27
  s_lshl_b32 s29, s29, 7
  v_lshlrev_b32 v186, 2, v255
  v_add_u32 v186, s29, v186
  v_mov_b32 v187, 0x7ffffff0
  v_cmp_gt_u32 vcc, 32, v255
  s_nop 1
  v_cndmask_b32 v186, v187, v186, vcc
  v_mov_b32 v188, 0
  buffer_store_dword v188, v186, s[56:59], 0 offen sc1
  v_cmp_eq_u32 vcc, 0, v255
  v_mov_b32 v188, 0
  s_nop 0
  v_cndmask_b32 v206, v187, v188, vcc
  s_cmp_eq_u32 s3, 3
  s_cselect_b32 s29, 0, 0x7ffffff0
  v_max_u32 v206, s29, v206
  v_mov_b32 v207, 1
  v_lshlrev_b32 v186, 3, v199
  v_add_u32 v186, v186, v202
  v_lshlrev_b32 v186, 9, v186
  v_and_b32 v187, 1, v203
  v_lshl_add_u32 v187, v204, 1, v187
  v_lshrrev_b32 v188, 1, v203
  v_lshlrev_b32 v188, 3, v188
  v_add_u32 v186, v186, v188
  v_add_u32 v186, 0, v186
  v_xor_b32 v189, s3, v202
  v_xor_b32 v190, 0, v189
  v_lshl_add_u32 v190, v190, 2, v187
  v_lshl_add_u32 v160, v190, 4, v186
  v_add_u32 v180, 0x10000, v160
  v_xor_b32 v190, 1, v189
  v_lshl_add_u32 v190, v190, 2, v187
  v_lshl_add_u32 v161, v190, 4, v186
  v_add_u32 v181, 0x10000, v161
  v_xor_b32 v190, 2, v189
  v_lshl_add_u32 v190, v190, 2, v187
  v_lshl_add_u32 v162, v190, 4, v186
  v_add_u32 v182, 0x10000, v162
  v_xor_b32 v190, 3, v189
  v_lshl_add_u32 v190, v190, 2, v187
  v_lshl_add_u32 v163, v190, 4, v186
  v_add_u32 v183, 0x10000, v163
  v_lshrrev_b32 v186, 2, v198
  v_and_b32 v186, 3, v186
  v_lshlrev_b32 v187, 6, v198
  s_lshl_b32 s29, s3, 11
  s_add_u32 s29, s29, 0x18000
  v_add_u32 v188, 0, v199
  v_xor_b32 v188, v188, v186
  v_lshl_add_u32 v188, v188, 4, v187
  v_add_u32 v164, s29, v188
  v_add_u32 v166, 0x1a000, v188
  v_add_u32 v188, 2, v199
  v_xor_b32 v188, v188, v186
  v_lshl_add_u32 v188, v188, 4, v187
  v_add_u32 v165, s29, v188
  v_add_u32 v167, 0x1a000, v188
  s_and_b32 s29, s3, 1
  s_lshl_b32 s29, s29, 3
  v_add_u32 v186, 0, v199
  v_add_u32 v186, s29, v186
  v_xor_b32 v186, v186, v198
  v_lshlrev_b32 v186, 4, v186
  v_lshl_add_u32 v240, v199, 9, v186
  v_add_u32 v186, 2, v199
  v_add_u32 v186, s29, v186
  v_xor_b32 v186, v186, v198
  v_lshlrev_b32 v186, 4, v186
  v_lshl_add_u32 v241, v199, 9, v186
  v_add_u32 v186, 4, v199
  v_add_u32 v186, s29, v186
  v_xor_b32 v186, v186, v198
  v_lshlrev_b32 v186, 4, v186
  v_lshl_add_u32 v242, v199, 9, v186
  v_add_u32 v186, 6, v199
  v_add_u32 v186, s29, v186
  v_xor_b32 v186, v186, v198
  v_lshlrev_b32 v186, 4, v186
  v_lshl_add_u32 v243, v199, 9, v186
  v_lshrrev_b32 v186, 3, v255
  v_lshlrev_b32 v186, 9, v186
  v_and_b32 v187, 7, v255
  v_lshlrev_b32 v188, 2, v204
  v_xor_b32 v187, v187, v188
  v_lshlrev_b32 v188, 1, v199
  v_xor_b32 v187, v187, v188
  v_lshl_add_u32 v252, v187, 4, v186
  v_and_b32 v186, 15, v198
  v_lshlrev_b32 v187, 9, v198
  s_xor_b32 s29, s3, 0
  s_lshl_b32 s29, s29, 2
  v_add_u32 v188, 0, v199
  v_add_u32 v188, s29, v188
  v_xor_b32 v188, v188, v186
  v_lshl_add_u32 v232, v188, 4, v187
  v_add_u32 v188, 2, v199
  v_add_u32 v188, s29, v188
  v_xor_b32 v188, v188, v186
  v_lshl_add_u32 v233, v188, 4, v187
  s_xor_b32 s29, s3, 1
  s_lshl_b32 s29, s29, 2
  v_add_u32 v188, 0, v199
  v_add_u32 v188, s29, v188
  v_xor_b32 v188, v188, v186
  v_lshl_add_u32 v234, v188, 4, v187
  v_add_u32 v188, 2, v199
  v_add_u32 v188, s29, v188
  v_xor_b32 v188, v188, v186
  v_lshl_add_u32 v235, v188, 4, v187
  s_xor_b32 s29, s3, 2
  s_lshl_b32 s29, s29, 2
  v_add_u32 v188, 0, v199
  v_add_u32 v188, s29, v188
  v_xor_b32 v188, v188, v186
  v_lshl_add_u32 v236, v188, 4, v187
  v_add_u32 v188, 2, v199
  v_add_u32 v188, s29, v188
  v_xor_b32 v188, v188, v186
  v_lshl_add_u32 v237, v188, 4, v187
  s_xor_b32 s29, s3, 3
  s_lshl_b32 s29, s29, 2
  v_add_u32 v188, 0, v199
  v_add_u32 v188, s29, v188
  v_xor_b32 v188, v188, v186
  v_lshl_add_u32 v238, v188, 4, v187
  v_add_u32 v188, 2, v199
  v_add_u32 v188, s29, v188
  v_xor_b32 v188, v188, v186
  v_lshl_add_u32 v239, v188, 4, v187
  v_lshlrev_b32 v186, 4, v255
  s_lshl_b32 s29, s3, 11
  s_add_u32 s29, s29, 0x20000
  v_add_u32 v194, s29, v186
  s_xor_b32 s29, s3, 0
  s_lshl_b32 s29, s29, 11
  s_add_u32 s29, s29, 0x20000
  v_add_u32 v195, s29, v186
  s_xor_b32 s29, s3, 1
  s_lshl_b32 s29, s29, 11
  s_add_u32 s29, s29, 0x20000
  v_add_u32 v196, s29, v186
  s_xor_b32 s29, s3, 2
  s_lshl_b32 s29, s29, 11
  s_add_u32 s29, s29, 0x20000
  v_add_u32 v197, s29, v186
  s_xor_b32 s29, s3, 3
  s_lshl_b32 s29, s29, 11
  s_add_u32 s29, s29, 0x20000
  v_add_u32 v205, s29, v186
  s_add_u32 s65, s64, 1
  s_cmp_ge_u32 s65, 14
  s_cselect_b32 s31, 14, 0
  s_sub_u32 s65, s65, s31
  s_lshl_b32 s65, s65, 6
  s_add_u32 s65, s65, s67
  s_add_u32 m0, s66, 0x2800
  s_mov_b32 s74, s65
  buffer_load_dwordx4 v170, s[12:15], s74 offen lds
  s_add_u32 s75, s65, 0x3400
  buffer_load_dwordx4 v170, s[12:15], s75 offen offset:1024 lds
  s_add_u32 s74, s65, 0x6800
  buffer_load_dwordx4 v170, s[12:15], s74 offen offset:2048 lds
  s_add_u32 s75, s65, 0x9c00
  buffer_load_dwordx4 v170, s[12:15], s75 offen offset:3072 lds
  s_add_u32 m0, s66, 0x3800
  s_add_u32 s74, s65, 0xe000
  buffer_load_dwordx4 v170, s[12:15], s74 offen lds
  s_add_u32 s65, s64, 2
  s_cmp_ge_u32 s65, 14
  s_cselect_b32 s31, 14, 0
  s_sub_u32 s65, s65, s31
  s_lshl_b32 s65, s65, 6
  s_add_u32 s65, s65, s67
  s_add_u32 m0, s66, 0x5000
  s_mov_b32 s75, s65
  buffer_load_dwordx4 v170, s[12:15], s75 offen lds
  s_add_u32 s74, s65, 0x3400
  buffer_load_dwordx4 v170, s[12:15], s74 offen offset:1024 lds
  s_add_u32 s75, s65, 0x6800
  buffer_load_dwordx4 v170, s[12:15], s75 offen offset:2048 lds
  s_add_u32 s74, s65, 0x9c00
  buffer_load_dwordx4 v170, s[12:15], s74 offen offset:3072 lds
  s_add_u32 m0, s66, 0x6000
  s_add_u32 s75, s65, 0xe000
  buffer_load_dwordx4 v170, s[12:15], s75 offen lds
  s_mov_b32 s29, 0x8000
  s_cmp_eq_u32 s3, 1
  s_cselect_b32 s29, 0xc000, s29
  s_cmp_eq_u32 s3, 2
  s_cselect_b32 s29, 0x10000, s29
  s_cmp_eq_u32 s3, 3
  s_cselect_b32 s29, 0x14000, s29
  s_mov_b32 s36, s29
  s_mov_b32 s30, 0xc000
  s_cmp_eq_u32 s3, 1
  s_cselect_b32 s30, 0x8000, s30
  s_cmp_eq_u32 s3, 2
  s_cselect_b32 s30, 0x14000, s30
  s_cmp_eq_u32 s3, 3
  s_cselect_b32 s30, 0x10000, s30
  s_sub_u32 s37, s30, s29
  s_mov_b32 s29, 0x10000
  s_cmp_eq_u32 s3, 1
  s_cselect_b32 s29, 0x14000, s29
  s_cmp_eq_u32 s3, 2
  s_cselect_b32 s29, 0x8000, s29
  s_cmp_eq_u32 s3, 3
  s_cselect_b32 s29, 0xc000, s29
  s_sub_u32 s38, s29, s30
  s_mov_b32 s30, 0x14000
  s_cmp_eq_u32 s3, 1
  s_cselect_b32 s30, 0x10000, s30
  s_cmp_eq_u32 s3, 2
  s_cselect_b32 s30, 0xc000, s30
  s_cmp_eq_u32 s3, 3
  s_cselect_b32 s30, 0x8000, s30
  s_sub_u32 s39, s30, s29
  s_mov_b32 s29, 0x24000
  s_cmp_eq_u32 s3, 1
  s_cselect_b32 s29, 0, s29
  s_cmp_eq_u32 s3, 2
  s_cselect_b32 s29, 0x4000, s29
  s_cmp_eq_u32 s3, 3
  s_cselect_b32 s29, 0x18000, s29
  s_sub_u32 s40, s29, s30
  s_mov_b32 s30, 0
  s_cmp_eq_u32 s3, 1
  s_cselect_b32 s30, 0x24000, s30
  s_cmp_eq_u32 s3, 2
  s_cselect_b32 s30, 0x18000, s30
  s_cmp_eq_u32 s3, 3
  s_cselect_b32 s30, 0x4000, s30
  s_sub_u32 s41, s30, s29
  s_mov_b32 s29, 0x4000
  s_cmp_eq_u32 s3, 1
  s_cselect_b32 s29, 0x18000, s29
  s_cmp_eq_u32 s3, 2
  s_cselect_b32 s29, 0x24000, s29
  s_cmp_eq_u32 s3, 3
  s_cselect_b32 s29, 0, s29
  s_sub_u32 s42, s29, s30
  s_mov_b32 s30, 0x18000
  s_cmp_eq_u32 s3, 1
  s_cselect_b32 s30, 0x4000, s30
  s_cmp_eq_u32 s3, 2
  s_cselect_b32 s30, 0, s30
  s_cmp_eq_u32 s3, 3
  s_cselect_b32 s30, 0x24000, s30
  s_sub_u32 s43, s30, s29
  s_mov_b32 s29, 0x1c000
  s_cmp_eq_u32 s3, 1
  s_cselect_b32 s29, 0x8000, s29
  s_cmp_eq_u32 s3, 2
  s_cselect_b32 s29, 0xc000, s29
  s_cmp_eq_u32 s3, 3
  s_cselect_b32 s29, 0x10000, s29
  s_sub_u32 s44, s29, s30
  s_mov_b32 s30, 0x8000
  s_cmp_eq_u32 s3, 1
  s_cselect_b32 s30, 0x1c000, s30
  s_cmp_eq_u32 s3, 2
  s_cselect_b32 s30, 0x10000, s30
  s_cmp_eq_u32 s3, 3
  s_cselect_b32 s30, 0xc000, s30
  s_sub_u32 s45, s30, s29
  s_mov_b32 s29, 0xc000
  s_cmp_eq_u32 s3, 1
  s_cselect_b32 s29, 0x10000, s29
  s_cmp_eq_u32 s3, 2
  s_cselect_b32 s29, 0x1c000, s29
  s_cmp_eq_u32 s3, 3
  s_cselect_b32 s29, 0x8000, s29
  s_sub_u32 s46, s29, s30
  s_mov_b32 s30, 0x10000
  s_cmp_eq_u32 s3, 1
  s_cselect_b32 s30, 0xc000, s30
  s_cmp_eq_u32 s3, 2
  s_cselect_b32 s30, 0x8000, s30
  s_cmp_eq_u32 s3, 3
  s_cselect_b32 s30, 0x1c000, s30
  s_sub_u32 s47, s30, s29
  s_mov_b32 s29, 0x14000
  s_cmp_eq_u32 s3, 1
  s_cselect_b32 s29, 0x20000, s29
  s_cmp_eq_u32 s3, 2
  s_cselect_b32 s29, 0x24000, s29
  s_cmp_eq_u32 s3, 3
  s_cselect_b32 s29, 0, s29
  s_sub_u32 s48, s29, s30
  s_mov_b32 s30, 0x20000
  s_cmp_eq_u32 s3, 1
  s_cselect_b32 s30, 0x14000, s30
  s_cmp_eq_u32 s3, 2
  s_cselect_b32 s30, 0, s30
  s_cmp_eq_u32 s3, 3
  s_cselect_b32 s30, 0x24000, s30
  s_sub_u32 s49, s30, s29
  s_mov_b32 s29, 0x24000
  s_cmp_eq_u32 s3, 1
  s_cselect_b32 s29, 0, s29
  s_cmp_eq_u32 s3, 2
  s_cselect_b32 s29, 0x14000, s29
  s_cmp_eq_u32 s3, 3
  s_cselect_b32 s29, 0x20000, s29
  s_sub_u32 s50, s29, s30
  s_mov_b32 s30, 0
  s_cmp_eq_u32 s3, 1
  s_cselect_b32 s30, 0x24000, s30
  s_cmp_eq_u32 s3, 2
  s_cselect_b32 s30, 0x20000, s30
  s_cmp_eq_u32 s3, 3
  s_cselect_b32 s30, 0x14000, s30
  s_sub_u32 s51, s30, s29
  s_waitcnt vmcnt(11)
  s_barrier
  ds_read_b128 a[64:67], v164
  ds_read_b64_tr_b16 a[192:193], v160
  ds_read_b64_tr_b16 a[194:195], v160 offset:2048
  ds_read_b128 a[68:71], v166
  ds_read_b64_tr_b16 a[196:197], v161
  ds_read_b64_tr_b16 a[198:199], v161 offset:2048
  ds_read_b64_tr_b16 a[200:201], v162
  ds_read_b64_tr_b16 a[202:203], v162 offset:2048
  ds_read_b64_tr_b16 a[204:205], v163
  ds_read_b64_tr_b16 a[206:207], v163 offset:2048
  ds_read_b64_tr_b16 a[208:209], v160 offset:256
  ds_read_b64_tr_b16 a[210:211], v160 offset:2304
  ds_read_b64_tr_b16 a[212:213], v161 offset:256
  ds_read_b64_tr_b16 a[214:215], v161 offset:2304
  s_waitcnt lgkmcnt(11)
  v_mfma_f32_32x32x16_bf16 v[0:15], a[192:195], a[64:67], 0
  ds_read_b64_tr_b16 a[216:217], v162 offset:256
  ds_read_b64_tr_b16 a[218:219], v162 offset:2304
  s_add_u32 s65, s64, 3
  s_waitcnt lgkmcnt(12)
  v_mfma_f32_32x32x16_bf16 v[128:143], a[192:195], a[68:71], 0
  ds_read_b64_tr_b16 a[220:221], v163 offset:256
  ds_read_b64_tr_b16 a[222:223], v163 offset:2304
  s_cmp_ge_u32 s65, 14
  s_cselect_b32 s31, 14, 0
  s_waitcnt lgkmcnt(12)
  v_mfma_f32_32x32x16_bf16 v[16:31], a[196:199], a[64:67], 0
  ds_read_b128 a[72:75], v165
  ds_read_b64_tr_b16 a[224:225], v160 offset:8192
  ds_read_b64_tr_b16 a[226:227], v160 offset:10240
  s_sub_u32 s65, s65, s31
  s_waitcnt lgkmcnt(13)
  v_mfma_f32_32x32x16_bf16 v[32:47], a[200:203], a[64:67], 0
  ds_read_b128 a[76:79], v167
  s_lshl_b32 s65, s65, 6
  s_add_u32 s65, s65, s67
  s_waitcnt lgkmcnt(12)
  v_mfma_f32_32x32x16_bf16 v[48:63], a[204:207], a[64:67], 0
  ds_read_b64_tr_b16 a[228:229], v161 offset:8192
  ds_read_b64_tr_b16 a[230:231], v161 offset:10240
  s_add_u32 m0, s66, 0x7800
  s_waitcnt lgkmcnt(12)
  v_mfma_f32_32x32x16_bf16 v[64:79], a[208:211], a[64:67], 0
  ds_read_b64_tr_b16 a[232:233], v162 offset:8192
  ds_read_b64_tr_b16 a[234:235], v162 offset:10240
  s_mov_b32 s74, s65
  buffer_load_dwordx4 v170, s[12:15], s74 offen lds
  v_mfma_f32_32x32x16_bf16 v[144:159], a[208:211], a[68:71], 0
  ds_read_b64_tr_b16 a[236:237], v163 offset:8192
  ds_read_b64_tr_b16 a[238:239], v163 offset:10240
  s_add_u32 s75, s65, 0x3400
  s_waitcnt lgkmcnt(14)
  v_mfma_f32_32x32x16_bf16 v[80:95], a[212:215], a[64:67], 0
  ds_read_b64_tr_b16 a[240:241], v160 offset:8448
  ds_read_b64_tr_b16 a[242:243], v160 offset:10496
  buffer_load_dwordx4 v170, s[12:15], s75 offen offset:1024 lds
  s_add_u32 s74, s65, 0x6800
  s_waitcnt lgkmcnt(12)
  v_mfma_f32_32x32x16_bf16 v[96:111], a[216:219], a[64:67], 0
  buffer_load_dwordx4 v170, s[12:15], s74 offen offset:2048 lds
  s_add_u32 s75, s65, 0x9c00
  v_mfma_f32_32x32x16_bf16 v[112:127], a[220:223], a[64:67], 0
  ds_read_b64_tr_b16 a[244:245], v161 offset:8448
  ds_read_b64_tr_b16 a[246:247], v161 offset:10496
  buffer_load_dwordx4 v170, s[12:15], s75 offen offset:3072 lds
  s_waitcnt lgkmcnt(10)
  v_mfma_f32_32x32x16_bf16 v[0:15], a[224:227], a[72:75], v[0:15]
  ds_read_b64_tr_b16 a[248:249], v162 offset:8448
  ds_read_b64_tr_b16 a[250:251], v162 offset:10496
  s_add_u32 m0, s66, 0x8800
  s_add_u32 s74, s65, 0xe000
  v_mfma_f32_32x32x16_bf16 v[128:143], a[224:227], a[76:79], v[128:143]
  ds_read_b64_tr_b16 a[252:253], v163 offset:8448
  ds_read_b64_tr_b16 a[254:255], v163 offset:10496
  buffer_load_dwordx4 v170, s[12:15], s74 offen lds
  s_waitcnt lgkmcnt(10)
  v_mfma_f32_32x32x16_bf16 v[16:31], a[228:231], a[72:75], v[16:31]
  v_mfma_f32_32x32x16_bf16 v[32:47], a[232:235], a[72:75], v[32:47]
  s_waitcnt vmcnt(10)
  s_waitcnt lgkmcnt(0)
  s_barrier
  ds_read_b128 a[80:83], v164 offset:10240
  ds_read_b64_tr_b16 a[192:193], v160 offset:16384
  ds_read_b64_tr_b16 a[194:195], v160 offset:18432
  ds_read_b128 a[84:87], v166 offset:10240
  buffer_atomic_add v207, v206, s[96:99], 0 offen
  v_mfma_f32_32x32x16_bf16 v[48:63], a[236:239], a[72:75], v[48:63]
  ds_read_b64_tr_b16 a[196:197], v161 offset:16384
  ds_read_b64_tr_b16 a[198:199], v161 offset:18432
  s_add_u32 s65, s64, 4
  s_cmp_ge_u32 s65, 14
  s_cselect_b32 s31, 14, 0
  v_mfma_f32_32x32x16_bf16 v[64:79], a[240:243], a[72:75], v[64:79]
  ds_read_b64_tr_b16 a[200:201], v162 offset:16384
  ds_read_b64_tr_b16 a[202:203], v162 offset:18432
  s_sub_u32 s65, s65, s31
  s_lshl_b32 s65, s65, 6
  s_add_u32 s65, s65, s67
  v_mfma_f32_32x32x16_bf16 v[144:159], a[240:243], a[76:79], v[144:159]
  ds_read_b64_tr_b16 a[204:205], v163 offset:16384
  ds_read_b64_tr_b16 a[206:207], v163 offset:18432
  s_add_u32 m0, s66, 0xa000
  s_mov_b32 s75, s65
  buffer_load_dwordx4 v170, s[12:15], s75 offen lds
  v_mfma_f32_32x32x16_bf16 v[80:95], a[244:247], a[72:75], v[80:95]
  ds_read_b64_tr_b16 a[208:209], v160 offset:16640
  ds_read_b64_tr_b16 a[210:211], v160 offset:18688
  s_add_u32 s74, s65, 0x3400
  buffer_load_dwordx4 v170, s[12:15], s74 offen offset:1024 lds
  s_add_u32 s75, s65, 0x6800
  v_mfma_f32_32x32x16_bf16 v[96:111], a[248:251], a[72:75], v[96:111]
  buffer_load_dwordx4 v170, s[12:15], s75 offen offset:2048 lds
  s_add_u32 s74, s65, 0x9c00
  buffer_load_dwordx4 v170, s[12:15], s74 offen offset:3072 lds
  s_add_u32 m0, s66, 0xb000
  v_mfma_f32_32x32x16_bf16 v[112:127], a[252:255], a[72:75], v[112:127]
  ds_read_b64_tr_b16 a[212:213], v161 offset:16640
  ds_read_b64_tr_b16 a[214:215], v161 offset:18688
  s_add_u32 s75, s65, 0xe000
  buffer_load_dwordx4 v170, s[12:15], s75 offen lds
  s_add_u32 s65, s64, 5
  s_waitcnt lgkmcnt(10)
  v_mfma_f32_32x32x16_bf16 v[0:15], a[192:195], a[80:83], v[0:15]
  ds_read_b64_tr_b16 a[216:217], v162 offset:16640
  ds_read_b64_tr_b16 a[218:219], v162 offset:18688
  s_cmp_ge_u32 s65, 14
  s_cselect_b32 s31, 14, 0
  s_sub_u32 s65, s65, s31
  v_mfma_f32_32x32x16_bf16 v[128:143], a[192:195], a[84:87], v[128:143]
  ds_read_b64_tr_b16 a[220:221], v163 offset:16640
  ds_read_b64_tr_b16 a[222:223], v163 offset:18688
  s_lshl_b32 s65, s65, 6
  s_add_u32 s65, s65, s67
  s_add_u32 m0, s66, 0xc800
  s_waitcnt lgkmcnt(10)
  v_mfma_f32_32x32x16_bf16 v[16:31], a[196:199], a[80:83], v[16:31]
  ds_read_b128 a[88:91], v165 offset:10240
  ds_read_b64_tr_b16 a[224:225], v160 offset:24576
  ds_read_b64_tr_b16 a[226:227], v160 offset:26624
  s_mov_b32 s74, s65
  buffer_load_dwordx4 v170, s[12:15], s74 offen lds
  v_mfma_f32_32x32x16_bf16 v[32:47], a[200:203], a[80:83], v[32:47]
  ds_read_b128 a[92:95], v167 offset:10240
  s_add_u32 s75, s65, 0x3400
  buffer_load_dwordx4 v170, s[12:15], s75 offen offset:1024 lds
  s_add_u32 s74, s65, 0x6800
  s_waitcnt lgkmcnt(10)
  v_mfma_f32_32x32x16_bf16 v[48:63], a[204:207], a[80:83], v[48:63]
  ds_read_b64_tr_b16 a[228:229], v161 offset:24576
  ds_read_b64_tr_b16 a[230:231], v161 offset:26624
  buffer_load_dwordx4 v170, s[12:15], s74 offen offset:2048 lds
  s_add_u32 s75, s65, 0x9c00
  buffer_load_dwordx4 v170, s[12:15], s75 offen offset:3072 lds
  v_mfma_f32_32x32x16_bf16 v[64:79], a[208:211], a[80:83], v[64:79]
  ds_read_b64_tr_b16 a[232:233], v162 offset:24576
  ds_read_b64_tr_b16 a[234:235], v162 offset:26624
  s_add_u32 m0, s66, 0xd800
  s_add_u32 s74, s65, 0xe000
  buffer_load_dwordx4 v170, s[12:15], s74 offen lds
  s_waitcnt lgkmcnt(12)
  v_mfma_f32_32x32x16_bf16 v[144:159], a[208:211], a[84:87], v[144:159]
  ds_read_b64_tr_b16 a[236:237], v163 offset:24576
  ds_read_b64_tr_b16 a[238:239], v163 offset:26624
  v_mfma_f32_32x32x16_bf16 v[80:95], a[212:215], a[80:83], v[80:95]
  ds_read_b64_tr_b16 a[240:241], v160 offset:24832
  ds_read_b64_tr_b16 a[242:243], v160 offset:26880
  s_waitcnt lgkmcnt(12)
  v_mfma_f32_32x32x16_bf16 v[96:111], a[216:219], a[80:83], v[96:111]
  v_mfma_f32_32x32x16_bf16 v[112:127], a[220:223], a[80:83], v[112:127]
  ds_read_b64_tr_b16 a[244:245], v161 offset:24832
  ds_read_b64_tr_b16 a[246:247], v161 offset:26880
  s_waitcnt lgkmcnt(10)
  v_mfma_f32_32x32x16_bf16 v[0:15], a[224:227], a[88:91], v[0:15]
  ds_read_b64_tr_b16 a[248:249], v162 offset:24832
  ds_read_b64_tr_b16 a[250:251], v162 offset:26880
  v_mfma_f32_32x32x16_bf16 v[128:143], a[224:227], a[92:95], v[128:143]
  ds_read_b64_tr_b16 a[252:253], v163 offset:24832
  ds_read_b64_tr_b16 a[254:255], v163 offset:26880
  s_waitcnt lgkmcnt(10)
  v_mfma_f32_32x32x16_bf16 v[16:31], a[228:231], a[88:91], v[16:31]
  v_mfma_f32_32x32x16_bf16 v[32:47], a[232:235], a[88:91], v[32:47]
  s_waitcnt vmcnt(16)
  s_waitcnt lgkmcnt(0)
  s_barrier
  ds_read_b128 a[96:99], v164 offset:20480
  ds_read_b64_tr_b16 a[192:193], v160 offset:32768
  ds_read_b64_tr_b16 a[194:195], v160 offset:34816
  ds_read_b128 a[100:103], v166 offset:20480
  v_mfma_f32_32x32x16_bf16 v[48:63], a[236:239], a[88:91], v[48:63]
  ds_read_b64_tr_b16 a[196:197], v161 offset:32768
  ds_read_b64_tr_b16 a[198:199], v161 offset:34816
  s_add_u32 s65, s64, 6
  v_mfma_f32_32x32x16_bf16 v[64:79], a[240:243], a[88:91], v[64:79]
  ds_read_b64_tr_b16 a[200:201], v162 offset:32768
  ds_read_b64_tr_b16 a[202:203], v162 offset:34816
  s_cmp_ge_u32 s65, 14
  s_cselect_b32 s31, 14, 0
  v_mfma_f32_32x32x16_bf16 v[144:159], a[240:243], a[92:95], v[144:159]
  ds_read_b64_tr_b16 a[204:205], v163 offset:32768
  ds_read_b64_tr_b16 a[206:207], v163 offset:34816
  s_sub_u32 s65, s65, s31
  v_mfma_f32_32x32x16_bf16 v[80:95], a[244:247], a[88:91], v[80:95]
  ds_read_b64_tr_b16 a[208:209], v160 offset:33024
  ds_read_b64_tr_b16 a[210:211], v160 offset:35072
  s_lshl_b32 s65, s65, 6
  s_add_u32 s65, s65, s67
  v_mfma_f32_32x32x16_bf16 v[96:111], a[248:251], a[88:91], v[96:111]
  s_add_u32 m0, s66, 0
  s_mov_b32 s75, s65
  v_mfma_f32_32x32x16_bf16 v[112:127], a[252:255], a[88:91], v[112:127]
  ds_read_b64_tr_b16 a[212:213], v161 offset:33024
  ds_read_b64_tr_b16 a[214:215], v161 offset:35072
  buffer_load_dwordx4 v170, s[12:15], s75 offen lds
  s_waitcnt lgkmcnt(10)
  v_mfma_f32_32x32x16_bf16 v[0:15], a[192:195], a[96:99], v[0:15]
  ds_read_b64_tr_b16 a[216:217], v162 offset:33024
  ds_read_b64_tr_b16 a[218:219], v162 offset:35072
  s_add_u32 s74, s65, 0x3400
  buffer_load_dwordx4 v170, s[12:15], s74 offen offset:1024 lds
  v_mfma_f32_32x32x16_bf16 v[128:143], a[192:195], a[100:103], v[128:143]
  ds_read_b64_tr_b16 a[220:221], v163 offset:33024
  ds_read_b64_tr_b16 a[222:223], v163 offset:35072
  s_add_u32 s75, s65, 0x6800
  s_waitcnt lgkmcnt(10)
  v_mfma_f32_32x32x16_bf16 v[16:31], a[196:199], a[96:99], v[16:31]
  ds_read_b128 a[104:107], v165 offset:20480
  ds_read_b64_tr_b16 a[224:225], v160 offset:40960
  ds_read_b64_tr_b16 a[226:227], v160 offset:43008
  buffer_load_dwordx4 v170, s[12:15], s75 offen offset:2048 lds
  v_mfma_f32_32x32x16_bf16 v[32:47], a[200:203], a[96:99], v[32:47]
  ds_read_b128 a[108:111], v167 offset:20480
  s_add_u32 s74, s65, 0x9c00
  buffer_load_dwordx4 v170, s[12:15], s74 offen offset:3072 lds
  s_waitcnt lgkmcnt(10)
  v_mfma_f32_32x32x16_bf16 v[48:63], a[204:207], a[96:99], v[48:63]
  ds_read_b64_tr_b16 a[228:229], v161 offset:40960
  ds_read_b64_tr_b16 a[230:231], v161 offset:43008
  s_add_u32 m0, s66, 0x1000
  s_add_u32 s75, s65, 0xe000
  v_mfma_f32_32x32x16_bf16 v[64:79], a[208:211], a[96:99], v[64:79]
  ds_read_b64_tr_b16 a[232:233], v162 offset:40960
  ds_read_b64_tr_b16 a[234:235], v162 offset:43008
  buffer_load_dwordx4 v170, s[12:15], s75 offen lds
  s_waitcnt lgkmcnt(12)
  v_mfma_f32_32x32x16_bf16 v[144:159], a[208:211], a[100:103], v[144:159]
  ds_read_b64_tr_b16 a[236:237], v163 offset:40960
  ds_read_b64_tr_b16 a[238:239], v163 offset:43008
  v_mfma_f32_32x32x16_bf16 v[80:95], a[212:215], a[96:99], v[80:95]
  ds_read_b64_tr_b16 a[240:241], v160 offset:41216
  ds_read_b64_tr_b16 a[242:243], v160 offset:43264
  s_waitcnt lgkmcnt(12)
  v_mfma_f32_32x32x16_bf16 v[96:111], a[216:219], a[96:99], v[96:111]
  v_mfma_f32_32x32x16_bf16 v[112:127], a[220:223], a[96:99], v[112:127]
  ds_read_b64_tr_b16 a[244:245], v161 offset:41216
  ds_read_b64_tr_b16 a[246:247], v161 offset:43264
  s_waitcnt lgkmcnt(10)
  v_mfma_f32_32x32x16_bf16 v[0:15], a[224:227], a[104:107], v[0:15]
  ds_read_b64_tr_b16 a[248:249], v162 offset:41216
  ds_read_b64_tr_b16 a[250:251], v162 offset:43264
  v_mfma_f32_32x32x16_bf16 v[128:143], a[224:227], a[108:111], v[128:143]
  ds_read_b64_tr_b16 a[252:253], v163 offset:41216
  ds_read_b64_tr_b16 a[254:255], v163 offset:43264
  s_waitcnt lgkmcnt(10)
  v_mfma_f32_32x32x16_bf16 v[16:31], a[228:231], a[104:107], v[16:31]
  v_mfma_f32_32x32x16_bf16 v[32:47], a[232:235], a[104:107], v[32:47]
  s_waitcnt vmcnt(16)
  s_waitcnt lgkmcnt(0)
  s_barrier
  ds_read_b128 a[64:67], v164 offset:30720
  ds_read_b64_tr_b16 a[192:193], v160 offset:49152
  ds_read_b64_tr_b16 a[194:195], v160 offset:51200
  ds_read_b128 a[68:71], v166 offset:30720
  v_mfma_f32_32x32x16_bf16 v[48:63], a[236:239], a[104:107], v[48:63]
  ds_read_b64_tr_b16 a[196:197], v161 offset:49152
  ds_read_b64_tr_b16 a[198:199], v161 offset:51200
  s_add_u32 s65, s64, 7
  s_cmp_ge_u32 s65, 14
  s_cselect_b32 s31, 14, 0
  v_mfma_f32_32x32x16_bf16 v[64:79], a[240:243], a[104:107], v[64:79]
  ds_read_b64_tr_b16 a[200:201], v162 offset:49152
  ds_read_b64_tr_b16 a[202:203], v162 offset:51200
  s_sub_u32 s65, s65, s31
  s_lshl_b32 s65, s65, 6
  s_add_u32 s65, s65, s67
  v_mfma_f32_32x32x16_bf16 v[144:159], a[240:243], a[108:111], v[144:159]
  ds_read_b64_tr_b16 a[204:205], v163 offset:49152
  ds_read_b64_tr_b16 a[206:207], v163 offset:51200
  s_add_u32 m0, s66, 0x2800
  s_mov_b32 s74, s65
  buffer_load_dwordx4 v170, s[12:15], s74 offen lds
  v_mfma_f32_32x32x16_bf16 v[80:95], a[244:247], a[104:107], v[80:95]
  ds_read_b64_tr_b16 a[208:209], v160 offset:49408
  ds_read_b64_tr_b16 a[210:211], v160 offset:51456
  s_add_u32 s75, s65, 0x3400
  buffer_load_dwordx4 v170, s[12:15], s75 offen offset:1024 lds
  s_add_u32 s74, s65, 0x6800
  v_mfma_f32_32x32x16_bf16 v[96:111], a[248:251], a[104:107], v[96:111]
  buffer_load_dwordx4 v170, s[12:15], s74 offen offset:2048 lds
  s_add_u32 s75, s65, 0x9c00
  buffer_load_dwordx4 v170, s[12:15], s75 offen offset:3072 lds
  s_add_u32 m0, s66, 0x3800
  v_mfma_f32_32x32x16_bf16 v[112:127], a[252:255], a[104:107], v[112:127]
  ds_read_b64_tr_b16 a[212:213], v161 offset:49408
  ds_read_b64_tr_b16 a[214:215], v161 offset:51456
  s_add_u32 s74, s65, 0xe000
  buffer_load_dwordx4 v170, s[12:15], s74 offen lds
  s_add_u32 s65, s64, 8
  s_waitcnt lgkmcnt(10)
  v_mfma_f32_32x32x16_bf16 v[0:15], a[192:195], a[64:67], v[0:15]
  ds_read_b64_tr_b16 a[216:217], v162 offset:49408
  ds_read_b64_tr_b16 a[218:219], v162 offset:51456
  s_cmp_ge_u32 s65, 14
  s_cselect_b32 s31, 14, 0
  s_sub_u32 s65, s65, s31
  v_mfma_f32_32x32x16_bf16 v[128:143], a[192:195], a[68:71], v[128:143]
  ds_read_b64_tr_b16 a[220:221], v163 offset:49408
  ds_read_b64_tr_b16 a[222:223], v163 offset:51456
  s_lshl_b32 s65, s65, 6
  s_add_u32 s65, s65, s67
  s_add_u32 m0, s66, 0x5000
  s_waitcnt lgkmcnt(10)
  v_mfma_f32_32x32x16_bf16 v[16:31], a[196:199], a[64:67], v[16:31]
  ds_read_b128 a[72:75], v165 offset:30720
  ds_read_b64_tr_b16 a[224:225], v160 offset:57344
  ds_read_b64_tr_b16 a[226:227], v160 offset:59392
  s_mov_b32 s75, s65
  buffer_load_dwordx4 v170, s[12:15], s75 offen lds
  v_mfma_f32_32x32x16_bf16 v[32:47], a[200:203], a[64:67], v[32:47]
  ds_read_b128 a[76:79], v167 offset:30720
  s_add_u32 s74, s65, 0x3400
  buffer_load_dwordx4 v170, s[12:15], s74 offen offset:1024 lds
  s_add_u32 s75, s65, 0x6800
  s_waitcnt lgkmcnt(10)
  v_mfma_f32_32x32x16_bf16 v[48:63], a[204:207], a[64:67], v[48:63]
  ds_read_b64_tr_b16 a[228:229], v161 offset:57344
  ds_read_b64_tr_b16 a[230:231], v161 offset:59392
  buffer_load_dwordx4 v170, s[12:15], s75 offen offset:2048 lds
  s_add_u32 s74, s65, 0x9c00
  buffer_load_dwordx4 v170, s[12:15], s74 offen offset:3072 lds
  v_mfma_f32_32x32x16_bf16 v[64:79], a[208:211], a[64:67], v[64:79]
  ds_read_b64_tr_b16 a[232:233], v162 offset:57344
  ds_read_b64_tr_b16 a[234:235], v162 offset:59392
  s_add_u32 m0, s66, 0x6000
  s_add_u32 s75, s65, 0xe000
  buffer_load_dwordx4 v170, s[12:15], s75 offen lds
  s_waitcnt lgkmcnt(12)
  v_mfma_f32_32x32x16_bf16 v[144:159], a[208:211], a[68:71], v[144:159]
  ds_read_b64_tr_b16 a[236:237], v163 offset:57344
  ds_read_b64_tr_b16 a[238:239], v163 offset:59392
  v_mfma_f32_32x32x16_bf16 v[80:95], a[212:215], a[64:67], v[80:95]
  ds_read_b64_tr_b16 a[240:241], v160 offset:57600
  ds_read_b64_tr_b16 a[242:243], v160 offset:59648
  s_waitcnt lgkmcnt(12)
  v_mfma_f32_32x32x16_bf16 v[96:111], a[216:219], a[64:67], v[96:111]
  v_mfma_f32_32x32x16_bf16 v[112:127], a[220:223], a[64:67], v[112:127]
  ds_read_b64_tr_b16 a[244:245], v161 offset:57600
  ds_read_b64_tr_b16 a[246:247], v161 offset:59648
  s_waitcnt lgkmcnt(10)
  v_mfma_f32_32x32x16_bf16 v[0:15], a[224:227], a[72:75], v[0:15]
  ds_read_b64_tr_b16 a[248:249], v162 offset:57600
  ds_read_b64_tr_b16 a[250:251], v162 offset:59648
  v_mfma_f32_32x32x16_bf16 v[128:143], a[224:227], a[76:79], v[128:143]
  ds_read_b64_tr_b16 a[252:253], v163 offset:57600
  ds_read_b64_tr_b16 a[254:255], v163 offset:59648
  s_waitcnt lgkmcnt(10)
  v_mfma_f32_32x32x16_bf16 v[16:31], a[228:231], a[72:75], v[16:31]
  v_mfma_f32_32x32x16_bf16 v[32:47], a[232:235], a[72:75], v[32:47]
  s_waitcnt vmcnt(20)
  s_waitcnt lgkmcnt(0)
  s_barrier
  ds_read_b128 a[80:83], v164 offset:40960
  ds_read_b64_tr_b16 a[192:193], v180
  ds_read_b64_tr_b16 a[194:195], v180 offset:2048
  ds_read_b128 a[84:87], v166 offset:40960
  v_mfma_f32_32x32x16_bf16 v[48:63], a[236:239], a[72:75], v[48:63]
  ds_read_b64_tr_b16 a[196:197], v181
  ds_read_b64_tr_b16 a[198:199], v181 offset:2048
  s_add_u32 s65, s64, 9
  v_mfma_f32_32x32x16_bf16 v[64:79], a[240:243], a[72:75], v[64:79]
  ds_read_b64_tr_b16 a[200:201], v182
  ds_read_b64_tr_b16 a[202:203], v182 offset:2048
  s_cmp_ge_u32 s65, 14
  s_cselect_b32 s31, 14, 0
  v_mfma_f32_32x32x16_bf16 v[144:159], a[240:243], a[76:79], v[144:159]
  ds_read_b64_tr_b16 a[204:205], v183
  ds_read_b64_tr_b16 a[206:207], v183 offset:2048
  s_sub_u32 s65, s65, s31
  v_mfma_f32_32x32x16_bf16 v[80:95], a[244:247], a[72:75], v[80:95]
  ds_read_b64_tr_b16 a[208:209], v180 offset:256
  ds_read_b64_tr_b16 a[210:211], v180 offset:2304
  s_lshl_b32 s65, s65, 6
  s_add_u32 s65, s65, s67
  v_mfma_f32_32x32x16_bf16 v[96:111], a[248:251], a[72:75], v[96:111]
  s_add_u32 m0, s66, 0x7800
  s_mov_b32 s74, s65
  v_mfma_f32_32x32x16_bf16 v[112:127], a[252:255], a[72:75], v[112:127]
  ds_read_b64_tr_b16 a[212:213], v181 offset:256
  ds_read_b64_tr_b16 a[214:215], v181 offset:2304
  buffer_load_dwordx4 v170, s[12:15], s74 offen lds
  s_waitcnt lgkmcnt(10)
  v_mfma_f32_32x32x16_bf16 v[0:15], a[192:195], a[80:83], v[0:15]
  ds_read_b64_tr_b16 a[216:217], v182 offset:256
  ds_read_b64_tr_b16 a[218:219], v182 offset:2304
  s_add_u32 s75, s65, 0x3400
  buffer_load_dwordx4 v170, s[12:15], s75 offen offset:1024 lds
  v_mfma_f32_32x32x16_bf16 v[128:143], a[192:195], a[84:87], v[128:143]
  ds_read_b64_tr_b16 a[220:221], v183 offset:256
  ds_read_b64_tr_b16 a[222:223], v183 offset:2304
  s_add_u32 s74, s65, 0x6800
  s_waitcnt lgkmcnt(10)
  v_mfma_f32_32x32x16_bf16 v[16:31], a[196:199], a[80:83], v[16:31]
  ds_read_b128 a[88:91], v165 offset:40960
  ds_read_b64_tr_b16 a[224:225], v180 offset:8192
  ds_read_b64_tr_b16 a[226:227], v180 offset:10240
  buffer_load_dwordx4 v170, s[12:15], s74 offen offset:2048 lds
  v_mfma_f32_32x32x16_bf16 v[32:47], a[200:203], a[80:83], v[32:47]
  ds_read_b128 a[92:95], v167 offset:40960
  s_add_u32 s75, s65, 0x9c00
  buffer_load_dwordx4 v170, s[12:15], s75 offen offset:3072 lds
  s_waitcnt lgkmcnt(10)
  v_mfma_f32_32x32x16_bf16 v[48:63], a[204:207], a[80:83], v[48:63]
  ds_read_b64_tr_b16 a[228:229], v181 offset:8192
  ds_read_b64_tr_b16 a[230:231], v181 offset:10240
  s_add_u32 m0, s66, 0x8800
  s_add_u32 s74, s65, 0xe000
  v_mfma_f32_32x32x16_bf16 v[64:79], a[208:211], a[80:83], v[64:79]
  ds_read_b64_tr_b16 a[232:233], v182 offset:8192
  ds_read_b64_tr_b16 a[234:235], v182 offset:10240
  buffer_load_dwordx4 v170, s[12:15], s74 offen lds
  s_waitcnt lgkmcnt(12)
  v_mfma_f32_32x32x16_bf16 v[144:159], a[208:211], a[84:87], v[144:159]
  ds_read_b64_tr_b16 a[236:237], v183 offset:8192
  ds_read_b64_tr_b16 a[238:239], v183 offset:10240
  v_mfma_f32_32x32x16_bf16 v[80:95], a[212:215], a[80:83], v[80:95]
  ds_read_b64_tr_b16 a[240:241], v180 offset:8448
  ds_read_b64_tr_b16 a[242:243], v180 offset:10496
  s_waitcnt lgkmcnt(12)
  v_mfma_f32_32x32x16_bf16 v[96:111], a[216:219], a[80:83], v[96:111]
  v_mfma_f32_32x32x16_bf16 v[112:127], a[220:223], a[80:83], v[112:127]
  ds_read_b64_tr_b16 a[244:245], v181 offset:8448
  ds_read_b64_tr_b16 a[246:247], v181 offset:10496
  s_waitcnt lgkmcnt(10)
  v_mfma_f32_32x32x16_bf16 v[0:15], a[224:227], a[88:91], v[0:15]
  ds_read_b64_tr_b16 a[248:249], v182 offset:8448
  ds_read_b64_tr_b16 a[250:251], v182 offset:10496
  v_mfma_f32_32x32x16_bf16 v[128:143], a[224:227], a[92:95], v[128:143]
  ds_read_b64_tr_b16 a[252:253], v183 offset:8448
  ds_read_b64_tr_b16 a[254:255], v183 offset:10496
  s_waitcnt lgkmcnt(10)
  v_mfma_f32_32x32x16_bf16 v[16:31], a[228:231], a[88:91], v[16:31]
  v_mfma_f32_32x32x16_bf16 v[32:47], a[232:235], a[88:91], v[32:47]
  s_waitcnt vmcnt(20)
  s_waitcnt lgkmcnt(0)
  s_barrier
  ds_read_b128 a[96:99], v164 offset:51200
  ds_read_b64_tr_b16 a[192:193], v180 offset:16384
  ds_read_b64_tr_b16 a[194:195], v180 offset:18432
  ds_read_b128 a[100:103], v166 offset:51200
  v_mfma_f32_32x32x16_bf16 v[48:63], a[236:239], a[88:91], v[48:63]
  ds_read_b64_tr_b16 a[196:197], v181 offset:16384
  ds_read_b64_tr_b16 a[198:199], v181 offset:18432
  s_add_u32 s65, s64, 10
  v_mfma_f32_32x32x16_bf16 v[64:79], a[240:243], a[88:91], v[64:79]
  ds_read_b64_tr_b16 a[200:201], v182 offset:16384
  ds_read_b64_tr_b16 a[202:203], v182 offset:18432
  s_cmp_ge_u32 s65, 14
  s_cselect_b32 s31, 14, 0
  v_mfma_f32_32x32x16_bf16 v[144:159], a[240:243], a[92:95], v[144:159]
  ds_read_b64_tr_b16 a[204:205], v183 offset:16384
  ds_read_b64_tr_b16 a[206:207], v183 offset:18432
  s_sub_u32 s65, s65, s31
  v_mfma_f32_32x32x16_bf16 v[80:95], a[244:247], a[88:91], v[80:95]
  ds_read_b64_tr_b16 a[208:209], v180 offset:16640
  ds_read_b64_tr_b16 a[210:211], v180 offset:18688
  s_lshl_b32 s65, s65, 6
  s_add_u32 s65, s65, s67
  v_mfma_f32_32x32x16_bf16 v[96:111], a[248:251], a[88:91], v[96:111]
  s_add_u32 m0, s66, 0xa000
  s_mov_b32 s75, s65
  v_mfma_f32_32x32x16_bf16 v[112:127], a[252:255], a[88:91], v[112:127]
  ds_read_b64_tr_b16 a[212:213], v181 offset:16640
  ds_read_b64_tr_b16 a[214:215], v181 offset:18688
  buffer_load_dwordx4 v170, s[12:15], s75 offen lds
  s_waitcnt lgkmcnt(10)
  v_mfma_f32_32x32x16_bf16 v[0:15], a[192:195], a[96:99], v[0:15]
  ds_read_b64_tr_b16 a[216:217], v182 offset:16640
  ds_read_b64_tr_b16 a[218:219], v182 offset:18688
  s_add_u32 s74, s65, 0x3400
  buffer_load_dwordx4 v170, s[12:15], s74 offen offset:1024 lds
  v_mfma_f32_32x32x16_bf16 v[128:143], a[192:195], a[100:103], v[128:143]
  ds_read_b64_tr_b16 a[220:221], v183 offset:16640
  ds_read_b64_tr_b16 a[222:223], v183 offset:18688
  s_add_u32 s75, s65, 0x6800
  s_waitcnt lgkmcnt(10)
  v_mfma_f32_32x32x16_bf16 v[16:31], a[196:199], a[96:99], v[16:31]
  ds_read_b128 a[104:107], v165 offset:51200
  ds_read_b64_tr_b16 a[224:225], v180 offset:24576
  ds_read_b64_tr_b16 a[226:227], v180 offset:26624
  buffer_load_dwordx4 v170, s[12:15], s75 offen offset:2048 lds
  v_mfma_f32_32x32x16_bf16 v[32:47], a[200:203], a[96:99], v[32:47]
  ds_read_b128 a[108:111], v167 offset:51200
  s_add_u32 s74, s65, 0x9c00
  buffer_load_dwordx4 v170, s[12:15], s74 offen offset:3072 lds
  s_waitcnt lgkmcnt(10)
  v_mfma_f32_32x32x16_bf16 v[48:63], a[204:207], a[96:99], v[48:63]
  ds_read_b64_tr_b16 a[228:229], v181 offset:24576
  ds_read_b64_tr_b16 a[230:231], v181 offset:26624
  s_add_u32 m0, s66, 0xb000
  s_add_u32 s75, s65, 0xe000
  v_mfma_f32_32x32x16_bf16 v[64:79], a[208:211], a[96:99], v[64:79]
  ds_read_b64_tr_b16 a[232:233], v182 offset:24576
  ds_read_b64_tr_b16 a[234:235], v182 offset:26624
  buffer_load_dwordx4 v170, s[12:15], s75 offen lds
  s_waitcnt lgkmcnt(12)
  v_mfma_f32_32x32x16_bf16 v[144:159], a[208:211], a[100:103], v[144:159]
  ds_read_b64_tr_b16 a[236:237], v183 offset:24576
  ds_read_b64_tr_b16 a[238:239], v183 offset:26624
  v_mfma_f32_32x32x16_bf16 v[80:95], a[212:215], a[96:99], v[80:95]
  ds_read_b64_tr_b16 a[240:241], v180 offset:24832
  ds_read_b64_tr_b16 a[242:243], v180 offset:26880
  s_waitcnt lgkmcnt(12)
  v_mfma_f32_32x32x16_bf16 v[96:111], a[216:219], a[96:99], v[96:111]
  v_mfma_f32_32x32x16_bf16 v[112:127], a[220:223], a[96:99], v[112:127]
  ds_read_b64_tr_b16 a[244:245], v181 offset:24832
  ds_read_b64_tr_b16 a[246:247], v181 offset:26880
  s_waitcnt lgkmcnt(10)
  v_mfma_f32_32x32x16_bf16 v[0:15], a[224:227], a[104:107], v[0:15]
  ds_read_b64_tr_b16 a[248:249], v182 offset:24832
  ds_read_b64_tr_b16 a[250:251], v182 offset:26880
  v_mfma_f32_32x32x16_bf16 v[128:143], a[224:227], a[108:111], v[128:143]
  ds_read_b64_tr_b16 a[252:253], v183 offset:24832
  ds_read_b64_tr_b16 a[254:255], v183 offset:26880
  s_waitcnt lgkmcnt(10)
  v_mfma_f32_32x32x16_bf16 v[16:31], a[228:231], a[104:107], v[16:31]
  v_mfma_f32_32x32x16_bf16 v[32:47], a[232:235], a[104:107], v[32:47]
  s_waitcnt vmcnt(20)
  s_waitcnt lgkmcnt(0)
  s_barrier
  ds_read_b128 a[64:67], v164
  ds_read_b64_tr_b16 a[192:193], v160
  ds_read_b64_tr_b16 a[194:195], v160 offset:2048
  ds_read_b128 a[68:71], v166
  v_mfma_f32_32x32x16_bf16 v[48:63], a[236:239], a[104:107], v[48:63]
  ds_read_b64_tr_b16 a[196:197], v161
  ds_read_b64_tr_b16 a[198:199], v161 offset:2048
  s_add_u32 s65, s64, 11
  v_mfma_f32_32x32x16_bf16 v[64:79], a[240:243], a[104:107], v[64:79]
  ds_read_b64_tr_b16 a[200:201], v162
  ds_read_b64_tr_b16 a[202:203], v162 offset:2048
  s_cmp_ge_u32 s65, 14
  s_cselect_b32 s31, 14, 0
  v_mfma_f32_32x32x16_bf16 v[144:159], a[240:243], a[108:111], v[144:159]
  ds_read_b64_tr_b16 a[204:205], v163
  ds_read_b64_tr_b16 a[206:207], v163 offset:2048
  s_sub_u32 s65, s65, s31
  v_mfma_f32_32x32x16_bf16 v[80:95], a[244:247], a[104:107], v[80:95]
  ds_read_b64_tr_b16 a[208:209], v160 offset:256
  ds_read_b64_tr_b16 a[210:211], v160 offset:2304
  s_lshl_b32 s65, s65, 6
  s_add_u32 s65, s65, s67
  v_mfma_f32_32x32x16_bf16 v[96:111], a[248:251], a[104:107], v[96:111]
  s_add_u32 m0, s66, 0xc800
  s_mov_b32 s74, s65
  v_mfma_f32_32x32x16_bf16 v[112:127], a[252:255], a[104:107], v[112:127]
  ds_read_b64_tr_b16 a[212:213], v161 offset:256
  ds_read_b64_tr_b16 a[214:215], v161 offset:2304
  buffer_load_dwordx4 v170, s[12:15], s74 offen lds
  s_waitcnt lgkmcnt(10)
  v_mfma_f32_32x32x16_bf16 v[0:15], a[192:195], a[64:67], v[0:15]
  ds_read_b64_tr_b16 a[216:217], v162 offset:256
  ds_read_b64_tr_b16 a[218:219], v162 offset:2304
  s_add_u32 s75, s65, 0x3400
  buffer_load_dwordx4 v170, s[12:15], s75 offen offset:1024 lds
  v_mfma_f32_32x32x16_bf16 v[128:143], a[192:195], a[68:71], v[128:143]
  ds_read_b64_tr_b16 a[220:221], v163 offset:256
  ds_read_b64_tr_b16 a[222:223], v163 offset:2304
  s_add_u32 s74, s65, 0x6800
  s_waitcnt lgkmcnt(10)
  v_mfma_f32_32x32x16_bf16 v[16:31], a[196:199], a[64:67], v[16:31]
  ds_read_b128 a[72:75], v165
  ds_read_b64_tr_b16 a[224:225], v160 offset:8192
  ds_read_b64_tr_b16 a[226:227], v160 offset:10240
  buffer_load_dwordx4 v170, s[12:15], s74 offen offset:2048 lds
  v_mfma_f32_32x32x16_bf16 v[32:47], a[200:203], a[64:67], v[32:47]
  ds_read_b128 a[76:79], v167
  s_add_u32 s75, s65, 0x9c00
  buffer_load_dwordx4 v170, s[12:15], s75 offen offset:3072 lds
  s_waitcnt lgkmcnt(10)
  v_mfma_f32_32x32x16_bf16 v[48:63], a[204:207], a[64:67], v[48:63]
  ds_read_b64_tr_b16 a[228:229], v161 offset:8192
  ds_read_b64_tr_b16 a[230:231], v161 offset:10240
  s_add_u32 m0, s66, 0xd800
  s_add_u32 s74, s65, 0xe000
  v_mfma_f32_32x32x16_bf16 v[64:79], a[208:211], a[64:67], v[64:79]
  ds_read_b64_tr_b16 a[232:233], v162 offset:8192
  ds_read_b64_tr_b16 a[234:235], v162 offset:10240
  buffer_load_dwordx4 v170, s[12:15], s74 offen lds
  s_waitcnt lgkmcnt(12)
  v_mfma_f32_32x32x16_bf16 v[144:159], a[208:211], a[68:71], v[144:159]
  ds_read_b64_tr_b16 a[236:237], v163 offset:8192
  ds_read_b64_tr_b16 a[238:239], v163 offset:10240
  v_mfma_f32_32x32x16_bf16 v[80:95], a[212:215], a[64:67], v[80:95]
  ds_read_b64_tr_b16 a[240:241], v160 offset:8448
  ds_read_b64_tr_b16 a[242:243], v160 offset:10496
  s_waitcnt lgkmcnt(12)
  v_mfma_f32_32x32x16_bf16 v[96:111], a[216:219], a[64:67], v[96:111]
  v_mfma_f32_32x32x16_bf16 v[112:127], a[220:223], a[64:67], v[112:127]
  ds_read_b64_tr_b16 a[244:245], v161 offset:8448
  ds_read_b64_tr_b16 a[246:247], v161 offset:10496
  s_waitcnt lgkmcnt(10)
  v_mfma_f32_32x32x16_bf16 v[0:15], a[224:227], a[72:75], v[0:15]
  ds_read_b64_tr_b16 a[248:249], v162 offset:8448
  ds_read_b64_tr_b16 a[250:251], v162 offset:10496
  v_mfma_f32_32x32x16_bf16 v[128:143], a[224:227], a[76:79], v[128:143]
  ds_read_b64_tr_b16 a[252:253], v163 offset:8448
  ds_read_b64_tr_b16 a[254:255], v163 offset:10496
  s_waitcnt lgkmcnt(10)
  v_mfma_f32_32x32x16_bf16 v[16:31], a[228:231], a[72:75], v[16:31]
  v_mfma_f32_32x32x16_bf16 v[32:47], a[232:235], a[72:75], v[32:47]
  s_waitcnt vmcnt(20)
  s_waitcnt lgkmcnt(0)
  s_barrier
  ds_read_b128 a[80:83], v164 offset:10240
  ds_read_b64_tr_b16 a[192:193], v160 offset:16384
  ds_read_b64_tr_b16 a[194:195], v160 offset:18432
  ds_read_b128 a[84:87], v166 offset:10240
  v_mfma_f32_32x32x16_bf16 v[48:63], a[236:239], a[72:75], v[48:63]
  ds_read_b64_tr_b16 a[196:197], v161 offset:16384
  ds_read_b64_tr_b16 a[198:199], v161 offset:18432
  s_add_u32 s65, s64, 12
  v_mfma_f32_32x32x16_bf16 v[64:79], a[240:243], a[72:75], v[64:79]
  ds_read_b64_tr_b16 a[200:201], v162 offset:16384
  ds_read_b64_tr_b16 a[202:203], v162 offset:18432
  s_cmp_ge_u32 s65, 14
  s_cselect_b32 s31, 14, 0
  v_mfma_f32_32x32x16_bf16 v[144:159], a[240:243], a[76:79], v[144:159]
  ds_read_b64_tr_b16 a[204:205], v163 offset:16384
  ds_read_b64_tr_b16 a[206:207], v163 offset:18432
  s_sub_u32 s65, s65, s31
  v_mfma_f32_32x32x16_bf16 v[80:95], a[244:247], a[72:75], v[80:95]
  ds_read_b64_tr_b16 a[208:209], v160 offset:16640
  ds_read_b64_tr_b16 a[210:211], v160 offset:18688
  s_lshl_b32 s65, s65, 6
  s_add_u32 s65, s65, s67
  v_mfma_f32_32x32x16_bf16 v[96:111], a[248:251], a[72:75], v[96:111]
  s_add_u32 m0, s66, 0
  s_mov_b32 s75, s65
  v_mfma_f32_32x32x16_bf16 v[112:127], a[252:255], a[72:75], v[112:127]
  ds_read_b64_tr_b16 a[212:213], v161 offset:16640
  ds_read_b64_tr_b16 a[214:215], v161 offset:18688
  buffer_load_dwordx4 v170, s[12:15], s75 offen lds
  s_waitcnt lgkmcnt(10)
  v_mfma_f32_32x32x16_bf16 v[0:15], a[192:195], a[80:83], v[0:15]
  ds_read_b64_tr_b16 a[216:217], v162 offset:16640
  ds_read_b64_tr_b16 a[218:219], v162 offset:18688
  s_add_u32 s74, s65, 0x3400
  buffer_load_dwordx4 v170, s[12:15], s74 offen offset:1024 lds
  v_mfma_f32_32x32x16_bf16 v[128:143], a[192:195], a[84:87], v[128:143]
  ds_read_b64_tr_b16 a[220:221], v163 offset:16640
  ds_read_b64_tr_b16 a[222:223], v163 offset:18688
  s_add_u32 s75, s65, 0x6800
  s_waitcnt lgkmcnt(10)
  v_mfma_f32_32x32x16_bf16 v[16:31], a[196:199], a[80:83], v[16:31]
  ds_read_b128 a[88:91], v165 offset:10240
  ds_read_b64_tr_b16 a[224:225], v160 offset:24576
  ds_read_b64_tr_b16 a[226:227], v160 offset:26624
  buffer_load_dwordx4 v170, s[12:15], s75 offen offset:2048 lds
  v_mfma_f32_32x32x16_bf16 v[32:47], a[200:203], a[80:83], v[32:47]
  ds_read_b128 a[92:95], v167 offset:10240
  s_add_u32 s74, s65, 0x9c00
  buffer_load_dwordx4 v170, s[12:15], s74 offen offset:3072 lds
  s_waitcnt lgkmcnt(10)
  v_mfma_f32_32x32x16_bf16 v[48:63], a[204:207], a[80:83], v[48:63]
  ds_read_b64_tr_b16 a[228:229], v161 offset:24576
  ds_read_b64_tr_b16 a[230:231], v161 offset:26624
  s_add_u32 m0, s66, 0x1000
  s_add_u32 s75, s65, 0xe000
  v_mfma_f32_32x32x16_bf16 v[64:79], a[208:211], a[80:83], v[64:79]
  ds_read_b64_tr_b16 a[232:233], v162 offset:24576
  ds_read_b64_tr_b16 a[234:235], v162 offset:26624
  buffer_load_dwordx4 v170, s[12:15], s75 offen lds
  s_waitcnt lgkmcnt(12)
  v_mfma_f32_32x32x16_bf16 v[144:159], a[208:211], a[84:87], v[144:159]
  ds_read_b64_tr_b16 a[236:237], v163 offset:24576
  ds_read_b64_tr_b16 a[238:239], v163 offset:26624
  v_mfma_f32_32x32x16_bf16 v[80:95], a[212:215], a[80:83], v[80:95]
  ds_read_b64_tr_b16 a[240:241], v160 offset:24832
  ds_read_b64_tr_b16 a[242:243], v160 offset:26880
  s_waitcnt lgkmcnt(12)
  v_mfma_f32_32x32x16_bf16 v[96:111], a[216:219], a[80:83], v[96:111]
  v_mfma_f32_32x32x16_bf16 v[112:127], a[220:223], a[80:83], v[112:127]
  ds_read_b64_tr_b16 a[244:245], v161 offset:24832
  ds_read_b64_tr_b16 a[246:247], v161 offset:26880
  s_waitcnt lgkmcnt(10)
  v_mfma_f32_32x32x16_bf16 v[0:15], a[224:227], a[88:91], v[0:15]
  ds_read_b64_tr_b16 a[248:249], v162 offset:24832
  ds_read_b64_tr_b16 a[250:251], v162 offset:26880
  v_mfma_f32_32x32x16_bf16 v[128:143], a[224:227], a[92:95], v[128:143]
  ds_read_b64_tr_b16 a[252:253], v163 offset:24832
  ds_read_b64_tr_b16 a[254:255], v163 offset:26880
  s_waitcnt lgkmcnt(10)
  v_mfma_f32_32x32x16_bf16 v[16:31], a[228:231], a[88:91], v[16:31]
  v_mfma_f32_32x32x16_bf16 v[32:47], a[232:235], a[88:91], v[32:47]
  s_waitcnt vmcnt(20)
  s_waitcnt lgkmcnt(0)
  s_barrier
  ds_read_b128 a[96:99], v164 offset:20480
  ds_read_b64_tr_b16 a[192:193], v160 offset:32768
  ds_read_b64_tr_b16 a[194:195], v160 offset:34816
  ds_read_b128 a[100:103], v166 offset:20480
  v_mfma_f32_32x32x16_bf16 v[48:63], a[236:239], a[88:91], v[48:63]
  ds_read_b64_tr_b16 a[196:197], v161 offset:32768
  ds_read_b64_tr_b16 a[198:199], v161 offset:34816
  s_add_u32 s65, s64, 13
  v_mfma_f32_32x32x16_bf16 v[64:79], a[240:243], a[88:91], v[64:79]
  ds_read_b64_tr_b16 a[200:201], v162 offset:32768
  ds_read_b64_tr_b16 a[202:203], v162 offset:34816
  s_cmp_ge_u32 s65, 14
  s_cselect_b32 s31, 14, 0
  v_mfma_f32_32x32x16_bf16 v[144:159], a[240:243], a[92:95], v[144:159]
  ds_read_b64_tr_b16 a[204:205], v163 offset:32768
  ds_read_b64_tr_b16 a[206:207], v163 offset:34816
  s_sub_u32 s65, s65, s31
  v_mfma_f32_32x32x16_bf16 v[80:95], a[244:247], a[88:91], v[80:95]
  ds_read_b64_tr_b16 a[208:209], v160 offset:33024
  ds_read_b64_tr_b16 a[210:211], v160 offset:35072
  s_lshl_b32 s65, s65, 6
  s_add_u32 s65, s65, s67
  v_mfma_f32_32x32x16_bf16 v[96:111], a[248:251], a[88:91], v[96:111]
  s_add_u32 m0, s66, 0x2800
  s_mov_b32 s74, s65
  v_mfma_f32_32x32x16_bf16 v[112:127], a[252:255], a[88:91], v[112:127]
  ds_read_b64_tr_b16 a[212:213], v161 offset:33024
  ds_read_b64_tr_b16 a[214:215], v161 offset:35072
  buffer_load_dwordx4 v170, s[12:15], s74 offen lds
  s_waitcnt lgkmcnt(10)
  v_mfma_f32_32x32x16_bf16 v[0:15], a[192:195], a[96:99], v[0:15]
  ds_read_b64_tr_b16 a[216:217], v162 offset:33024
  ds_read_b64_tr_b16 a[218:219], v162 offset:35072
  s_add_u32 s75, s65, 0x3400
  buffer_load_dwordx4 v170, s[12:15], s75 offen offset:1024 lds
  v_mfma_f32_32x32x16_bf16 v[128:143], a[192:195], a[100:103], v[128:143]
  ds_read_b64_tr_b16 a[220:221], v163 offset:33024
  ds_read_b64_tr_b16 a[222:223], v163 offset:35072
  s_add_u32 s74, s65, 0x6800
  s_waitcnt lgkmcnt(10)
  v_mfma_f32_32x32x16_bf16 v[16:31], a[196:199], a[96:99], v[16:31]
  ds_read_b128 a[104:107], v165 offset:20480
  ds_read_b64_tr_b16 a[224:225], v160 offset:40960
  ds_read_b64_tr_b16 a[226:227], v160 offset:43008
  buffer_load_dwordx4 v170, s[12:15], s74 offen offset:2048 lds
  v_mfma_f32_32x32x16_bf16 v[32:47], a[200:203], a[96:99], v[32:47]
  ds_read_b128 a[108:111], v167 offset:20480
  s_add_u32 s75, s65, 0x9c00
  buffer_load_dwordx4 v170, s[12:15], s75 offen offset:3072 lds
  s_waitcnt lgkmcnt(10)
  v_mfma_f32_32x32x16_bf16 v[48:63], a[204:207], a[96:99], v[48:63]
  ds_read_b64_tr_b16 a[228:229], v161 offset:40960
  ds_read_b64_tr_b16 a[230:231], v161 offset:43008
  s_add_u32 m0, s66, 0x3800
  s_add_u32 s74, s65, 0xe000
  v_mfma_f32_32x32x16_bf16 v[64:79], a[208:211], a[96:99], v[64:79]
  ds_read_b64_tr_b16 a[232:233], v162 offset:40960
  ds_read_b64_tr_b16 a[234:235], v162 offset:43008
  buffer_load_dwordx4 v170, s[12:15], s74 offen lds
  s_waitcnt lgkmcnt(12)
  v_mfma_f32_32x32x16_bf16 v[144:159], a[208:211], a[100:103], v[144:159]
  ds_read_b64_tr_b16 a[236:237], v163 offset:40960
  ds_read_b64_tr_b16 a[238:239], v163 offset:43008
  v_mfma_f32_32x32x16_bf16 v[80:95], a[212:215], a[96:99], v[80:95]
  ds_read_b64_tr_b16 a[240:241], v160 offset:41216
  ds_read_b64_tr_b16 a[242:243], v160 offset:43264
  s_waitcnt lgkmcnt(12)
  v_mfma_f32_32x32x16_bf16 v[96:111], a[216:219], a[96:99], v[96:111]
  v_mfma_f32_32x32x16_bf16 v[112:127], a[220:223], a[96:99], v[112:127]
  ds_read_b64_tr_b16 a[244:245], v161 offset:41216
  ds_read_b64_tr_b16 a[246:247], v161 offset:43264
  s_waitcnt lgkmcnt(10)
  v_mfma_f32_32x32x16_bf16 v[0:15], a[224:227], a[104:107], v[0:15]
  ds_read_b64_tr_b16 a[248:249], v162 offset:41216
  ds_read_b64_tr_b16 a[250:251], v162 offset:43264
  v_mfma_f32_32x32x16_bf16 v[128:143], a[224:227], a[108:111], v[128:143]
  ds_read_b64_tr_b16 a[252:253], v163 offset:41216
  ds_read_b64_tr_b16 a[254:255], v163 offset:43264
  s_waitcnt lgkmcnt(10)
  v_mfma_f32_32x32x16_bf16 v[16:31], a[228:231], a[104:107], v[16:31]
  v_mfma_f32_32x32x16_bf16 v[32:47], a[232:235], a[104:107], v[32:47]
  s_waitcnt vmcnt(20)
  s_waitcnt lgkmcnt(0)
  s_barrier
  ds_read_b128 a[64:67], v164 offset:30720
  ds_read_b64_tr_b16 a[192:193], v160 offset:49152
  ds_read_b64_tr_b16 a[194:195], v160 offset:51200
  ds_read_b128 a[68:71], v166 offset:30720
  v_mfma_f32_32x32x16_bf16 v[48:63], a[236:239], a[104:107], v[48:63]
  ds_read_b64_tr_b16 a[196:197], v161 offset:49152
  ds_read_b64_tr_b16 a[198:199], v161 offset:51200
  s_add_u32 m0, s33, 0x8000
  v_mfma_f32_32x32x16_bf16 v[64:79], a[240:243], a[104:107], v[64:79]
  ds_read_b64_tr_b16 a[200:201], v162 offset:49152
  ds_read_b64_tr_b16 a[202:203], v162 offset:51200
  s_add_u32 s75, s33, 0
  v_mfma_f32_32x32x16_bf16 v[144:159], a[240:243], a[108:111], v[144:159]
  ds_read_b64_tr_b16 a[204:205], v163 offset:49152
  ds_read_b64_tr_b16 a[206:207], v163 offset:51200
  buffer_load_dwordx4 v240, s[4:7], s75 offen nt lds
  v_mfma_f32_32x32x16_bf16 v[80:95], a[244:247], a[104:107], v[80:95]
  ds_read_b64_tr_b16 a[208:209], v160 offset:49408
  ds_read_b64_tr_b16 a[210:211], v160 offset:51456
  buffer_load_dwordx4 v241, s[4:7], s75 offen offset:1024 nt lds
  v_mfma_f32_32x32x16_bf16 v[96:111], a[248:251], a[104:107], v[96:111]
  buffer_load_dwordx4 v242, s[4:7], s75 offen offset:2048 nt lds
  buffer_load_dwordx4 v243, s[4:7], s75 offen offset:3072 nt lds
  v_mfma_f32_32x32x16_bf16 v[112:127], a[252:255], a[104:107], v[112:127]
  ds_read_b64_tr_b16 a[212:213], v161 offset:49408
  ds_read_b64_tr_b16 a[214:215], v161 offset:51456
  s_waitcnt lgkmcnt(10)
  v_mfma_f32_32x32x16_bf16 v[0:15], a[192:195], a[64:67], v[0:15]
  ds_read_b64_tr_b16 a[216:217], v162 offset:49408
  ds_read_b64_tr_b16 a[218:219], v162 offset:51456
  v_mfma_f32_32x32x16_bf16 v[128:143], a[192:195], a[68:71], v[128:143]
  ds_read_b64_tr_b16 a[220:221], v163 offset:49408
  ds_read_b64_tr_b16 a[222:223], v163 offset:51456
  s_waitcnt lgkmcnt(10)
  v_mfma_f32_32x32x16_bf16 v[16:31], a[196:199], a[64:67], v[16:31]
  ds_read_b128 a[72:75], v165 offset:30720
  ds_read_b64_tr_b16 a[224:225], v160 offset:57344
  ds_read_b64_tr_b16 a[226:227], v160 offset:59392
  v_mfma_f32_32x32x16_bf16 v[32:47], a[200:203], a[64:67], v[32:47]
  ds_read_b128 a[76:79], v167 offset:30720
  s_waitcnt lgkmcnt(10)
  v_mfma_f32_32x32x16_bf16 v[48:63], a[204:207], a[64:67], v[48:63]
  ds_read_b64_tr_b16 a[228:229], v161 offset:57344
  ds_read_b64_tr_b16 a[230:231], v161 offset:59392
  v_mfma_f32_32x32x16_bf16 v[64:79], a[208:211], a[64:67], v[64:79]
  ds_read_b64_tr_b16 a[232:233], v162 offset:57344
  ds_read_b64_tr_b16 a[234:235], v162 offset:59392
  s_waitcnt lgkmcnt(12)
  v_mfma_f32_32x32x16_bf16 v[144:159], a[208:211], a[68:71], v[144:159]
  ds_read_b64_tr_b16 a[236:237], v163 offset:57344
  ds_read_b64_tr_b16 a[238:239], v163 offset:59392
  v_mfma_f32_32x32x16_bf16 v[80:95], a[212:215], a[64:67], v[80:95]
  ds_read_b64_tr_b16 a[240:241], v160 offset:57600
  ds_read_b64_tr_b16 a[242:243], v160 offset:59648
  s_waitcnt lgkmcnt(12)
  v_mfma_f32_32x32x16_bf16 v[96:111], a[216:219], a[64:67], v[96:111]
  v_mfma_f32_32x32x16_bf16 v[112:127], a[220:223], a[64:67], v[112:127]
  ds_read_b64_tr_b16 a[244:245], v161 offset:57600
  ds_read_b64_tr_b16 a[246:247], v161 offset:59648
  s_waitcnt lgkmcnt(10)
  v_mfma_f32_32x32x16_bf16 v[0:15], a[224:227], a[72:75], v[0:15]
  ds_read_b64_tr_b16 a[248:249], v162 offset:57600
  ds_read_b64_tr_b16 a[250:251], v162 offset:59648
  v_mfma_f32_32x32x16_bf16 v[128:143], a[224:227], a[76:79], v[128:143]
  ds_read_b64_tr_b16 a[252:253], v163 offset:57600
  ds_read_b64_tr_b16 a[254:255], v163 offset:59648
  s_waitcnt lgkmcnt(10)
  v_mfma_f32_32x32x16_bf16 v[16:31], a[228:231], a[72:75], v[16:31]
  v_mfma_f32_32x32x16_bf16 v[32:47], a[232:235], a[72:75], v[32:47]
  s_waitcnt vmcnt(19)
  s_waitcnt lgkmcnt(0)
  s_barrier
  ds_read_b128 a[80:83], v164 offset:40960
  ds_read_b64_tr_b16 a[192:193], v180
  ds_read_b64_tr_b16 a[194:195], v180 offset:2048
  ds_read_b128 a[84:87], v166 offset:40960
  buffer_load_dword v207, v206, s[96:99], 0 offen sc1
  v_mfma_f32_32x32x16_bf16 v[48:63], a[236:239], a[72:75], v[48:63]
  ds_read_b64_tr_b16 a[196:197], v181
  ds_read_b64_tr_b16 a[198:199], v181 offset:2048
  s_add_u32 m0, s33, 0xc000
  v_mfma_f32_32x32x16_bf16 v[64:79], a[240:243], a[72:75], v[64:79]
  ds_read_b64_tr_b16 a[200:201], v182
  ds_read_b64_tr_b16 a[202:203], v182 offset:2048
  s_add_u32 s74, s33, 0x4000
  v_mfma_f32_32x32x16_bf16 v[144:159], a[240:243], a[76:79], v[144:159]
  ds_read_b64_tr_b16 a[204:205], v183
  ds_read_b64_tr_b16 a[206:207], v183 offset:2048
  buffer_load_dwordx4 v240, s[4:7], s74 offen nt lds
  v_mfma_f32_32x32x16_bf16 v[80:95], a[244:247], a[72:75], v[80:95]
  ds_read_b64_tr_b16 a[208:209], v180 offset:256
  ds_read_b64_tr_b16 a[210:211], v180 offset:2304
  buffer_load_dwordx4 v241, s[4:7], s74 offen offset:1024 nt lds
  v_mfma_f32_32x32x16_bf16 v[96:111], a[248:251], a[72:75], v[96:111]
  buffer_load_dwordx4 v242, s[4:7], s74 offen offset:2048 nt lds
  buffer_load_dwordx4 v243, s[4:7], s74 offen offset:3072 nt lds
  v_mfma_f32_32x32x16_bf16 v[112:127], a[252:255], a[72:75], v[112:127]
  ds_read_b64_tr_b16 a[212:213], v181 offset:256
  ds_read_b64_tr_b16 a[214:215], v181 offset:2304
  s_waitcnt lgkmcnt(10)
  v_mfma_f32_32x32x16_bf16 v[0:15], a[192:195], a[80:83], v[0:15]
  ds_read_b64_tr_b16 a[216:217], v182 offset:256
  ds_read_b64_tr_b16 a[218:219], v182 offset:2304
  v_mfma_f32_32x32x16_bf16 v[128:143], a[192:195], a[84:87], v[128:143]
  ds_read_b64_tr_b16 a[220:221], v183 offset:256
  ds_read_b64_tr_b16 a[222:223], v183 offset:2304
  s_waitcnt lgkmcnt(10)
  v_mfma_f32_32x32x16_bf16 v[16:31], a[196:199], a[80:83], v[16:31]
  ds_read_b128 a[88:91], v165 offset:40960
  ds_read_b64_tr_b16 a[224:225], v180 offset:8192
  ds_read_b64_tr_b16 a[226:227], v180 offset:10240
  v_mfma_f32_32x32x16_bf16 v[32:47], a[200:203], a[80:83], v[32:47]
  ds_read_b128 a[92:95], v167 offset:40960
  s_waitcnt lgkmcnt(10)
  v_mfma_f32_32x32x16_bf16 v[48:63], a[204:207], a[80:83], v[48:63]
  ds_read_b64_tr_b16 a[228:229], v181 offset:8192
  ds_read_b64_tr_b16 a[230:231], v181 offset:10240
  v_mfma_f32_32x32x16_bf16 v[64:79], a[208:211], a[80:83], v[64:79]
  ds_read_b64_tr_b16 a[232:233], v182 offset:8192
  ds_read_b64_tr_b16 a[234:235], v182 offset:10240
  s_waitcnt lgkmcnt(12)
  v_mfma_f32_32x32x16_bf16 v[144:159], a[208:211], a[84:87], v[144:159]
  ds_read_b64_tr_b16 a[236:237], v183 offset:8192
  ds_read_b64_tr_b16 a[238:239], v183 offset:10240
  v_mfma_f32_32x32x16_bf16 v[80:95], a[212:215], a[80:83], v[80:95]
  ds_read_b64_tr_b16 a[240:241], v180 offset:8448
  ds_read_b64_tr_b16 a[242:243], v180 offset:10496
  s_waitcnt lgkmcnt(12)
  v_mfma_f32_32x32x16_bf16 v[96:111], a[216:219], a[80:83], v[96:111]
  v_mfma_f32_32x32x16_bf16 v[112:127], a[220:223], a[80:83], v[112:127]
  ds_read_b64_tr_b16 a[244:245], v181 offset:8448
  ds_read_b64_tr_b16 a[246:247], v181 offset:10496
  s_waitcnt lgkmcnt(10)
  v_mfma_f32_32x32x16_bf16 v[0:15], a[224:227], a[88:91], v[0:15]
  ds_read_b64_tr_b16 a[248:249], v182 offset:8448
  ds_read_b64_tr_b16 a[250:251], v182 offset:10496
  v_mfma_f32_32x32x16_bf16 v[128:143], a[224:227], a[92:95], v[128:143]
  ds_read_b64_tr_b16 a[252:253], v183 offset:8448
  ds_read_b64_tr_b16 a[254:255], v183 offset:10496
  s_waitcnt lgkmcnt(10)
  v_mfma_f32_32x32x16_bf16 v[16:31], a[228:231], a[88:91], v[16:31]
  v_mfma_f32_32x32x16_bf16 v[32:47], a[232:235], a[88:91], v[32:47]
  s_waitcnt vmcnt(19)
  s_waitcnt lgkmcnt(0)
  s_barrier
  ds_read_b128 a[96:99], v164 offset:51200
  ds_read_b64_tr_b16 a[192:193], v180 offset:16384
  ds_read_b64_tr_b16 a[194:195], v180 offset:18432
  ds_read_b128 a[100:103], v166 offset:51200
  v_mfma_f32_32x32x16_bf16 v[48:63], a[236:239], a[88:91], v[48:63]
  ds_read_b64_tr_b16 a[196:197], v181 offset:16384
  ds_read_b64_tr_b16 a[198:199], v181 offset:18432
  s_add_u32 m0, s33, 0x10000
  v_mfma_f32_32x32x16_bf16 v[64:79], a[240:243], a[88:91], v[64:79]
  ds_read_b64_tr_b16 a[200:201], v182 offset:16384
  ds_read_b64_tr_b16 a[202:203], v182 offset:18432
  s_add_u32 s75, s33, 0x8000
  v_mfma_f32_32x32x16_bf16 v[144:159], a[240:243], a[92:95], v[144:159]
  ds_read_b64_tr_b16 a[204:205], v183 offset:16384
  ds_read_b64_tr_b16 a[206:207], v183 offset:18432
  buffer_load_dwordx4 v240, s[4:7], s75 offen nt lds
  v_mfma_f32_32x32x16_bf16 v[80:95], a[244:247], a[88:91], v[80:95]
  ds_read_b64_tr_b16 a[208:209], v180 offset:16640
  ds_read_b64_tr_b16 a[210:211], v180 offset:18688
  buffer_load_dwordx4 v241, s[4:7], s75 offen offset:1024 nt lds
  v_mfma_f32_32x32x16_bf16 v[96:111], a[248:251], a[88:91], v[96:111]
  buffer_load_dwordx4 v242, s[4:7], s75 offen offset:2048 nt lds
  buffer_load_dwordx4 v243, s[4:7], s75 offen offset:3072 nt lds
  v_mfma_f32_32x32x16_bf16 v[112:127], a[252:255], a[88:91], v[112:127]
  ds_read_b64_tr_b16 a[212:213], v181 offset:16640
  ds_read_b64_tr_b16 a[214:215], v181 offset:18688
  s_waitcnt lgkmcnt(10)
  v_mfma_f32_32x32x16_bf16 v[0:15], a[192:195], a[96:99], v[0:15]
  ds_read_b64_tr_b16 a[216:217], v182 offset:16640
  ds_read_b64_tr_b16 a[218:219], v182 offset:18688
  v_mfma_f32_32x32x16_bf16 v[128:143], a[192:195], a[100:103], v[128:143]
  ds_read_b64_tr_b16 a[220:221], v183 offset:16640
  ds_read_b64_tr_b16 a[222:223], v183 offset:18688
  s_waitcnt lgkmcnt(10)
  v_mfma_f32_32x32x16_bf16 v[16:31], a[196:199], a[96:99], v[16:31]
  ds_read_b128 a[104:107], v165 offset:51200
  ds_read_b64_tr_b16 a[224:225], v180 offset:24576
  ds_read_b64_tr_b16 a[226:227], v180 offset:26624
  v_mfma_f32_32x32x16_bf16 v[32:47], a[200:203], a[96:99], v[32:47]
  ds_read_b128 a[108:111], v167 offset:51200
  s_waitcnt lgkmcnt(10)
  v_mfma_f32_32x32x16_bf16 v[48:63], a[204:207], a[96:99], v[48:63]
  ds_read_b64_tr_b16 a[228:229], v181 offset:24576
  ds_read_b64_tr_b16 a[230:231], v181 offset:26624
  v_mfma_f32_32x32x16_bf16 v[64:79], a[208:211], a[96:99], v[64:79]
  ds_read_b64_tr_b16 a[232:233], v182 offset:24576
  ds_read_b64_tr_b16 a[234:235], v182 offset:26624
  s_waitcnt lgkmcnt(12)
  v_mfma_f32_32x32x16_bf16 v[144:159], a[208:211], a[100:103], v[144:159]
  ds_read_b64_tr_b16 a[236:237], v183 offset:24576
  ds_read_b64_tr_b16 a[238:239], v183 offset:26624
  v_mfma_f32_32x32x16_bf16 v[80:95], a[212:215], a[96:99], v[80:95]
  ds_read_b64_tr_b16 a[240:241], v180 offset:24832
  ds_read_b64_tr_b16 a[242:243], v180 offset:26880
  s_waitcnt lgkmcnt(12)
  v_mfma_f32_32x32x16_bf16 v[96:111], a[216:219], a[96:99], v[96:111]
  v_mfma_f32_32x32x16_bf16 v[112:127], a[220:223], a[96:99], v[112:127]
  ds_read_b64_tr_b16 a[244:245], v181 offset:24832
  ds_read_b64_tr_b16 a[246:247], v181 offset:26880
  s_waitcnt lgkmcnt(10)
  v_mfma_f32_32x32x16_bf16 v[0:15], a[224:227], a[104:107], v[0:15]
  ds_read_b64_tr_b16 a[248:249], v182 offset:24832
  ds_read_b64_tr_b16 a[250:251], v182 offset:26880
  v_mfma_f32_32x32x16_bf16 v[128:143], a[224:227], a[108:111], v[128:143]
  ds_read_b64_tr_b16 a[252:253], v183 offset:24832
  ds_read_b64_tr_b16 a[254:255], v183 offset:26880
  s_waitcnt lgkmcnt(10)
  v_mfma_f32_32x32x16_bf16 v[16:31], a[228:231], a[104:107], v[16:31]
  v_mfma_f32_32x32x16_bf16 v[32:47], a[232:235], a[104:107], v[32:47]
  s_waitcnt vmcnt(18)
  s_waitcnt vmcnt(13)
  s_cmp_lg_u32 s3, 3
  s_cbranch_scc1 concat_heads__mha_block_cached__mha_block_cached__near_ridge_kernel_go10
  s_waitcnt vmcnt(8)
  v_readfirstlane_b32 s29, v207
  s_nop 1
  s_cmp_ge_u32 s29, 0x100
  s_cbranch_scc0 concat_heads__mha_block_cached__mha_block_cached__near_ridge_kernel_spin10
concat_heads__mha_block_cached__mha_block_cached__near_ridge_kernel_go10:
  s_waitcnt lgkmcnt(0)
concat_heads__mha_block_cached__mha_block_cached__near_ridge_kernel_common:
  s_barrier
  ds_read_b128 a[64:67], v164
  ds_read_b64_tr_b16 a[192:193], v160
  ds_read_b64_tr_b16 a[194:195], v160 offset:2048
  ds_read_b128 a[68:71], v166
  v_mfma_f32_32x32x16_bf16 v[48:63], a[236:239], a[104:107], v[48:63]
  ds_read_b128 a[72:75], v165
  ds_read_b64_tr_b16 a[196:197], v160 offset:8192
  ds_read_b64_tr_b16 a[198:199], v160 offset:10240
  s_add_u32 m0, s33, 0x14000
  v_mfma_f32_32x32x16_bf16 v[64:79], a[240:243], a[104:107], v[64:79]
  ds_read_b128 a[76:79], v167
  s_add_u32 s74, s33, 0xc000
  v_mfma_f32_32x32x16_bf16 v[144:159], a[240:243], a[108:111], v[144:159]
  ds_read_b128 a[80:83], v164 offset:10240
  ds_read_b64_tr_b16 a[200:201], v160 offset:16384
  ds_read_b64_tr_b16 a[202:203], v160 offset:18432
  buffer_load_dwordx4 v240, s[4:7], s74 offen nt lds
  v_mfma_f32_32x32x16_bf16 v[80:95], a[244:247], a[104:107], v[80:95]
  ds_read_b128 a[84:87], v166 offset:10240
  buffer_load_dwordx4 v241, s[4:7], s74 offen offset:1024 nt lds
  v_mfma_f32_32x32x16_bf16 v[96:111], a[248:251], a[104:107], v[96:111]
  ds_read_b128 a[88:91], v165 offset:10240
  ds_read_b64_tr_b16 a[204:205], v160 offset:24576
  ds_read_b64_tr_b16 a[206:207], v160 offset:26624
  buffer_load_dwordx4 v242, s[4:7], s74 offen offset:2048 nt lds
  v_mfma_f32_32x32x16_bf16 v[112:127], a[252:255], a[104:107], v[112:127]
  ds_read_b128 a[92:95], v167 offset:10240
  buffer_load_dwordx4 v243, s[4:7], s74 offen offset:3072 nt lds
  s_waitcnt lgkmcnt(12)
  v_mfma_f32_32x32x16_bf16 v[0:15], a[192:195], a[64:67], v[0:15]
  ds_read_b64_tr_b16 a[208:209], v161
  ds_read_b64_tr_b16 a[210:211], v161 offset:2048
  s_add_u32 m0, s33, 0x24000
  v_mfma_f32_32x32x16_bf16 v[128:143], a[192:195], a[68:71], v[128:143]
  ds_read_b64_tr_b16 a[212:213], v161 offset:8192
  ds_read_b64_tr_b16 a[214:215], v161 offset:10240
  s_add_u32 s75, s33, 0x10000
  s_waitcnt lgkmcnt(12)
  v_mfma_f32_32x32x16_bf16 v[0:15], a[196:199], a[72:75], v[0:15]
  ds_read_b64_tr_b16 a[216:217], v161 offset:16384
  ds_read_b64_tr_b16 a[218:219], v161 offset:18432
  buffer_load_dwordx4 v240, s[4:7], s75 offen nt lds
  v_mfma_f32_32x32x16_bf16 v[128:143], a[196:199], a[76:79], v[128:143]
  ds_read_b64_tr_b16 a[220:221], v161 offset:24576
  ds_read_b64_tr_b16 a[222:223], v161 offset:26624
  buffer_load_dwordx4 v241, s[4:7], s75 offen offset:1024 nt lds
  s_waitcnt lgkmcnt(12)
  v_mfma_f32_32x32x16_bf16 v[0:15], a[200:203], a[80:83], v[0:15]
  ds_read_b64_tr_b16 a[224:225], v162
  ds_read_b64_tr_b16 a[226:227], v162 offset:2048
  buffer_load_dwordx4 v242, s[4:7], s75 offen offset:2048 nt lds
  v_mfma_f32_32x32x16_bf16 v[128:143], a[200:203], a[84:87], v[128:143]
  ds_read_b64_tr_b16 a[228:229], v162 offset:8192
  ds_read_b64_tr_b16 a[230:231], v162 offset:10240
  buffer_load_dwordx4 v243, s[4:7], s75 offen offset:3072 nt lds
  s_waitcnt lgkmcnt(12)
  v_mfma_f32_32x32x16_bf16 v[0:15], a[204:207], a[88:91], v[0:15]
  ds_read_b64_tr_b16 a[232:233], v162 offset:16384
  ds_read_b64_tr_b16 a[234:235], v162 offset:18432
  v_mfma_f32_32x32x16_bf16 v[128:143], a[204:207], a[92:95], v[128:143]
  ds_read_b64_tr_b16 a[236:237], v162 offset:24576
  ds_read_b64_tr_b16 a[238:239], v162 offset:26624
  s_waitcnt lgkmcnt(12)
  v_mfma_f32_32x32x16_bf16 v[16:31], a[208:211], a[64:67], v[16:31]
  ds_read_b64_tr_b16 a[240:241], v163
  ds_read_b64_tr_b16 a[242:243], v163 offset:2048
  v_mfma_f32_32x32x16_bf16 v[16:31], a[212:215], a[72:75], v[16:31]
  ds_read_b64_tr_b16 a[244:245], v163 offset:8192
  ds_read_b64_tr_b16 a[246:247], v163 offset:10240
  v_mul_f32 v0, s73, v0
  v_mul_f32 v1, s73, v1
  v_mul_f32 v2, s73, v2
  v_mul_f32 v3, s73, v3
  s_waitcnt lgkmcnt(12)
  v_mfma_f32_32x32x16_bf16 v[16:31], a[216:219], a[80:83], v[16:31]
  ds_read_b64_tr_b16 a[248:249], v163 offset:16384
  ds_read_b64_tr_b16 a[250:251], v163 offset:18432
  v_mul_f32 v4, s73, v4
  v_mul_f32 v5, s73, v5
  v_mul_f32 v6, s73, v6
  v_mul_f32 v7, s73, v7
  v_mfma_f32_32x32x16_bf16 v[16:31], a[220:223], a[88:91], v[16:31]
  ds_read_b64_tr_b16 a[252:253], v163 offset:24576
  ds_read_b64_tr_b16 a[254:255], v163 offset:26624
  v_cvt_pk_bf16_f32 v186, v0, v1
  v_cvt_pk_bf16_f32 v187, v2, v3
  v_cvt_pk_bf16_f32 v188, v4, v5
  v_cvt_pk_bf16_f32 v189, v6, v7
  s_waitcnt lgkmcnt(12)
  v_mfma_f32_32x32x16_bf16 v[32:47], a[224:227], a[64:67], v[32:47]
  ds_read_b64_tr_b16 a[192:193], v160 offset:256
  ds_read_b64_tr_b16 a[194:195], v160 offset:2304
  v_accvgpr_write_b32 a0, v186
  v_accvgpr_write_b32 a1, v187
  v_accvgpr_write_b32 a2, v188
  v_accvgpr_write_b32 a3, v189
  v_mfma_f32_32x32x16_bf16 v[32:47], a[228:231], a[72:75], v[32:47]
  v_mul_f32 v8, s73, v8
  v_mul_f32 v9, s73, v9
  v_mul_f32 v10, s73, v10
  v_mul_f32 v11, s73, v11
  v_mul_f32 v12, s73, v12
  v_mul_f32 v13, s73, v13
  s_waitcnt lgkmcnt(10)
  v_mfma_f32_32x32x16_bf16 v[32:47], a[232:235], a[80:83], v[32:47]
  ds_read_b64_tr_b16 a[196:197], v160 offset:8448
  ds_read_b64_tr_b16 a[198:199], v160 offset:10496
  v_mul_f32 v14, s73, v14
  v_mul_f32 v15, s73, v15
  v_cvt_pk_bf16_f32 v190, v8, v9
  v_cvt_pk_bf16_f32 v191, v10, v11
  v_mfma_f32_32x32x16_bf16 v[32:47], a[236:239], a[88:91], v[32:47]
  v_cvt_pk_bf16_f32 v192, v12, v13
  v_cvt_pk_bf16_f32 v193, v14, v15
  v_accvgpr_write_b32 a4, v190
  v_accvgpr_write_b32 a5, v191
  v_accvgpr_write_b32 a6, v192
  v_accvgpr_write_b32 a7, v193
  s_waitcnt lgkmcnt(8)
  v_mfma_f32_32x32x16_bf16 v[48:63], a[240:243], a[64:67], v[48:63]
  ds_read_b64_tr_b16 a[200:201], v160 offset:16640
  ds_read_b64_tr_b16 a[202:203], v160 offset:18688
  v_mul_f32 v128, s73, v128
  v_mul_f32 v129, s73, v129
  v_mul_f32 v130, s73, v130
  v_mul_f32 v131, s73, v131
  v_mfma_f32_32x32x16_bf16 v[48:63], a[244:247], a[72:75], v[48:63]
  v_mul_f32 v132, s73, v132
  v_mul_f32 v133, s73, v133
  v_mul_f32 v134, s73, v134
  v_mul_f32 v135, s73, v135
  v_cvt_pk_bf16_f32 v186, v128, v129
  v_cvt_pk_bf16_f32 v187, v130, v131
  s_waitcnt lgkmcnt(6)
  v_mfma_f32_32x32x16_bf16 v[48:63], a[248:251], a[80:83], v[48:63]
  ds_read_b64_tr_b16 a[204:205], v160 offset:24832
  ds_read_b64_tr_b16 a[206:207], v160 offset:26880
  v_cvt_pk_bf16_f32 v188, v132, v133
  v_cvt_pk_bf16_f32 v189, v134, v135
  ds_write_b128 v194, v[186:189]
  v_mul_f32 v136, s73, v136
  v_mfma_f32_32x32x16_bf16 v[48:63], a[252:255], a[88:91], v[48:63]
  v_mul_f32 v137, s73, v137
  v_mul_f32 v138, s73, v138
  v_mul_f32 v139, s73, v139
  v_mul_f32 v140, s73, v140
  v_mul_f32 v141, s73, v141
  v_mul_f32 v142, s73, v142
  s_waitcnt lgkmcnt(7)
  v_mfma_f32_32x32x16_bf16 v[64:79], a[192:195], a[64:67], v[64:79]
  ds_read_b64_tr_b16 a[208:209], v161 offset:256
  ds_read_b64_tr_b16 a[210:211], v161 offset:2304
  v_mul_f32 v143, s73, v143
  v_cvt_pk_bf16_f32 v190, v136, v137
  v_cvt_pk_bf16_f32 v191, v138, v139
  v_cvt_pk_bf16_f32 v192, v140, v141
  v_mfma_f32_32x32x16_bf16 v[144:159], a[192:195], a[68:71], v[144:159]
  ds_read_b64_tr_b16 a[212:213], v161 offset:8448
  ds_read_b64_tr_b16 a[214:215], v161 offset:10496
  v_cvt_pk_bf16_f32 v193, v142, v143
  ds_write_b128 v194, v[190:193] offset:1024
  v_mul_f32 v16, s73, v16
  v_mul_f32 v17, s73, v17
  s_waitcnt lgkmcnt(10)
  v_mfma_f32_32x32x16_bf16 v[64:79], a[196:199], a[72:75], v[64:79]
  ds_read_b64_tr_b16 a[216:217], v161 offset:16640
  ds_read_b64_tr_b16 a[218:219], v161 offset:18688
  v_mul_f32 v18, s73, v18
  v_mul_f32 v19, s73, v19
  v_mul_f32 v20, s73, v20
  v_mul_f32 v21, s73, v21
  v_mfma_f32_32x32x16_bf16 v[144:159], a[196:199], a[76:79], v[144:159]
  ds_read_b64_tr_b16 a[220:221], v161 offset:24832
  ds_read_b64_tr_b16 a[222:223], v161 offset:26880
  v_mul_f32 v22, s73, v22
  v_mul_f32 v23, s73, v23
  v_cvt_pk_bf16_f32 v186, v16, v17
  v_cvt_pk_bf16_f32 v187, v18, v19
  s_waitcnt lgkmcnt(12)
  v_mfma_f32_32x32x16_bf16 v[64:79], a[200:203], a[80:83], v[64:79]
  ds_read_b64_tr_b16 a[224:225], v162 offset:256
  ds_read_b64_tr_b16 a[226:227], v162 offset:2304
  v_cvt_pk_bf16_f32 v188, v20, v21
  v_cvt_pk_bf16_f32 v189, v22, v23
  v_accvgpr_write_b32 a8, v186
  v_accvgpr_write_b32 a9, v187
  v_mfma_f32_32x32x16_bf16 v[144:159], a[200:203], a[84:87], v[144:159]
  ds_read_b64_tr_b16 a[228:229], v162 offset:8448
  ds_read_b64_tr_b16 a[230:231], v162 offset:10496
  v_accvgpr_write_b32 a10, v188
  v_accvgpr_write_b32 a11, v189
  v_mul_f32 v24, s73, v24
  v_mul_f32 v25, s73, v25
  s_waitcnt lgkmcnt(14)
  v_mfma_f32_32x32x16_bf16 v[64:79], a[204:207], a[88:91], v[64:79]
  ds_read_b64_tr_b16 a[232:233], v162 offset:16640
  ds_read_b64_tr_b16 a[234:235], v162 offset:18688
  v_mul_f32 v26, s73, v26
  v_mul_f32 v27, s73, v27
  v_mul_f32 v28, s73, v28
  v_mul_f32 v29, s73, v29
  v_mfma_f32_32x32x16_bf16 v[144:159], a[204:207], a[92:95], v[144:159]
  ds_read_b64_tr_b16 a[236:237], v162 offset:24832
  ds_read_b64_tr_b16 a[238:239], v162 offset:26880
  s_waitcnt vmcnt(4)
  s_barrier
  v_add_u32 v232, s36, v232
  v_add_u32 v233, s36, v233
  v_add_u32 v234, s36, v234
  v_add_u32 v235, s36, v235
  v_add_u32 v236, s36, v236
  v_add_u32 v237, s36, v237
  v_add_u32 v238, s36, v238
  v_add_u32 v239, s36, v239
  s_waitcnt lgkmcnt(13)
  v_mfma_f32_32x32x16_bf16 v[80:95], a[208:211], a[64:67], v[80:95]
  ds_read_b64_tr_b16 a[240:241], v163 offset:256
  ds_read_b64_tr_b16 a[242:243], v163 offset:2304
  ds_read_b128 a[128:131], v232
  ds_read_b128 a[132:135], v233
  v_mul_f32 v30, s73, v30
  v_mul_f32 v31, s73, v31
  v_mfma_f32_32x32x16_bf16 v[80:95], a[212:215], a[72:75], v[80:95]
  ds_read_b64_tr_b16 a[244:245], v163 offset:8448
  ds_read_b64_tr_b16 a[246:247], v163 offset:10496
  ds_read_b128 a[136:139], v234
  ds_read_b128 a[140:143], v235
  v_cvt_pk_bf16_f32 v190, v24, v25
  v_cvt_pk_bf16_f32 v191, v26, v27
  s_waitcnt lgkmcnt(15)
  v_mfma_f32_32x32x16_bf16 v[80:95], a[216:219], a[80:83], v[80:95]
  ds_read_b64_tr_b16 a[248:249], v163 offset:16640
  ds_read_b64_tr_b16 a[250:251], v163 offset:18688
  ds_read_b128 a[144:147], v236
  ds_read_b128 a[148:151], v237
  v_cvt_pk_bf16_f32 v192, v28, v29
  v_cvt_pk_bf16_f32 v193, v30, v31
  v_mfma_f32_32x32x16_bf16 v[80:95], a[220:223], a[88:91], v[80:95]
  ds_read_b64_tr_b16 a[252:253], v163 offset:24832
  ds_read_b64_tr_b16 a[254:255], v163 offset:26880
  ds_read_b128 a[152:155], v238
  ds_read_b128 a[156:159], v239
  v_accvgpr_write_b32 a12, v190
  v_accvgpr_write_b32 a13, v191
  s_waitcnt lgkmcnt(15)
  v_mfma_f32_32x32x16_bf16 v[96:111], a[224:227], a[64:67], v[96:111]
  ds_read_b128 a[160:163], v232 offset:256
  ds_read_b128 a[164:167], v233 offset:256
  v_accvgpr_write_b32 a14, v192
  v_accvgpr_write_b32 a15, v193
  v_mul_f32 v32, s73, v32
  v_mul_f32 v33, s73, v33
  v_mfma_f32_32x32x16_bf16 v[96:111], a[228:231], a[72:75], v[96:111]
  s_waitcnt lgkmcnt(0)
  s_barrier
  ds_read_b128 a[168:171], v234 offset:256
  ds_read_b128 a[172:175], v235 offset:256
  v_mul_f32 v34, s73, v34
  v_mul_f32 v35, s73, v35
  v_mfma_f32_32x32x16_bf16 v[96:111], a[232:235], a[80:83], v[96:111]
  ds_read_b128 a[176:179], v236 offset:256
  ds_read_b128 a[180:183], v237 offset:256
  s_add_u32 m0, s33, 0
  v_mul_f32 v36, s73, v36
  v_mul_f32 v37, s73, v37
  v_mul_f32 v38, s73, v38
  v_mfma_f32_32x32x16_bf16 v[96:111], a[236:239], a[88:91], v[96:111]
  ds_read_b128 a[184:187], v238 offset:256
  ds_read_b128 a[188:191], v239 offset:256
  v_mul_f32 v39, s73, v39
  v_cvt_pk_bf16_f32 v186, v32, v33
  v_cvt_pk_bf16_f32 v187, v34, v35
  v_cvt_pk_bf16_f32 v188, v36, v37
  v_mfma_f32_32x32x16_bf16 v[112:127], a[240:243], a[64:67], v[112:127]
  s_add_u32 s74, s33, 0x14000
  v_cvt_pk_bf16_f32 v189, v38, v39
  v_accvgpr_write_b32 a16, v186
  v_accvgpr_write_b32 a17, v187
  v_accvgpr_write_b32 a18, v188
  v_accvgpr_write_b32 a19, v189
  v_mfma_f32_32x32x16_bf16 v[112:127], a[244:247], a[72:75], v[112:127]
  buffer_load_dwordx4 v240, s[4:7], s74 offen nt lds
  v_mul_f32 v40, s73, v40
  v_mul_f32 v41, s73, v41
  v_mul_f32 v42, s73, v42
  v_mul_f32 v43, s73, v43
  v_mul_f32 v44, s73, v44
  v_mfma_f32_32x32x16_bf16 v[112:127], a[248:251], a[80:83], v[112:127]
  buffer_load_dwordx4 v241, s[4:7], s74 offen offset:1024 nt lds
  v_mul_f32 v45, s73, v45
  v_mul_f32 v46, s73, v46
  v_mul_f32 v47, s73, v47
  v_cvt_pk_bf16_f32 v190, v40, v41
  v_cvt_pk_bf16_f32 v191, v42, v43
  v_mfma_f32_32x32x16_bf16 v[112:127], a[252:255], a[88:91], v[112:127]
  s_waitcnt lgkmcnt(0)
  v_cvt_pk_bf16_f32 v192, v44, v45
  v_cvt_pk_bf16_f32 v193, v46, v47
  v_accvgpr_write_b32 a20, v190
  v_accvgpr_write_b32 a21, v191
  v_accvgpr_write_b32 a22, v192
  v_mfma_f32_32x32x16_bf16 v[160:175], a[128:131], a[0:3], 0
  buffer_load_dwordx4 v242, s[4:7], s74 offen offset:2048 nt lds
  v_accvgpr_write_b32 a23, v193
  v_mul_f32 v144, s73, v144
  v_mul_f32 v145, s73, v145
  v_mul_f32 v146, s73, v146
  v_mul_f32 v147, s73, v147
  v_mfma_f32_32x32x16_bf16 v[160:175], a[132:135], a[4:7], v[160:175]
  buffer_load_dwordx4 v243, s[4:7], s74 offen offset:3072 nt lds
  v_mul_f32 v148, s73, v148
  v_mul_f32 v149, s73, v149
  v_mul_f32 v150, s73, v150
  v_mul_f32 v151, s73, v151
  v_cvt_pk_bf16_f32 v186, v144, v145
  v_mfma_f32_32x32x16_bf16 v[160:175], a[136:139], a[8:11], v[160:175]
  s_add_u32 m0, s33, 0x4000
  v_cvt_pk_bf16_f32 v187, v146, v147
  v_cvt_pk_bf16_f32 v188, v148, v149
  v_cvt_pk_bf16_f32 v189, v150, v151
  ds_write_b128 v194, v[186:189] offset:8192
  v_mul_f32 v152, s73, v152
  v_mov_b32 v244, 0
  v_mov_b32 v245, 0
  v_mov_b32 v248, 0
  v_mov_b32 v249, 0
  v_mfma_f32_32x32x16_bf16 v[160:175], a[140:143], a[12:15], v[160:175]
  v_mul_f32 v153, s73, v153
  v_mul_f32 v154, s73, v154
  v_mul_f32 v155, s73, v155
  v_mul_f32 v156, s73, v156
  v_mul_f32 v157, s73, v157
  v_mul_f32 v158, s73, v158
  v_mfma_f32_32x32x16_bf16 v[160:175], a[144:147], a[16:19], v[160:175]
  s_add_u32 s75, s33, 0x18000
  v_mul_f32 v159, s73, v159
  v_cvt_pk_bf16_f32 v190, v152, v153
  v_cvt_pk_bf16_f32 v191, v154, v155
  v_cvt_pk_bf16_f32 v192, v156, v157
  v_cvt_pk_bf16_f32 v193, v158, v159
  ds_write_b128 v194, v[190:193] offset:9216
  v_mfma_f32_32x32x16_bf16 v[160:175], a[148:151], a[20:23], v[160:175]
  buffer_load_dwordx4 v240, s[4:7], s75 offen nt lds
  v_mul_f32 v48, s73, v48
  v_mul_f32 v49, s73, v49
  v_mul_f32 v50, s73, v50
  v_mul_f32 v51, s73, v51
  v_mul_f32 v52, s73, v52
  v_mul_f32 v53, s73, v53
  v_mul_f32 v54, s73, v54
  v_mul_f32 v55, s73, v55
  v_cvt_pk_bf16_f32 v186, v48, v49
  v_cvt_pk_bf16_f32 v187, v50, v51
  v_cvt_pk_bf16_f32 v188, v52, v53
  v_cvt_pk_bf16_f32 v189, v54, v55
  v_accvgpr_write_b32 a24, v186
  v_accvgpr_write_b32 a25, v187
  v_accvgpr_write_b32 a26, v188
  v_accvgpr_write_b32 a27, v189
  v_mul_f32 v56, s73, v56
  v_mul_f32 v57, s73, v57
  v_mul_f32 v58, s73, v58
  v_mul_f32 v59, s73, v59
  v_mul_f32 v60, s73, v60
  v_mul_f32 v61, s73, v61
  v_mul_f32 v62, s73, v62
  v_mul_f32 v63, s73, v63
  v_cvt_pk_bf16_f32 v190, v56, v57
  v_cvt_pk_bf16_f32 v191, v58, v59
  v_cvt_pk_bf16_f32 v192, v60, v61
  v_cvt_pk_bf16_f32 v193, v62, v63
  v_accvgpr_write_b32 a28, v190
  v_accvgpr_write_b32 a29, v191
  v_accvgpr_write_b32 a30, v192
  v_accvgpr_write_b32 a31, v193
  s_waitcnt lgkmcnt(0)
  s_barrier
  v_mfma_f32_32x32x16_bf16 v[160:175], a[152:155], a[24:27], v[160:175]
  buffer_load_dwordx4 v241, s[4:7], s75 offen offset:1024 nt lds
  v_mul_f32 v64, s73, v64
  v_mul_f32 v65, s73, v65
  v_mul_f32 v66, s73, v66
  v_mul_f32 v67, s73, v67
  v_mul_f32 v68, s73, v68
  ds_read_b128 a[64:67], v195
  ds_read_b128 a[68:71], v195 offset:1024
  v_mfma_f32_32x32x16_bf16 v[160:175], a[156:159], a[28:31], v[160:175]
  v_mul_f32 v69, s73, v69
  v_mul_f32 v70, s73, v70
  v_mul_f32 v71, s73, v71
  v_cvt_pk_bf16_f32 v186, v64, v65
  v_cvt_pk_bf16_f32 v187, v66, v67
  v_cvt_pk_bf16_f32 v188, v68, v69
  v_cvt_pk_bf16_f32 v189, v70, v71
  v_accvgpr_write_b32 a32, v186
  v_accvgpr_write_b32 a33, v187
  v_accvgpr_write_b32 a34, v188
  v_accvgpr_write_b32 a35, v189
  v_mul_f32 v72, s73, v72
  v_mul_f32 v73, s73, v73
  v_mul_f32 v74, s73, v74
  v_mul_f32 v75, s73, v75
  v_mul_f32 v76, s73, v76
  v_mul_f32 v77, s73, v77
  v_mul_f32 v78, s73, v78
  v_mul_f32 v79, s73, v79
  v_cvt_pk_bf16_f32 v190, v72, v73
  v_cvt_pk_bf16_f32 v191, v74, v75
  v_cvt_pk_bf16_f32 v192, v76, v77
  v_cvt_pk_bf16_f32 v193, v78, v79
  v_accvgpr_write_b32 a36, v190
  v_accvgpr_write_b32 a37, v191
  v_accvgpr_write_b32 a38, v192
  v_accvgpr_write_b32 a39, v193
  ds_read_b128 a[96:99], v195 offset:8192
  ds_read_b128 a[100:103], v195 offset:9216
  v_mfma_f32_32x32x16_bf16 v[160:175], a[160:163], a[32:35], v[160:175]
  buffer_load_dwordx4 v242, s[4:7], s75 offen offset:2048 nt lds
  v_mul_f32 v80, s73, v80
  v_mul_f32 v81, s73, v81
  v_mul_f32 v82, s73, v82
  v_mul_f32 v83, s73, v83
  v_mul_f32 v84, s73, v84
  ds_read_b128 a[72:75], v196
  ds_read_b128 a[76:79], v196 offset:1024
  v_mfma_f32_32x32x16_bf16 v[160:175], a[164:167], a[36:39], v[160:175]
  buffer_load_dwordx4 v243, s[4:7], s75 offen offset:3072 nt lds
  v_mul_f32 v85, s73, v85
  v_mul_f32 v86, s73, v86
  v_mul_f32 v87, s73, v87
  v_cvt_pk_bf16_f32 v186, v80, v81
  v_cvt_pk_bf16_f32 v187, v82, v83
  v_cvt_pk_bf16_f32 v188, v84, v85
  v_cvt_pk_bf16_f32 v189, v86, v87
  v_accvgpr_write_b32 a40, v186
  v_accvgpr_write_b32 a41, v187
  v_accvgpr_write_b32 a42, v188
  v_accvgpr_write_b32 a43, v189
  v_mul_f32 v88, s73, v88
  v_mul_f32 v89, s73, v89
  v_mul_f32 v90, s73, v90
  v_mul_f32 v91, s73, v91
  v_mul_f32 v92, s73, v92
  v_mul_f32 v93, s73, v93
  v_mul_f32 v94, s73, v94
  v_mul_f32 v95, s73, v95
  v_cvt_pk_bf16_f32 v190, v88, v89
  v_cvt_pk_bf16_f32 v191, v90, v91
  v_cvt_pk_bf16_f32 v192, v92, v93
  v_cvt_pk_bf16_f32 v193, v94, v95
  v_accvgpr_write_b32 a44, v190
  v_accvgpr_write_b32 a45, v191
  v_accvgpr_write_b32 a46, v192
  v_accvgpr_write_b32 a47, v193
  ds_read_b128 a[104:107], v196 offset:8192
  ds_read_b128 a[108:111], v196 offset:9216
  v_mfma_f32_32x32x16_bf16 v[160:175], a[168:171], a[40:43], v[160:175]
  v_mul_f32 v96, s73, v96
  v_mul_f32 v97, s73, v97
  v_mul_f32 v98, s73, v98
  v_mul_f32 v99, s73, v99
  v_mul_f32 v100, s73, v100
  v_mul_f32 v101, s73, v101
  ds_read_b128 a[80:83], v197
  v_mfma_f32_32x32x16_bf16 v[160:175], a[172:175], a[44:47], v[160:175]
  v_mul_f32 v102, s73, v102
  v_mul_f32 v103, s73, v103
  v_cvt_pk_bf16_f32 v186, v96, v97
  v_cvt_pk_bf16_f32 v187, v98, v99
  v_cvt_pk_bf16_f32 v188, v100, v101
  v_cvt_pk_bf16_f32 v189, v102, v103
  v_accvgpr_write_b32 a48, v186
  v_accvgpr_write_b32 a49, v187
  v_accvgpr_write_b32 a50, v188
  v_accvgpr_write_b32 a51, v189
  v_mul_f32 v104, s73, v104
  v_mul_f32 v105, s73, v105
  v_mul_f32 v106, s73, v106
  v_mul_f32 v107, s73, v107
  v_mul_f32 v108, s73, v108
  v_mul_f32 v109, s73, v109
  v_mul_f32 v110, s73, v110
  v_mul_f32 v111, s73, v111
  v_cvt_pk_bf16_f32 v190, v104, v105
  v_cvt_pk_bf16_f32 v191, v106, v107
  v_cvt_pk_bf16_f32 v192, v108, v109
  v_cvt_pk_bf16_f32 v193, v110, v111
  v_accvgpr_write_b32 a52, v190
  v_accvgpr_write_b32 a53, v191
  v_accvgpr_write_b32 a54, v192
  v_accvgpr_write_b32 a55, v193
  ds_read_b128 a[84:87], v197 offset:1024
  ds_read_b128 a[112:115], v197 offset:8192
  v_mfma_f32_32x32x16_bf16 v[160:175], a[176:179], a[48:51], v[160:175]
  v_mul_f32 v112, s73, v112
  v_mul_f32 v113, s73, v113
  v_mul_f32 v114, s73, v114
  v_mul_f32 v115, s73, v115
  v_mul_f32 v116, s73, v116
  v_mul_f32 v117, s73, v117
  ds_read_b128 a[116:119], v197 offset:9216
  ds_read_b128 a[88:91], v205
  v_mfma_f32_32x32x16_bf16 v[160:175], a[180:183], a[52:55], v[160:175]
  v_mul_f32 v118, s73, v118
  v_mul_f32 v119, s73, v119
  v_cvt_pk_bf16_f32 v186, v112, v113
  v_cvt_pk_bf16_f32 v187, v114, v115
  v_cvt_pk_bf16_f32 v188, v116, v117
  v_cvt_pk_bf16_f32 v189, v118, v119
  v_accvgpr_write_b32 a56, v186
  v_accvgpr_write_b32 a57, v187
  v_accvgpr_write_b32 a58, v188
  v_accvgpr_write_b32 a59, v189
  v_mul_f32 v120, s73, v120
  v_mul_f32 v121, s73, v121
  v_mul_f32 v122, s73, v122
  v_mul_f32 v123, s73, v123
  v_mul_f32 v124, s73, v124
  v_mul_f32 v125, s73, v125
  v_mul_f32 v126, s73, v126
  v_mul_f32 v127, s73, v127
  v_cvt_pk_bf16_f32 v190, v120, v121
  v_cvt_pk_bf16_f32 v191, v122, v123
  v_cvt_pk_bf16_f32 v192, v124, v125
  v_cvt_pk_bf16_f32 v193, v126, v127
  v_accvgpr_write_b32 a60, v190
  v_accvgpr_write_b32 a61, v191
  v_accvgpr_write_b32 a62, v192
  v_accvgpr_write_b32 a63, v193
  ds_read_b128 a[92:95], v205 offset:1024
  ds_read_b128 a[120:123], v205 offset:8192
  v_mfma_f32_32x32x16_bf16 v[160:175], a[184:187], a[56:59], v[160:175]
  ds_read_b128 a[124:127], v205 offset:9216
  v_mfma_f32_32x32x16_bf16 v[160:175], a[188:191], a[60:63], v[160:175]
concat_heads__mha_block_cached__mha_block_cached__near_ridge_kernel_ph1:
  s_waitcnt lgkmcnt(0)
  v_mfma_f32_32x32x16_bf16 v[176:191], a[128:131], a[64:67], 0
  s_add_u32 m0, s33, 0x18000
  s_add_u32 s74, s33, 0x1c000
  v_add_u32 v232, s37, v232
  v_add_u32 v233, s37, v233
  v_mfma_f32_32x32x16_bf16 v[176:191], a[132:135], a[68:71], v[176:191]
  ds_read_b128 a[192:195], v232
  ds_read_b128 a[196:199], v233
  buffer_load_dwordx4 v240, s[4:7], s74 offen nt lds
  v_add_u32 v234, s37, v234
  v_mfma_f32_32x32x16_bf16 v[176:191], a[136:139], a[72:75], v[176:191]
  ds_read_b128 a[200:203], v234
  buffer_load_dwordx4 v241, s[4:7], s74 offen offset:1024 nt lds
  buffer_load_dwordx4 v242, s[4:7], s74 offen offset:2048 nt lds
  v_max3_f32 v253, v160, v161, v162
  v_max3_f32 v253, v253, v163, v164
  v_max3_f32 v253, v253, v165, v166
  v_max3_f32 v253, v253, v167, v168
  v_add_u32 v235, s37, v235
  v_mfma_f32_32x32x16_bf16 v[176:191], a[140:143], a[76:79], v[176:191]
  ds_read_b128 a[204:207], v235
  buffer_load_dwordx4 v243, s[4:7], s74 offen offset:3072 nt lds
  v_max3_f32 v253, v253, v169, v170
  v_max3_f32 v253, v253, v171, v172
  v_max3_f32 v253, v253, v173, v174
  v_add_u32 v236, s37, v236
  v_add_u32 v237, s37, v237
  v_mfma_f32_32x32x16_bf16 v[176:191], a[144:147], a[80:83], v[176:191]
  ds_read_b128 a[208:211], v236
  ds_read_b128 a[212:215], v237
  v_max_f32 v253, v253, v175
  v_mov_b32 v254, v253
  s_nop 1
  v_permlane32_swap_b32 v253, v254
  v_max_f32 v253, v253, v254
  v_ceil_f32 v253, v253
  v_add_u32 v238, s37, v238
  v_mfma_f32_32x32x16_bf16 v[176:191], a[148:151], a[84:87], v[176:191]
  ds_read_b128 a[216:219], v238
  v_max_f32 v253, v253, v250
  v_sub_f32 v192, 0, v253
  v_sub_f32 v193, 0, v253
  v_sub_f32 v194, 0, v253
  v_sub_f32 v195, 0, v253
  v_sub_f32 v196, 0, v253
  v_sub_f32 v197, 0, v253
  v_add_u32 v239, s37, v239
  v_mfma_f32_32x32x16_bf16 v[176:191], a[152:155], a[88:91], v[176:191]
  ds_read_b128 a[220:223], v239
  v_sub_f32 v198, 0, v253
  v_sub_f32 v199, 0, v253
  v_sub_f32 v200, 0, v253
  v_sub_f32 v201, 0, v253
  v_sub_f32 v202, 0, v253
  v_sub_f32 v203, 0, v253
  v_sub_f32 v204, 0, v253
  v_sub_f32 v205, 0, v253
  v_sub_f32 v206, 0, v253
  v_mfma_f32_32x32x16_bf16 v[176:191], a[156:159], a[92:95], v[176:191]
  ds_read_b128 a[224:227], v232 offset:256
  ds_read_b128 a[228:231], v233 offset:256
  v_sub_f32 v207, 0, v253
  v_add_f32 v160, v160, v192
  v_add_f32 v161, v161, v192
  v_add_f32 v162, v162, v192
  v_add_f32 v163, v163, v192
  v_add_f32 v164, v164, v192
  v_add_f32 v165, v165, v192
  v_add_f32 v166, v166, v192
  v_mfma_f32_32x32x16_bf16 v[176:191], a[160:163], a[96:99], v[176:191]
  ds_read_b128 a[232:235], v234 offset:256
  v_add_f32 v167, v167, v192
  v_add_f32 v168, v168, v192
  v_add_f32 v169, v169, v192
  v_add_f32 v170, v170, v192
  v_add_f32 v171, v171, v192
  v_add_f32 v172, v172, v192
  v_add_f32 v173, v173, v192
  v_add_f32 v174, v174, v192
  v_add_f32 v175, v175, v192
  v_mfma_f32_32x32x16_bf16 v[176:191], a[164:167], a[100:103], v[176:191]
  ds_read_b128 a[236:239], v235 offset:256
  v_exp_f32 v224, v160
  v_exp_f32 v225, v161
  v_exp_f32 v226, v162
  v_exp_f32 v227, v163
  v_add_f32 v246, v224, v225
  v_mfma_f32_32x32x16_bf16 v[176:191], a[168:171], a[104:107], v[176:191]
  ds_read_b128 a[240:243], v236 offset:256
  ds_read_b128 a[244:247], v237 offset:256
  v_cvt_pk_bf16_f32 v0, v224, v225
  v_exp_f32 v228, v164
  v_exp_f32 v229, v165
  v_add_f32 v247, v226, v227
  v_cvt_pk_bf16_f32 v1, v226, v227
  v_mfma_f32_32x32x16_bf16 v[176:191], a[172:175], a[108:111], v[176:191]
  ds_read_b128 a[248:251], v238 offset:256
  v_exp_f32 v230, v166
  v_exp_f32 v231, v167
  v_add_f32 v246, v246, v228
  v_add_f32 v247, v247, v229
  v_cvt_pk_bf16_f32 v2, v228, v229
  v_exp_f32 v224, v168
  v_mfma_f32_32x32x16_bf16 v[176:191], a[176:179], a[112:115], v[176:191]
  ds_read_b128 a[252:255], v239 offset:256
  v_exp_f32 v225, v169
  v_add_f32 v246, v246, v230
  v_add_f32 v247, v247, v231
  v_cvt_pk_bf16_f32 v3, v230, v231
  v_exp_f32 v226, v170
  v_exp_f32 v227, v171
  v_add_f32 v246, v246, v224
  v_mfma_f32_32x32x16_bf16 v[176:191], a[180:183], a[116:119], v[176:191]
  v_add_f32 v247, v247, v225
  v_cvt_pk_bf16_f32 v4, v224, v225
  v_exp_f32 v228, v172
  v_exp_f32 v229, v173
  v_add_f32 v246, v246, v226
  v_add_f32 v247, v247, v227
  v_cvt_pk_bf16_f32 v5, v226, v227
  v_exp_f32 v230, v174
  v_mfma_f32_32x32x16_bf16 v[176:191], a[184:187], a[120:123], v[176:191]
  v_exp_f32 v231, v175
  v_add_f32 v246, v246, v228
  v_add_f32 v247, v247, v229
  v_cvt_pk_bf16_f32 v6, v228, v229
  v_add_f32 v246, v246, v230
  v_add_f32 v247, v247, v231
  v_cvt_pk_bf16_f32 v7, v230, v231
  v_add_f32 v246, v246, v247
  v_cmp_lt_f32 vcc, s62, v246
  v_add_f32 v244, v244, v246
  v_mfma_f32_32x32x16_bf16 v[176:191], a[188:191], a[124:127], v[176:191]
  s_cbranch_vccnz concat_heads__mha_block_cached__mha_block_cached__near_ridge_kernel_rare0
concat_heads__mha_block_cached__mha_block_cached__near_ridge_kernel_back0:
  s_waitcnt lgkmcnt(0)
  v_mfma_f32_32x32x16_bf16 v[160:175], a[192:195], a[0:3], v[192:207]
  s_add_u32 m0, s33, 0x1c000
  s_add_u32 s75, s33, 0x20000
  v_add_u32 v232, s38, v232
  v_add_u32 v233, s38, v233
  v_mfma_f32_32x32x16_bf16 v[160:175], a[196:199], a[4:7], v[160:175]
  ds_read_b128 a[128:131], v232
  ds_read_b128 a[132:135], v233
  buffer_load_dwordx4 v240, s[4:7], s75 offen nt lds
  v_add_u32 v234, s38, v234
  v_mfma_f32_32x32x16_bf16 v[160:175], a[200:203], a[8:11], v[160:175]
  ds_read_b128 a[136:139], v234
  buffer_load_dwordx4 v241, s[4:7], s75 offen offset:1024 nt lds
  buffer_load_dwordx4 v242, s[4:7], s75 offen offset:2048 nt lds
  v_max3_f32 v253, v176, v177, v178
  v_max3_f32 v253, v253, v179, v180
  v_max3_f32 v253, v253, v181, v182
  v_max3_f32 v253, v253, v183, v184
  v_add_u32 v235, s38, v235
  v_mfma_f32_32x32x16_bf16 v[160:175], a[204:207], a[12:15], v[160:175]
  ds_read_b128 a[140:143], v235
  buffer_load_dwordx4 v243, s[4:7], s75 offen offset:3072 nt lds
  v_max3_f32 v253, v253, v185, v186
  v_max3_f32 v253, v253, v187, v188
  v_max3_f32 v253, v253, v189, v190
  v_add_u32 v236, s38, v236
  v_add_u32 v237, s38, v237
  v_mfma_f32_32x32x16_bf16 v[160:175], a[208:211], a[16:19], v[160:175]
  ds_read_b128 a[144:147], v236
  ds_read_b128 a[148:151], v237
  v_max_f32 v253, v253, v191
  v_mov_b32 v254, v253
  s_nop 1
  v_permlane32_swap_b32 v253, v254
  v_max_f32 v253, v253, v254
  v_ceil_f32 v253, v253
  v_add_u32 v238, s38, v238
  v_mfma_f32_32x32x16_bf16 v[160:175], a[212:215], a[20:23], v[160:175]
  ds_read_b128 a[152:155], v238
  v_max_f32 v253, v253, v251
  v_sub_f32 v208, 0, v253
  v_sub_f32 v209, 0, v253
  v_sub_f32 v210, 0, v253
  v_sub_f32 v211, 0, v253
  v_sub_f32 v212, 0, v253
  v_sub_f32 v213, 0, v253
  v_add_u32 v239, s38, v239
  v_mfma_f32_32x32x16_bf16 v[160:175], a[216:219], a[24:27], v[160:175]
  ds_read_b128 a[156:159], v239
  v_sub_f32 v214, 0, v253
  v_sub_f32 v215, 0, v253
  v_sub_f32 v216, 0, v253
  v_sub_f32 v217, 0, v253
  v_sub_f32 v218, 0, v253
  v_sub_f32 v219, 0, v253
  v_sub_f32 v220, 0, v253
  v_sub_f32 v221, 0, v253
  v_sub_f32 v222, 0, v253
  v_mfma_f32_32x32x16_bf16 v[160:175], a[220:223], a[28:31], v[160:175]
  ds_read_b128 a[160:163], v232 offset:256
  ds_read_b128 a[164:167], v233 offset:256
  v_sub_f32 v223, 0, v253
  v_add_f32 v176, v176, v208
  v_add_f32 v177, v177, v208
  v_add_f32 v178, v178, v208
  v_add_f32 v179, v179, v208
  v_add_f32 v180, v180, v208
  v_add_f32 v181, v181, v208
  v_add_f32 v182, v182, v208
  v_mfma_f32_32x32x16_bf16 v[160:175], a[224:227], a[32:35], v[160:175]
  ds_read_b128 a[168:171], v234 offset:256
  v_add_f32 v183, v183, v208
  v_add_f32 v184, v184, v208
  v_add_f32 v185, v185, v208
  v_add_f32 v186, v186, v208
  v_add_f32 v187, v187, v208
  v_add_f32 v188, v188, v208
  v_add_f32 v189, v189, v208
  v_add_f32 v190, v190, v208
  v_add_f32 v191, v191, v208
  v_mfma_f32_32x32x16_bf16 v[160:175], a[228:231], a[36:39], v[160:175]
  ds_read_b128 a[172:175], v235 offset:256
  v_exp_f32 v224, v176
  v_exp_f32 v225, v177
  v_exp_f32 v226, v178
  v_exp_f32 v227, v179
  v_add_f32 v246, v224, v225
  v_mfma_f32_32x32x16_bf16 v[160:175], a[232:235], a[40:43], v[160:175]
  ds_read_b128 a[176:179], v236 offset:256
  ds_read_b128 a[180:183], v237 offset:256
  v_cvt_pk_bf16_f32 v128, v224, v225
  v_exp_f32 v228, v180
  v_exp_f32 v229, v181
  v_add_f32 v247, v226, v227
  v_cvt_pk_bf16_f32 v129, v226, v227
  v_mfma_f32_32x32x16_bf16 v[160:175], a[236:239], a[44:47], v[160:175]
  ds_read_b128 a[184:187], v238 offset:256
  v_exp_f32 v230, v182
  v_exp_f32 v231, v183
  v_add_f32 v246, v246, v228
  v_add_f32 v247, v247, v229
  v_cvt_pk_bf16_f32 v130, v228, v229
  v_exp_f32 v224, v184
  v_mfma_f32_32x32x16_bf16 v[160:175], a[240:243], a[48:51], v[160:175]
  ds_read_b128 a[188:191], v239 offset:256
  v_exp_f32 v225, v185
  v_add_f32 v246, v246, v230
  v_add_f32 v247, v247, v231
  v_cvt_pk_bf16_f32 v131, v230, v231
  v_exp_f32 v226, v186
  v_exp_f32 v227, v187
  v_add_f32 v246, v246, v224
  v_mfma_f32_32x32x16_bf16 v[160:175], a[244:247], a[52:55], v[160:175]
  v_add_f32 v247, v247, v225
  v_cvt_pk_bf16_f32 v132, v224, v225
  v_exp_f32 v228, v188
  v_exp_f32 v229, v189
  v_add_f32 v246, v246, v226
  v_add_f32 v247, v247, v227
  v_cvt_pk_bf16_f32 v133, v226, v227
  v_exp_f32 v230, v190
  v_mfma_f32_32x32x16_bf16 v[160:175], a[248:251], a[56:59], v[160:175]
  v_exp_f32 v231, v191
  v_add_f32 v246, v246, v228
  v_add_f32 v247, v247, v229
  v_cvt_pk_bf16_f32 v134, v228, v229
  v_add_f32 v246, v246, v230
  v_add_f32 v247, v247, v231
  v_cvt_pk_bf16_f32 v135, v230, v231
  v_add_f32 v246, v246, v247
  v_cmp_lt_f32 vcc, s62, v246
  v_add_f32 v245, v245, v246
  v_mfma_f32_32x32x16_bf16 v[160:175], a[252:255], a[60:63], v[160:175]
  s_cbranch_vccnz concat_heads__mha_block_cached__mha_block_cached__near_ridge_kernel_rare1
concat_heads__mha_block_cached__mha_block_cached__near_ridge_kernel_back1:
  s_waitcnt lgkmcnt(0)
  v_mfma_f32_32x32x16_bf16 v[176:191], a[128:131], a[0:3], v[192:207]
  v_add_u32 v232, s39, v232
  v_add_u32 v233, s39, v233
  v_mfma_f32_32x32x16_bf16 v[176:191], a[132:135], a[4:7], v[176:191]
  ds_read_b128 a[192:195], v232
  ds_read_b128 a[196:199], v233
  v_add_u32 v234, s39, v234
  v_mfma_f32_32x32x16_bf16 v[176:191], a[136:139], a[8:11], v[176:191]
  ds_read_b128 a[200:203], v234
  s_nop 0
  v_exp_f32 v224, v160
  v_exp_f32 v225, v161
  v_add_u32 v235, s39, v235
  v_mfma_f32_32x32x16_bf16 v[176:191], a[140:143], a[12:15], v[176:191]
  ds_read_b128 a[204:207], v235
  v_exp_f32 v226, v162
  v_add_u32 v236, s39, v236
  v_add_u32 v237, s39, v237
  v_mfma_f32_32x32x16_bf16 v[176:191], a[144:147], a[16:19], v[176:191]
  ds_read_b128 a[208:211], v236
  ds_read_b128 a[212:215], v237
  v_exp_f32 v227, v163
  v_add_f32 v246, v224, v225
  v_cvt_pk_bf16_f32 v8, v224, v225
  v_add_u32 v238, s39, v238
  v_mfma_f32_32x32x16_bf16 v[176:191], a[148:151], a[20:23], v[176:191]
  ds_read_b128 a[216:219], v238
  v_exp_f32 v228, v164
  v_exp_f32 v229, v165
  v_add_u32 v239, s39, v239
  v_mfma_f32_32x32x16_bf16 v[176:191], a[152:155], a[24:27], v[176:191]
  ds_read_b128 a[220:223], v239
  v_add_f32 v247, v226, v227
  v_cvt_pk_bf16_f32 v9, v226, v227
  v_exp_f32 v230, v166
  v_mfma_f32_32x32x16_bf16 v[176:191], a[156:159], a[28:31], v[176:191]
  ds_read_b128 a[224:227], v232 offset:256
  ds_read_b128 a[228:231], v233 offset:256
  v_exp_f32 v231, v167
  v_add_f32 v246, v246, v228
  v_add_f32 v247, v247, v229
  v_mfma_f32_32x32x16_bf16 v[176:191], a[160:163], a[32:35], v[176:191]
  ds_read_b128 a[232:235], v234 offset:256
  v_cvt_pk_bf16_f32 v10, v228, v229
  v_exp_f32 v224, v168
  v_exp_f32 v225, v169
  v_mfma_f32_32x32x16_bf16 v[176:191], a[164:167], a[36:39], v[176:191]
  ds_read_b128 a[236:239], v235 offset:256
  v_add_f32 v246, v246, v230
  v_add_f32 v247, v247, v231
  v_cvt_pk_bf16_f32 v11, v230, v231
  v_exp_f32 v226, v170
  v_mfma_f32_32x32x16_bf16 v[176:191], a[168:171], a[40:43], v[176:191]
  ds_read_b128 a[240:243], v236 offset:256
  ds_read_b128 a[244:247], v237 offset:256
  v_exp_f32 v227, v171
  v_add_f32 v246, v246, v224
  v_add_f32 v247, v247, v225
  v_mfma_f32_32x32x16_bf16 v[176:191], a[172:175], a[44:47], v[176:191]
  ds_read_b128 a[248:251], v238 offset:256
  v_cvt_pk_bf16_f32 v12, v224, v225
  v_exp_f32 v228, v172
  v_exp_f32 v229, v173
  v_mfma_f32_32x32x16_bf16 v[176:191], a[176:179], a[48:51], v[176:191]
  ds_read_b128 a[252:255], v239 offset:256
  v_add_f32 v246, v246, v226
  v_add_f32 v247, v247, v227
  v_cvt_pk_bf16_f32 v13, v226, v227
  v_exp_f32 v230, v174
  v_mfma_f32_32x32x16_bf16 v[176:191], a[180:183], a[52:55], v[176:191]
  v_exp_f32 v231, v175
  v_add_f32 v246, v246, v228
  v_add_f32 v247, v247, v229
  v_cvt_pk_bf16_f32 v14, v228, v229
  v_mfma_f32_32x32x16_bf16 v[176:191], a[184:187], a[56:59], v[176:191]
  v_add_f32 v246, v246, v230
  v_add_f32 v247, v247, v231
  v_cvt_pk_bf16_f32 v15, v230, v231
  v_add_f32 v246, v246, v247
  v_cmp_lt_f32 vcc, s62, v246
  v_add_f32 v244, v244, v246
  v_mfma_f32_32x32x16_bf16 v[176:191], a[188:191], a[60:63], v[176:191]
  s_cbranch_vccnz concat_heads__mha_block_cached__mha_block_cached__near_ridge_kernel_rare2
concat_heads__mha_block_cached__mha_block_cached__near_ridge_kernel_back2:
  s_waitcnt lgkmcnt(0)
  s_waitcnt vmcnt(4)
  s_barrier
  v_mfma_f32_32x32x16_bf16 v[160:175], a[192:195], a[0:3], v[192:207]
  s_add_u32 m0, s33, 0x8000
  s_add_u32 s74, s33, 0x24000
  v_add_u32 v232, s40, v232
  v_add_u32 v233, s40, v233
  v_mfma_f32_32x32x16_bf16 v[160:175], a[196:199], a[4:7], v[160:175]
  ds_read_b128 a[128:131], v232
  ds_read_b128 a[132:135], v233
  buffer_load_dwordx4 v240, s[4:7], s74 offen nt lds
  v_add_u32 v234, s40, v234
  v_mfma_f32_32x32x16_bf16 v[160:175], a[200:203], a[8:11], v[160:175]
  ds_read_b128 a[136:139], v234
  buffer_load_dwordx4 v241, s[4:7], s74 offen offset:1024 nt lds
  buffer_load_dwordx4 v242, s[4:7], s74 offen offset:2048 nt lds
  v_exp_f32 v224, v176
  v_add_u32 v235, s40, v235
  v_mfma_f32_32x32x16_bf16 v[160:175], a[204:207], a[12:15], v[160:175]
  ds_read_b128 a[140:143], v235
  buffer_load_dwordx4 v243, s[4:7], s74 offen offset:3072 nt lds
  v_exp_f32 v225, v177
  v_add_u32 v236, s40, v236
  v_add_u32 v237, s40, v237
  v_mfma_f32_32x32x16_bf16 v[160:175], a[208:211], a[16:19], v[160:175]
  ds_read_b128 a[144:147], v236
  ds_read_b128 a[148:151], v237
  v_exp_f32 v226, v178
  v_exp_f32 v227, v179
  v_add_u32 v238, s40, v238
  v_mfma_f32_32x32x16_bf16 v[160:175], a[212:215], a[20:23], v[160:175]
  ds_read_b128 a[152:155], v238
  v_add_f32 v246, v224, v225
  v_cvt_pk_bf16_f32 v16, v224, v225
  v_exp_f32 v228, v180
  v_add_u32 v239, s40, v239
  v_mfma_f32_32x32x16_bf16 v[160:175], a[216:219], a[24:27], v[160:175]
  ds_read_b128 a[156:159], v239
  v_exp_f32 v229, v181
  v_add_f32 v247, v226, v227
  v_cvt_pk_bf16_f32 v17, v226, v227
  v_mfma_f32_32x32x16_bf16 v[160:175], a[220:223], a[28:31], v[160:175]
  ds_read_b128 a[160:163], v232 offset:256
  ds_read_b128 a[164:167], v233 offset:256
  v_exp_f32 v230, v182
  v_exp_f32 v231, v183
  v_mfma_f32_32x32x16_bf16 v[160:175], a[224:227], a[32:35], v[160:175]
  ds_read_b128 a[168:171], v234 offset:256
  v_add_f32 v246, v246, v228
  v_add_f32 v247, v247, v229
  v_cvt_pk_bf16_f32 v18, v228, v229
  v_exp_f32 v224, v184
  v_mfma_f32_32x32x16_bf16 v[160:175], a[228:231], a[36:39], v[160:175]
  ds_read_b128 a[172:175], v235 offset:256
  v_exp_f32 v225, v185
  v_add_f32 v246, v246, v230
  v_add_f32 v247, v247, v231
  v_cvt_pk_bf16_f32 v19, v230, v231
  v_mfma_f32_32x32x16_bf16 v[160:175], a[232:235], a[40:43], v[160:175]
  ds_read_b128 a[176:179], v236 offset:256
  ds_read_b128 a[180:183], v237 offset:256
  v_exp_f32 v226, v186
  v_exp_f32 v227, v187
  v_add_f32 v246, v246, v224
  v_mfma_f32_32x32x16_bf16 v[160:175], a[236:239], a[44:47], v[160:175]
  ds_read_b128 a[184:187], v238 offset:256
  v_add_f32 v247, v247, v225
  v_cvt_pk_bf16_f32 v20, v224, v225
  v_exp_f32 v228, v188
  v_mfma_f32_32x32x16_bf16 v[160:175], a[240:243], a[48:51], v[160:175]
  ds_read_b128 a[188:191], v239 offset:256
  v_exp_f32 v229, v189
  v_add_f32 v246, v246, v226
  v_add_f32 v247, v247, v227
  v_cvt_pk_bf16_f32 v21, v226, v227
  v_mfma_f32_32x32x16_bf16 v[160:175], a[244:247], a[52:55], v[160:175]
  v_exp_f32 v230, v190
  v_exp_f32 v231, v191
  v_add_f32 v246, v246, v228
  v_add_f32 v247, v247, v229
  v_cvt_pk_bf16_f32 v22, v228, v229
  v_mfma_f32_32x32x16_bf16 v[160:175], a[248:251], a[56:59], v[160:175]
  v_add_f32 v246, v246, v230
  v_add_f32 v247, v247, v231
  v_cvt_pk_bf16_f32 v23, v230, v231
  v_add_f32 v246, v246, v247
  v_cmp_lt_f32 vcc, s62, v246
  v_add_f32 v244, v244, v246
  v_mfma_f32_32x32x16_bf16 v[160:175], a[252:255], a[60:63], v[160:175]
  s_cbranch_vccnz concat_heads__mha_block_cached__mha_block_cached__near_ridge_kernel_rare3
concat_heads__mha_block_cached__mha_block_cached__near_ridge_kernel_back3:
  s_waitcnt lgkmcnt(0)
  v_mfma_f32_32x32x16_bf16 v[176:191], a[128:131], a[0:3], v[192:207]
  s_add_u32 m0, s33, 0xc000
  s_add_u32 s75, s33, 0x28000
  buffer_load_dwordx4 v240, s[4:7], s75 offen nt lds
  buffer_load_dwordx4 v241, s[4:7], s75 offen offset:1024 nt lds
  buffer_load_dwordx4 v242, s[4:7], s75 offen offset:2048 nt lds
  v_mfma_f32_32x32x16_bf16 v[176:191], a[132:135], a[4:7], v[176:191]
  buffer_load_dwordx4 v243, s[4:7], s75 offen offset:3072 nt lds
  s_add_u32 m0, s33, 0x10000
  s_add_u32 s74, s33, 0x2c000
  buffer_load_dwordx4 v240, s[4:7], s74 offen nt lds
  v_mfma_f32_32x32x16_bf16 v[176:191], a[136:139], a[8:11], v[176:191]
  buffer_load_dwordx4 v241, s[4:7], s74 offen offset:1024 nt lds
  buffer_load_dwordx4 v242, s[4:7], s74 offen offset:2048 nt lds
  buffer_load_dwordx4 v243, s[4:7], s74 offen offset:3072 nt lds
  s_add_u32 m0, s33, 0x14000
  s_add_u32 s75, s33, 0x30000
  v_mfma_f32_32x32x16_bf16 v[176:191], a[140:143], a[12:15], v[176:191]
  buffer_load_dwordx4 v240, s[4:7], s75 offen nt lds
  buffer_load_dwordx4 v241, s[4:7], s75 offen offset:1024 nt lds
  buffer_load_dwordx4 v242, s[4:7], s75 offen offset:2048 nt lds
  buffer_load_dwordx4 v243, s[4:7], s75 offen offset:3072 nt lds
  v_exp_f32 v224, v160
  v_mfma_f32_32x32x16_bf16 v[176:191], a[144:147], a[16:19], v[176:191]
  v_exp_f32 v225, v161
  v_exp_f32 v226, v162
  v_exp_f32 v227, v163
  v_mfma_f32_32x32x16_bf16 v[176:191], a[148:151], a[20:23], v[176:191]
  v_add_f32 v246, v224, v225
  v_cvt_pk_bf16_f32 v24, v224, v225
  v_exp_f32 v228, v164
  v_mfma_f32_32x32x16_bf16 v[176:191], a[152:155], a[24:27], v[176:191]
  v_exp_f32 v229, v165
  v_add_f32 v247, v226, v227
  v_cvt_pk_bf16_f32 v25, v226, v227
  v_exp_f32 v230, v166
  v_mfma_f32_32x32x16_bf16 v[176:191], a[156:159], a[28:31], v[176:191]
  v_exp_f32 v231, v167
  v_add_f32 v246, v246, v228
  v_add_f32 v247, v247, v229
  v_mfma_f32_32x32x16_bf16 v[176:191], a[160:163], a[32:35], v[176:191]
  v_cvt_pk_bf16_f32 v26, v228, v229
  v_exp_f32 v224, v168
  v_exp_f32 v225, v169
  v_mfma_f32_32x32x16_bf16 v[176:191], a[164:167], a[36:39], v[176:191]
  v_add_f32 v246, v246, v230
  v_add_f32 v247, v247, v231
  v_cvt_pk_bf16_f32 v27, v230, v231
  v_exp_f32 v226, v170
  v_mfma_f32_32x32x16_bf16 v[176:191], a[168:171], a[40:43], v[176:191]
  v_exp_f32 v227, v171
  v_add_f32 v246, v246, v224
  v_add_f32 v247, v247, v225
  v_cvt_pk_bf16_f32 v28, v224, v225
  v_mfma_f32_32x32x16_bf16 v[176:191], a[172:175], a[44:47], v[176:191]
  v_exp_f32 v228, v172
  v_exp_f32 v229, v173
  v_add_f32 v246, v246, v226
  v_mfma_f32_32x32x16_bf16 v[176:191], a[176:179], a[48:51], v[176:191]
  v_add_f32 v247, v247, v227
  v_cvt_pk_bf16_f32 v29, v226, v227
  v_exp_f32 v230, v174
  v_exp_f32 v231, v175
  v_mfma_f32_32x32x16_bf16 v[176:191], a[180:183], a[52:55], v[176:191]
  v_add_f32 v246, v246, v228
  v_add_f32 v247, v247, v229
  v_cvt_pk_bf16_f32 v30, v228, v229
  v_add_f32 v246, v246, v230
  v_mfma_f32_32x32x16_bf16 v[176:191], a[184:187], a[56:59], v[176:191]
  v_add_f32 v247, v247, v231
  v_cvt_pk_bf16_f32 v31, v230, v231
  v_add_f32 v246, v246, v247
  v_cmp_lt_f32 vcc, s62, v246
  v_add_f32 v244, v244, v246
  v_mfma_f32_32x32x16_bf16 v[176:191], a[188:191], a[60:63], v[176:191]
  s_cbranch_vccnz concat_heads__mha_block_cached__mha_block_cached__near_ridge_kernel_rare4
concat_heads__mha_block_cached__mha_block_cached__near_ridge_kernel_back4:
  s_waitcnt lgkmcnt(0)
  v_mfma_f32_32x32x16_bf16 v[160:175], a[128:131], a[64:67], v[208:223]
  s_add_u32 m0, s33, 0x20000
  s_add_u32 s74, s33, 0x34000
  v_add_u32 v232, s41, v232
  v_add_u32 v233, s41, v233
  v_mfma_f32_32x32x16_bf16 v[160:175], a[132:135], a[68:71], v[160:175]
  ds_read_b128 a[192:195], v232
  ds_read_b128 a[196:199], v233
  buffer_load_dwordx4 v240, s[4:7], s74 offen nt lds
  v_add_u32 v234, s41, v234
  v_mfma_f32_32x32x16_bf16 v[160:175], a[136:139], a[72:75], v[160:175]
  ds_read_b128 a[200:203], v234
  buffer_load_dwordx4 v241, s[4:7], s74 offen offset:1024 nt lds
  buffer_load_dwordx4 v242, s[4:7], s74 offen offset:2048 nt lds
  v_exp_f32 v224, v176
  v_add_u32 v235, s41, v235
  v_mfma_f32_32x32x16_bf16 v[160:175], a[140:143], a[76:79], v[160:175]
  ds_read_b128 a[204:207], v235
  buffer_load_dwordx4 v243, s[4:7], s74 offen offset:3072 nt lds
  v_exp_f32 v225, v177
  v_add_u32 v236, s41, v236
  v_add_u32 v237, s41, v237
  v_mfma_f32_32x32x16_bf16 v[160:175], a[144:147], a[80:83], v[160:175]
  ds_read_b128 a[208:211], v236
  ds_read_b128 a[212:215], v237
  v_exp_f32 v226, v178
  v_exp_f32 v227, v179
  v_add_u32 v238, s41, v238
  v_mfma_f32_32x32x16_bf16 v[160:175], a[148:151], a[84:87], v[160:175]
  ds_read_b128 a[216:219], v238
  v_add_f32 v246, v224, v225
  v_cvt_pk_bf16_f32 v32, v224, v225
  v_exp_f32 v228, v180
  v_add_u32 v239, s41, v239
  v_mfma_f32_32x32x16_bf16 v[160:175], a[152:155], a[88:91], v[160:175]
  ds_read_b128 a[220:223], v239
  v_exp_f32 v229, v181
  v_add_f32 v247, v226, v227
  v_cvt_pk_bf16_f32 v33, v226, v227
  v_mfma_f32_32x32x16_bf16 v[160:175], a[156:159], a[92:95], v[160:175]
  ds_read_b128 a[224:227], v232 offset:256
  ds_read_b128 a[228:231], v233 offset:256
  v_exp_f32 v230, v182
  v_exp_f32 v231, v183
  v_mfma_f32_32x32x16_bf16 v[160:175], a[160:163], a[96:99], v[160:175]
  ds_read_b128 a[232:235], v234 offset:256
  v_add_f32 v246, v246, v228
  v_add_f32 v247, v247, v229
  v_cvt_pk_bf16_f32 v34, v228, v229
  v_exp_f32 v224, v184
  v_mfma_f32_32x32x16_bf16 v[160:175], a[164:167], a[100:103], v[160:175]
  ds_read_b128 a[236:239], v235 offset:256
  v_exp_f32 v225, v185
  v_add_f32 v246, v246, v230
  v_add_f32 v247, v247, v231
  v_cvt_pk_bf16_f32 v35, v230, v231
  v_mfma_f32_32x32x16_bf16 v[160:175], a[168:171], a[104:107], v[160:175]
  ds_read_b128 a[240:243], v236 offset:256
  ds_read_b128 a[244:247], v237 offset:256
  v_exp_f32 v226, v186
  v_exp_f32 v227, v187
  v_add_f32 v246, v246, v224
  v_mfma_f32_32x32x16_bf16 v[160:175], a[172:175], a[108:111], v[160:175]
  ds_read_b128 a[248:251], v238 offset:256
  v_add_f32 v247, v247, v225
  v_cvt_pk_bf16_f32 v36, v224, v225
  v_exp_f32 v228, v188
  v_mfma_f32_32x32x16_bf16 v[160:175], a[176:179], a[112:115], v[160:175]
  ds_read_b128 a[252:255], v239 offset:256
  v_exp_f32 v229, v189
  v_add_f32 v246, v246, v226
  v_add_f32 v247, v247, v227
  v_cvt_pk_bf16_f32 v37, v226, v227
  v_mfma_f32_32x32x16_bf16 v[160:175], a[180:183], a[116:119], v[160:175]
  v_exp_f32 v230, v190
  v_exp_f32 v231, v191
  v_add_f32 v246, v246, v228
  v_add_f32 v247, v247, v229
  v_cvt_pk_bf16_f32 v38, v228, v229
  v_mfma_f32_32x32x16_bf16 v[160:175], a[184:187], a[120:123], v[160:175]
  v_add_f32 v246, v246, v230
  v_add_f32 v247, v247, v231
  v_cvt_pk_bf16_f32 v39, v230, v231
  v_add_f32 v246, v246, v247
  v_cmp_lt_f32 vcc, s62, v246
  v_add_f32 v244, v244, v246
  v_mfma_f32_32x32x16_bf16 v[160:175], a[188:191], a[124:127], v[160:175]
  s_cbranch_vccnz concat_heads__mha_block_cached__mha_block_cached__near_ridge_kernel_rare5
concat_heads__mha_block_cached__mha_block_cached__near_ridge_kernel_back5:
  s_waitcnt lgkmcnt(0)
  v_mfma_f32_32x32x16_bf16 v[176:191], a[192:195], a[0:3], v[192:207]
  v_add_u32 v232, s42, v232
  v_add_u32 v233, s42, v233
  v_mfma_f32_32x32x16_bf16 v[176:191], a[196:199], a[4:7], v[176:191]
  ds_read_b128 a[128:131], v232
  ds_read_b128 a[132:135], v233
  v_add_u32 v234, s42, v234
  v_mfma_f32_32x32x16_bf16 v[176:191], a[200:203], a[8:11], v[176:191]
  ds_read_b128 a[136:139], v234
  s_nop 0
  v_exp_f32 v224, v160
  v_exp_f32 v225, v161
  v_add_u32 v235, s42, v235
  v_mfma_f32_32x32x16_bf16 v[176:191], a[204:207], a[12:15], v[176:191]
  ds_read_b128 a[140:143], v235
  v_exp_f32 v226, v162
  v_add_u32 v236, s42, v236
  v_add_u32 v237, s42, v237
  v_mfma_f32_32x32x16_bf16 v[176:191], a[208:211], a[16:19], v[176:191]
  ds_read_b128 a[144:147], v236
  ds_read_b128 a[148:151], v237
  v_exp_f32 v227, v163
  v_add_f32 v246, v224, v225
  v_cvt_pk_bf16_f32 v136, v224, v225
  v_add_u32 v238, s42, v238
  v_mfma_f32_32x32x16_bf16 v[176:191], a[212:215], a[20:23], v[176:191]
  ds_read_b128 a[152:155], v238
  v_exp_f32 v228, v164
  v_exp_f32 v229, v165
  v_add_u32 v239, s42, v239
  v_mfma_f32_32x32x16_bf16 v[176:191], a[216:219], a[24:27], v[176:191]
  ds_read_b128 a[156:159], v239
  v_add_f32 v247, v226, v227
  v_cvt_pk_bf16_f32 v137, v226, v227
  v_exp_f32 v230, v166
  v_mfma_f32_32x32x16_bf16 v[176:191], a[220:223], a[28:31], v[176:191]
  ds_read_b128 a[160:163], v232 offset:256
  ds_read_b128 a[164:167], v233 offset:256
  v_exp_f32 v231, v167
  v_add_f32 v246, v246, v228
  v_add_f32 v247, v247, v229
  v_mfma_f32_32x32x16_bf16 v[176:191], a[224:227], a[32:35], v[176:191]
  ds_read_b128 a[168:171], v234 offset:256
  v_cvt_pk_bf16_f32 v138, v228, v229
  v_exp_f32 v224, v168
  v_exp_f32 v225, v169
  v_mfma_f32_32x32x16_bf16 v[176:191], a[228:231], a[36:39], v[176:191]
  ds_read_b128 a[172:175], v235 offset:256
  v_add_f32 v246, v246, v230
  v_add_f32 v247, v247, v231
  v_cvt_pk_bf16_f32 v139, v230, v231
  v_exp_f32 v226, v170
  v_mfma_f32_32x32x16_bf16 v[176:191], a[232:235], a[40:43], v[176:191]
  ds_read_b128 a[176:179], v236 offset:256
  ds_read_b128 a[180:183], v237 offset:256
  v_exp_f32 v227, v171
  v_add_f32 v246, v246, v224
  v_add_f32 v247, v247, v225
  v_mfma_f32_32x32x16_bf16 v[176:191], a[236:239], a[44:47], v[176:191]
  ds_read_b128 a[184:187], v238 offset:256
  v_cvt_pk_bf16_f32 v140, v224, v225
  v_exp_f32 v228, v172
  v_exp_f32 v229, v173
  v_mfma_f32_32x32x16_bf16 v[176:191], a[240:243], a[48:51], v[176:191]
  ds_read_b128 a[188:191], v239 offset:256
  v_add_f32 v246, v246, v226
  v_add_f32 v247, v247, v227
  v_cvt_pk_bf16_f32 v141, v226, v227
  v_exp_f32 v230, v174
  v_mfma_f32_32x32x16_bf16 v[176:191], a[244:247], a[52:55], v[176:191]
  v_exp_f32 v231, v175
  v_add_f32 v246, v246, v228
  v_add_f32 v247, v247, v229
  v_cvt_pk_bf16_f32 v142, v228, v229
  v_mfma_f32_32x32x16_bf16 v[176:191], a[248:251], a[56:59], v[176:191]
  v_add_f32 v246, v246, v230
  v_add_f32 v247, v247, v231
  v_cvt_pk_bf16_f32 v143, v230, v231
  v_add_f32 v246, v246, v247
  v_cmp_lt_f32 vcc, s62, v246
  v_add_f32 v245, v245, v246
  v_mfma_f32_32x32x16_bf16 v[176:191], a[252:255], a[60:63], v[176:191]
  s_cbranch_vccnz concat_heads__mha_block_cached__mha_block_cached__near_ridge_kernel_rare6
concat_heads__mha_block_cached__mha_block_cached__near_ridge_kernel_back6:
  s_waitcnt lgkmcnt(0)
  v_mfma_f32_32x32x16_bf16 v[160:175], a[128:131], a[0:3], v[192:207]
  v_add_u32 v232, s43, v232
  v_add_u32 v233, s43, v233
  v_mfma_f32_32x32x16_bf16 v[160:175], a[132:135], a[4:7], v[160:175]
  ds_read_b128 a[192:195], v232
  ds_read_b128 a[196:199], v233
  v_add_u32 v234, s43, v234
  v_mfma_f32_32x32x16_bf16 v[160:175], a[136:139], a[8:11], v[160:175]
  ds_read_b128 a[200:203], v234
  s_nop 0
  v_exp_f32 v224, v176
  v_exp_f32 v225, v177
  v_add_u32 v235, s43, v235
  v_mfma_f32_32x32x16_bf16 v[160:175], a[140:143], a[12:15], v[160:175]
  ds_read_b128 a[204:207], v235
  v_exp_f32 v226, v178
  v_add_u32 v236, s43, v236
  v_add_u32 v237, s43, v237
  v_mfma_f32_32x32x16_bf16 v[160:175], a[144:147], a[16:19], v[160:175]
  ds_read_b128 a[208:211], v236
  ds_read_b128 a[212:215], v237
  v_exp_f32 v227, v179
  v_add_f32 v246, v224, v225
  v_cvt_pk_bf16_f32 v40, v224, v225
  v_add_u32 v238, s43, v238
  v_mfma_f32_32x32x16_bf16 v[160:175], a[148:151], a[20:23], v[160:175]
  ds_read_b128 a[216:219], v238
  v_exp_f32 v228, v180
  v_exp_f32 v229, v181
  v_add_u32 v239, s43, v239
  v_mfma_f32_32x32x16_bf16 v[160:175], a[152:155], a[24:27], v[160:175]
  ds_read_b128 a[220:223], v239
  v_add_f32 v247, v226, v227
  v_cvt_pk_bf16_f32 v41, v226, v227
  v_exp_f32 v230, v182
  v_mfma_f32_32x32x16_bf16 v[160:175], a[156:159], a[28:31], v[160:175]
  ds_read_b128 a[224:227], v232 offset:256
  ds_read_b128 a[228:231], v233 offset:256
  v_exp_f32 v231, v183
  v_add_f32 v246, v246, v228
  v_add_f32 v247, v247, v229
  v_mfma_f32_32x32x16_bf16 v[160:175], a[160:163], a[32:35], v[160:175]
  ds_read_b128 a[232:235], v234 offset:256
  v_cvt_pk_bf16_f32 v42, v228, v229
  v_exp_f32 v224, v184
  v_exp_f32 v225, v185
  v_mfma_f32_32x32x16_bf16 v[160:175], a[164:167], a[36:39], v[160:175]
  ds_read_b128 a[236:239], v235 offset:256
  v_add_f32 v246, v246, v230
  v_add_f32 v247, v247, v231
  v_cvt_pk_bf16_f32 v43, v230, v231
  v_exp_f32 v226, v186
  v_mfma_f32_32x32x16_bf16 v[160:175], a[168:171], a[40:43], v[160:175]
  ds_read_b128 a[240:243], v236 offset:256
  ds_read_b128 a[244:247], v237 offset:256
  v_exp_f32 v227, v187
  v_add_f32 v246, v246, v224
  v_add_f32 v247, v247, v225
  v_mfma_f32_32x32x16_bf16 v[160:175], a[172:175], a[44:47], v[160:175]
  ds_read_b128 a[248:251], v238 offset:256
  v_cvt_pk_bf16_f32 v44, v224, v225
  v_exp_f32 v228, v188
  v_exp_f32 v229, v189
  v_mfma_f32_32x32x16_bf16 v[160:175], a[176:179], a[48:51], v[160:175]
  ds_read_b128 a[252:255], v239 offset:256
  v_add_f32 v246, v246, v226
  v_add_f32 v247, v247, v227
  v_cvt_pk_bf16_f32 v45, v226, v227
  v_exp_f32 v230, v190
  v_mfma_f32_32x32x16_bf16 v[160:175], a[180:183], a[52:55], v[160:175]
  v_exp_f32 v231, v191
  v_add_f32 v246, v246, v228
  v_add_f32 v247, v247, v229
  v_cvt_pk_bf16_f32 v46, v228, v229
  v_mfma_f32_32x32x16_bf16 v[160:175], a[184:187], a[56:59], v[160:175]
  v_add_f32 v246, v246, v230
  v_add_f32 v247, v247, v231
  v_cvt_pk_bf16_f32 v47, v230, v231
  v_add_f32 v246, v246, v247
  v_cmp_lt_f32 vcc, s62, v246
  v_add_f32 v244, v244, v246
  v_mfma_f32_32x32x16_bf16 v[160:175], a[188:191], a[60:63], v[160:175]
  s_cbranch_vccnz concat_heads__mha_block_cached__mha_block_cached__near_ridge_kernel_rare7
concat_heads__mha_block_cached__mha_block_cached__near_ridge_kernel_back7:
  s_waitcnt lgkmcnt(0)
  s_waitcnt vmcnt(8)
  s_barrier
  v_mfma_f32_32x32x16_bf16 v[176:191], a[192:195], a[0:3], v[192:207]
  s_add_u32 m0, s33, 0x24000
  s_add_u32 s75, s33, 0x38000
  v_add_u32 v232, s44, v232
  v_add_u32 v233, s44, v233
  v_mfma_f32_32x32x16_bf16 v[176:191], a[196:199], a[4:7], v[176:191]
  ds_read_b128 a[128:131], v232
  ds_read_b128 a[132:135], v233
  buffer_load_dwordx4 v240, s[4:7], s75 offen nt lds
  v_add_u32 v234, s44, v234
  v_mfma_f32_32x32x16_bf16 v[176:191], a[200:203], a[8:11], v[176:191]
  ds_read_b128 a[136:139], v234
  buffer_load_dwordx4 v241, s[4:7], s75 offen offset:1024 nt lds
  buffer_load_dwordx4 v242, s[4:7], s75 offen offset:2048 nt lds
  v_exp_f32 v224, v160
  v_add_u32 v235, s44, v235
  v_mfma_f32_32x32x16_bf16 v[176:191], a[204:207], a[12:15], v[176:191]
  ds_read_b128 a[140:143], v235
  buffer_load_dwordx4 v243, s[4:7], s75 offen offset:3072 nt lds
  v_exp_f32 v225, v161
  v_add_u32 v236, s44, v236
  v_add_u32 v237, s44, v237
  v_mfma_f32_32x32x16_bf16 v[176:191], a[208:211], a[16:19], v[176:191]
  ds_read_b128 a[144:147], v236
  ds_read_b128 a[148:151], v237
  v_exp_f32 v226, v162
  v_exp_f32 v227, v163
  v_add_u32 v238, s44, v238
  v_mfma_f32_32x32x16_bf16 v[176:191], a[212:215], a[20:23], v[176:191]
  ds_read_b128 a[152:155], v238
  v_add_f32 v246, v224, v225
  v_cvt_pk_bf16_f32 v48, v224, v225
  v_exp_f32 v228, v164
  v_add_u32 v239, s44, v239
  v_mfma_f32_32x32x16_bf16 v[176:191], a[216:219], a[24:27], v[176:191]
  ds_read_b128 a[156:159], v239
  v_exp_f32 v229, v165
  v_add_f32 v247, v226, v227
  v_cvt_pk_bf16_f32 v49, v226, v227
  v_mfma_f32_32x32x16_bf16 v[176:191], a[220:223], a[28:31], v[176:191]
  ds_read_b128 a[160:163], v232 offset:256
  ds_read_b128 a[164:167], v233 offset:256
  v_exp_f32 v230, v166
  v_exp_f32 v231, v167
  v_mfma_f32_32x32x16_bf16 v[176:191], a[224:227], a[32:35], v[176:191]
  ds_read_b128 a[168:171], v234 offset:256
  v_add_f32 v246, v246, v228
  v_add_f32 v247, v247, v229
  v_cvt_pk_bf16_f32 v50, v228, v229
  v_exp_f32 v224, v168
  v_mfma_f32_32x32x16_bf16 v[176:191], a[228:231], a[36:39], v[176:191]
  ds_read_b128 a[172:175], v235 offset:256
  v_exp_f32 v225, v169
  v_add_f32 v246, v246, v230
  v_add_f32 v247, v247, v231
  v_cvt_pk_bf16_f32 v51, v230, v231
  v_mfma_f32_32x32x16_bf16 v[176:191], a[232:235], a[40:43], v[176:191]
  ds_read_b128 a[176:179], v236 offset:256
  ds_read_b128 a[180:183], v237 offset:256
  v_exp_f32 v226, v170
  v_exp_f32 v227, v171
  v_add_f32 v246, v246, v224
  v_mfma_f32_32x32x16_bf16 v[176:191], a[236:239], a[44:47], v[176:191]
  ds_read_b128 a[184:187], v238 offset:256
  v_add_f32 v247, v247, v225
  v_cvt_pk_bf16_f32 v52, v224, v225
  v_exp_f32 v228, v172
  v_mfma_f32_32x32x16_bf16 v[176:191], a[240:243], a[48:51], v[176:191]
  ds_read_b128 a[188:191], v239 offset:256
  v_exp_f32 v229, v173
  v_add_f32 v246, v246, v226
  v_add_f32 v247, v247, v227
  v_cvt_pk_bf16_f32 v53, v226, v227
  v_mfma_f32_32x32x16_bf16 v[176:191], a[244:247], a[52:55], v[176:191]
  v_exp_f32 v230, v174
  v_exp_f32 v231, v175
  v_add_f32 v246, v246, v228
  v_add_f32 v247, v247, v229
  v_cvt_pk_bf16_f32 v54, v228, v229
  v_mfma_f32_32x32x16_bf16 v[176:191], a[248:251], a[56:59], v[176:191]
  v_add_f32 v246, v246, v230
  v_add_f32 v247, v247, v231
  v_cvt_pk_bf16_f32 v55, v230, v231
  v_add_f32 v246, v246, v247
  v_cmp_lt_f32 vcc, s62, v246
  v_add_f32 v244, v244, v246
  v_mfma_f32_32x32x16_bf16 v[176:191], a[252:255], a[60:63], v[176:191]
  s_cbranch_vccnz concat_heads__mha_block_cached__mha_block_cached__near_ridge_kernel_rare8
concat_heads__mha_block_cached__mha_block_cached__near_ridge_kernel_back8:
  s_waitcnt lgkmcnt(0)
  v_mfma_f32_32x32x16_bf16 v[160:175], a[128:131], a[0:3], v[192:207]
  s_add_u32 m0, s33, 0
  s_add_u32 s74, s33, 0x3c000
  buffer_load_dwordx4 v240, s[4:7], s74 offen nt lds
  buffer_load_dwordx4 v241, s[4:7], s74 offen offset:1024 nt lds
  buffer_load_dwordx4 v242, s[4:7], s74 offen offset:2048 nt lds
  v_mfma_f32_32x32x16_bf16 v[160:175], a[132:135], a[4:7], v[160:175]
  buffer_load_dwordx4 v243, s[4:7], s74 offen offset:3072 nt lds
  s_add_u32 m0, s33, 0x4000
  s_add_u32 s75, s72, 0
  buffer_load_dwordx4 v252, s[8:11], s75 offen nt lds
  v_mfma_f32_32x32x16_bf16 v[160:175], a[136:139], a[8:11], v[160:175]
  s_add_u32 s74, s72, 0xc00
  buffer_load_dwordx4 v252, s[8:11], s74 offen offset:1024 nt lds
  s_add_u32 s75, s72, 0x1800
  buffer_load_dwordx4 v252, s[8:11], s75 offen offset:2048 nt lds
  s_add_u32 s74, s72, 0x2400
  v_mfma_f32_32x32x16_bf16 v[160:175], a[140:143], a[12:15], v[160:175]
  buffer_load_dwordx4 v252, s[8:11], s74 offen offset:3072 nt lds
  s_add_u32 m0, s33, 0x18000
  s_add_u32 s75, s72, 0x10000
  buffer_load_dwordx4 v252, s[8:11], s75 offen nt lds
  v_exp_f32 v224, v176
  v_mfma_f32_32x32x16_bf16 v[160:175], a[144:147], a[16:19], v[160:175]
  v_exp_f32 v225, v177
  v_exp_f32 v226, v178
  v_exp_f32 v227, v179
  v_mfma_f32_32x32x16_bf16 v[160:175], a[148:151], a[20:23], v[160:175]
  v_add_f32 v246, v224, v225
  v_cvt_pk_bf16_f32 v56, v224, v225
  v_exp_f32 v228, v180
  v_mfma_f32_32x32x16_bf16 v[160:175], a[152:155], a[24:27], v[160:175]
  v_exp_f32 v229, v181
  v_add_f32 v247, v226, v227
  v_cvt_pk_bf16_f32 v57, v226, v227
  v_exp_f32 v230, v182
  v_mfma_f32_32x32x16_bf16 v[160:175], a[156:159], a[28:31], v[160:175]
  v_exp_f32 v231, v183
  v_add_f32 v246, v246, v228
  v_add_f32 v247, v247, v229
  v_mfma_f32_32x32x16_bf16 v[160:175], a[160:163], a[32:35], v[160:175]
  v_cvt_pk_bf16_f32 v58, v228, v229
  v_exp_f32 v224, v184
  v_exp_f32 v225, v185
  v_mfma_f32_32x32x16_bf16 v[160:175], a[164:167], a[36:39], v[160:175]
  v_add_f32 v246, v246, v230
  v_add_f32 v247, v247, v231
  v_cvt_pk_bf16_f32 v59, v230, v231
  v_exp_f32 v226, v186
  v_mfma_f32_32x32x16_bf16 v[160:175], a[168:171], a[40:43], v[160:175]
  v_exp_f32 v227, v187
  v_add_f32 v246, v246, v224
  v_add_f32 v247, v247, v225
  v_cvt_pk_bf16_f32 v60, v224, v225
  v_mfma_f32_32x32x16_bf16 v[160:175], a[172:175], a[44:47], v[160:175]
  v_exp_f32 v228, v188
  v_exp_f32 v229, v189
  v_add_f32 v246, v246, v226
  v_mfma_f32_32x32x16_bf16 v[160:175], a[176:179], a[48:51], v[160:175]
  v_add_f32 v247, v247, v227
  v_cvt_pk_bf16_f32 v61, v226, v227
  v_exp_f32 v230, v190
  v_exp_f32 v231, v191
  v_mfma_f32_32x32x16_bf16 v[160:175], a[180:183], a[52:55], v[160:175]
  v_add_f32 v246, v246, v228
  v_add_f32 v247, v247, v229
  v_cvt_pk_bf16_f32 v62, v228, v229
  v_add_f32 v246, v246, v230
  v_mfma_f32_32x32x16_bf16 v[160:175], a[184:187], a[56:59], v[160:175]
  v_add_f32 v247, v247, v231
  v_cvt_pk_bf16_f32 v63, v230, v231
  v_add_f32 v246, v246, v247
  v_cmp_lt_f32 vcc, s62, v246
  v_add_f32 v244, v244, v246
  v_mfma_f32_32x32x16_bf16 v[160:175], a[188:191], a[60:63], v[160:175]
  s_cbranch_vccnz concat_heads__mha_block_cached__mha_block_cached__near_ridge_kernel_rare9
concat_heads__mha_block_cached__mha_block_cached__near_ridge_kernel_back9:
  s_waitcnt lgkmcnt(0)
  v_mfma_f32_32x32x16_bf16 v[176:191], a[128:131], a[64:67], v[208:223]
  s_add_u32 s74, s72, 0x10c00
  buffer_load_dwordx4 v252, s[8:11], s74 offen offset:1024 nt lds
  v_add_u32 v232, s45, v232
  v_add_u32 v233, s45, v233
  v_mfma_f32_32x32x16_bf16 v[176:191], a[132:135], a[68:71], v[176:191]
  ds_read_b128 a[192:195], v232
  ds_read_b128 a[196:199], v233
  s_add_u32 s75, s72, 0x11800
  v_add_u32 v234, s45, v234
  v_mfma_f32_32x32x16_bf16 v[176:191], a[136:139], a[72:75], v[176:191]
  ds_read_b128 a[200:203], v234
  buffer_load_dwordx4 v252, s[8:11], s75 offen offset:2048 nt lds
  s_add_u32 s74, s72, 0x12400
  v_exp_f32 v224, v160
  v_add_u32 v235, s45, v235
  v_mfma_f32_32x32x16_bf16 v[176:191], a[140:143], a[76:79], v[176:191]
  ds_read_b128 a[204:207], v235
  buffer_load_dwordx4 v252, s[8:11], s74 offen offset:3072 nt lds
  v_exp_f32 v225, v161
  v_add_u32 v236, s45, v236
  v_add_u32 v237, s45, v237
  v_mfma_f32_32x32x16_bf16 v[176:191], a[144:147], a[80:83], v[176:191]
  ds_read_b128 a[208:211], v236
  ds_read_b128 a[212:215], v237
  v_exp_f32 v226, v162
  v_exp_f32 v227, v163
  v_add_u32 v238, s45, v238
  v_mfma_f32_32x32x16_bf16 v[176:191], a[148:151], a[84:87], v[176:191]
  ds_read_b128 a[216:219], v238
  v_add_f32 v246, v224, v225
  v_cvt_pk_bf16_f32 v64, v224, v225
  v_exp_f32 v228, v164
  v_add_u32 v239, s45, v239
  v_mfma_f32_32x32x16_bf16 v[176:191], a[152:155], a[88:91], v[176:191]
  ds_read_b128 a[220:223], v239
  v_exp_f32 v229, v165
  v_add_f32 v247, v226, v227
  v_cvt_pk_bf16_f32 v65, v226, v227
  v_mfma_f32_32x32x16_bf16 v[176:191], a[156:159], a[92:95], v[176:191]
  ds_read_b128 a[224:227], v232 offset:256
  ds_read_b128 a[228:231], v233 offset:256
  v_exp_f32 v230, v166
  v_exp_f32 v231, v167
  v_mfma_f32_32x32x16_bf16 v[176:191], a[160:163], a[96:99], v[176:191]
  ds_read_b128 a[232:235], v234 offset:256
  v_add_f32 v246, v246, v228
  v_add_f32 v247, v247, v229
  v_cvt_pk_bf16_f32 v66, v228, v229
  v_exp_f32 v224, v168
  v_mfma_f32_32x32x16_bf16 v[176:191], a[164:167], a[100:103], v[176:191]
  ds_read_b128 a[236:239], v235 offset:256
  v_exp_f32 v225, v169
  v_add_f32 v246, v246, v230
  v_add_f32 v247, v247, v231
  v_cvt_pk_bf16_f32 v67, v230, v231
  v_mfma_f32_32x32x16_bf16 v[176:191], a[168:171], a[104:107], v[176:191]
  ds_read_b128 a[240:243], v236 offset:256
  ds_read_b128 a[244:247], v237 offset:256
  v_exp_f32 v226, v170
  v_exp_f32 v227, v171
  v_add_f32 v246, v246, v224
  v_mfma_f32_32x32x16_bf16 v[176:191], a[172:175], a[108:111], v[176:191]
  ds_read_b128 a[248:251], v238 offset:256
  v_add_f32 v247, v247, v225
  v_cvt_pk_bf16_f32 v68, v224, v225
  v_exp_f32 v228, v172
  v_mfma_f32_32x32x16_bf16 v[176:191], a[176:179], a[112:115], v[176:191]
  ds_read_b128 a[252:255], v239 offset:256
  v_exp_f32 v229, v173
  v_add_f32 v246, v246, v226
  v_add_f32 v247, v247, v227
  v_cvt_pk_bf16_f32 v69, v226, v227
  v_mfma_f32_32x32x16_bf16 v[176:191], a[180:183], a[116:119], v[176:191]
  v_exp_f32 v230, v174
  v_exp_f32 v231, v175
  v_add_f32 v246, v246, v228
  v_add_f32 v247, v247, v229
  v_cvt_pk_bf16_f32 v70, v228, v229
  v_mfma_f32_32x32x16_bf16 v[176:191], a[184:187], a[120:123], v[176:191]
  v_add_f32 v246, v246, v230
  v_add_f32 v247, v247, v231
  v_cvt_pk_bf16_f32 v71, v230, v231
  v_add_f32 v246, v246, v247
  v_cmp_lt_f32 vcc, s62, v246
  v_add_f32 v244, v244, v246
  v_mfma_f32_32x32x16_bf16 v[176:191], a[188:191], a[124:127], v[176:191]
  s_cbranch_vccnz concat_heads__mha_block_cached__mha_block_cached__near_ridge_kernel_rare10
concat_heads__mha_block_cached__mha_block_cached__near_ridge_kernel_back10:
  s_waitcnt lgkmcnt(0)
  v_mfma_f32_32x32x16_bf16 v[160:175], a[192:195], a[0:3], v[192:207]
  v_add_u32 v232, s46, v232
  v_add_u32 v233, s46, v233
  v_mfma_f32_32x32x16_bf16 v[160:175], a[196:199], a[4:7], v[160:175]
  ds_read_b128 a[128:131], v232
  ds_read_b128 a[132:135], v233
  v_add_u32 v234, s46, v234
  v_mfma_f32_32x32x16_bf16 v[160:175], a[200:203], a[8:11], v[160:175]
  ds_read_b128 a[136:139], v234
  s_nop 0
  v_exp_f32 v224, v176
  v_exp_f32 v225, v177
  v_add_u32 v235, s46, v235
  v_mfma_f32_32x32x16_bf16 v[160:175], a[204:207], a[12:15], v[160:175]
  ds_read_b128 a[140:143], v235
  v_exp_f32 v226, v178
  v_add_u32 v236, s46, v236
  v_add_u32 v237, s46, v237
  v_mfma_f32_32x32x16_bf16 v[160:175], a[208:211], a[16:19], v[160:175]
  ds_read_b128 a[144:147], v236
  ds_read_b128 a[148:151], v237
  v_exp_f32 v227, v179
  v_add_f32 v246, v224, v225
  v_cvt_pk_bf16_f32 v144, v224, v225
  v_add_u32 v238, s46, v238
  v_mfma_f32_32x32x16_bf16 v[160:175], a[212:215], a[20:23], v[160:175]
  ds_read_b128 a[152:155], v238
  v_exp_f32 v228, v180
  v_exp_f32 v229, v181
  v_add_u32 v239, s46, v239
  v_mfma_f32_32x32x16_bf16 v[160:175], a[216:219], a[24:27], v[160:175]
  ds_read_b128 a[156:159], v239
  v_add_f32 v247, v226, v227
  v_cvt_pk_bf16_f32 v145, v226, v227
  v_exp_f32 v230, v182
  v_mfma_f32_32x32x16_bf16 v[160:175], a[220:223], a[28:31], v[160:175]
  ds_read_b128 a[160:163], v232 offset:256
  ds_read_b128 a[164:167], v233 offset:256
  v_exp_f32 v231, v183
  v_add_f32 v246, v246, v228
  v_add_f32 v247, v247, v229
  v_mfma_f32_32x32x16_bf16 v[160:175], a[224:227], a[32:35], v[160:175]
  ds_read_b128 a[168:171], v234 offset:256
  v_cvt_pk_bf16_f32 v146, v228, v229
  v_exp_f32 v224, v184
  v_exp_f32 v225, v185
  v_mfma_f32_32x32x16_bf16 v[160:175], a[228:231], a[36:39], v[160:175]
  ds_read_b128 a[172:175], v235 offset:256
  v_add_f32 v246, v246, v230
  v_add_f32 v247, v247, v231
  v_cvt_pk_bf16_f32 v147, v230, v231
  v_exp_f32 v226, v186
  v_mfma_f32_32x32x16_bf16 v[160:175], a[232:235], a[40:43], v[160:175]
  ds_read_b128 a[176:179], v236 offset:256
  ds_read_b128 a[180:183], v237 offset:256
  v_exp_f32 v227, v187
  v_add_f32 v246, v246, v224
  v_add_f32 v247, v247, v225
  v_mfma_f32_32x32x16_bf16 v[160:175], a[236:239], a[44:47], v[160:175]
  ds_read_b128 a[184:187], v238 offset:256
  v_cvt_pk_bf16_f32 v148, v224, v225
  v_exp_f32 v228, v188
  v_exp_f32 v229, v189
  v_mfma_f32_32x32x16_bf16 v[160:175], a[240:243], a[48:51], v[160:175]
  ds_read_b128 a[188:191], v239 offset:256
  v_add_f32 v246, v246, v226
  v_add_f32 v247, v247, v227
  v_cvt_pk_bf16_f32 v149, v226, v227
  v_exp_f32 v230, v190
  v_mfma_f32_32x32x16_bf16 v[160:175], a[244:247], a[52:55], v[160:175]
  v_exp_f32 v231, v191
  v_add_f32 v246, v246, v228
  v_add_f32 v247, v247, v229
  v_cvt_pk_bf16_f32 v150, v228, v229
  v_mfma_f32_32x32x16_bf16 v[160:175], a[248:251], a[56:59], v[160:175]
  v_add_f32 v246, v246, v230
  v_add_f32 v247, v247, v231
  v_cvt_pk_bf16_f32 v151, v230, v231
  v_add_f32 v246, v246, v247
  v_cmp_lt_f32 vcc, s62, v246
  v_add_f32 v245, v245, v246
  v_mfma_f32_32x32x16_bf16 v[160:175], a[252:255], a[60:63], v[160:175]
  s_cbranch_vccnz concat_heads__mha_block_cached__mha_block_cached__near_ridge_kernel_rare11
concat_heads__mha_block_cached__mha_block_cached__near_ridge_kernel_back11:
  s_waitcnt lgkmcnt(0)
  v_mfma_f32_32x32x16_bf16 v[176:191], a[128:131], a[0:3], v[192:207]
  v_add_u32 v232, s47, v232
  v_add_u32 v233, s47, v233
  v_mfma_f32_32x32x16_bf16 v[176:191], a[132:135], a[4:7], v[176:191]
  ds_read_b128 a[192:195], v232
  ds_read_b128 a[196:199], v233
  v_add_u32 v234, s47, v234
  v_mfma_f32_32x32x16_bf16 v[176:191], a[136:139], a[8:11], v[176:191]
  ds_read_b128 a[200:203], v234
  s_nop 0
  v_exp_f32 v224, v160
  v_exp_f32 v225, v161
  v_add_u32 v235, s47, v235
  v_mfma_f32_32x32x16_bf16 v[176:191], a[140:143], a[12:15], v[176:191]
  ds_read_b128 a[204:207], v235
  v_exp_f32 v226, v162
  v_add_u32 v236, s47, v236
  v_add_u32 v237, s47, v237
  v_mfma_f32_32x32x16_bf16 v[176:191], a[144:147], a[16:19], v[176:191]
  ds_read_b128 a[208:211], v236
  ds_read_b128 a[212:215], v237
  v_exp_f32 v227, v163
  v_add_f32 v246, v224, v225
  v_cvt_pk_bf16_f32 v72, v224, v225
  v_add_u32 v238, s47, v238
  v_mfma_f32_32x32x16_bf16 v[176:191], a[148:151], a[20:23], v[176:191]
  ds_read_b128 a[216:219], v238
  v_exp_f32 v228, v164
  v_exp_f32 v229, v165
  v_add_u32 v239, s47, v239
  v_mfma_f32_32x32x16_bf16 v[176:191], a[152:155], a[24:27], v[176:191]
  ds_read_b128 a[220:223], v239
  v_add_f32 v247, v226, v227
  v_cvt_pk_bf16_f32 v73, v226, v227
  v_exp_f32 v230, v166
  v_mfma_f32_32x32x16_bf16 v[176:191], a[156:159], a[28:31], v[176:191]
  ds_read_b128 a[224:227], v232 offset:256
  ds_read_b128 a[228:231], v233 offset:256
  v_exp_f32 v231, v167
  v_add_f32 v246, v246, v228
  v_add_f32 v247, v247, v229
  v_mfma_f32_32x32x16_bf16 v[176:191], a[160:163], a[32:35], v[176:191]
  ds_read_b128 a[232:235], v234 offset:256
  v_cvt_pk_bf16_f32 v74, v228, v229
  v_exp_f32 v224, v168
  v_exp_f32 v225, v169
  v_mfma_f32_32x32x16_bf16 v[176:191], a[164:167], a[36:39], v[176:191]
  ds_read_b128 a[236:239], v235 offset:256
  v_add_f32 v246, v246, v230
  v_add_f32 v247, v247, v231
  v_cvt_pk_bf16_f32 v75, v230, v231
  v_exp_f32 v226, v170
  v_mfma_f32_32x32x16_bf16 v[176:191], a[168:171], a[40:43], v[176:191]
  ds_read_b128 a[240:243], v236 offset:256
  ds_read_b128 a[244:247], v237 offset:256
  v_exp_f32 v227, v171
  v_add_f32 v246, v246, v224
  v_add_f32 v247, v247, v225
  v_mfma_f32_32x32x16_bf16 v[176:191], a[172:175], a[44:47], v[176:191]
  ds_read_b128 a[248:251], v238 offset:256
  v_cvt_pk_bf16_f32 v76, v224, v225
  v_exp_f32 v228, v172
  v_exp_f32 v229, v173
  v_mfma_f32_32x32x16_bf16 v[176:191], a[176:179], a[48:51], v[176:191]
  ds_read_b128 a[252:255], v239 offset:256
  v_add_f32 v246, v246, v226
  v_add_f32 v247, v247, v227
  v_cvt_pk_bf16_f32 v77, v226, v227
  v_exp_f32 v230, v174
  v_mfma_f32_32x32x16_bf16 v[176:191], a[180:183], a[52:55], v[176:191]
  v_exp_f32 v231, v175
  v_add_f32 v246, v246, v228
  v_add_f32 v247, v247, v229
  v_cvt_pk_bf16_f32 v78, v228, v229
  v_mfma_f32_32x32x16_bf16 v[176:191], a[184:187], a[56:59], v[176:191]
  v_add_f32 v246, v246, v230
  v_add_f32 v247, v247, v231
  v_cvt_pk_bf16_f32 v79, v230, v231
  v_add_f32 v246, v246, v247
  v_cmp_lt_f32 vcc, s62, v246
  v_add_f32 v244, v244, v246
  v_mfma_f32_32x32x16_bf16 v[176:191], a[188:191], a[60:63], v[176:191]
  s_cbranch_vccnz concat_heads__mha_block_cached__mha_block_cached__near_ridge_kernel_rare12
concat_heads__mha_block_cached__mha_block_cached__near_ridge_kernel_back12:
  s_waitcnt lgkmcnt(0)
  s_waitcnt vmcnt(8)
  s_barrier
  v_mfma_f32_32x32x16_bf16 v[160:175], a[192:195], a[0:3], v[192:207]
  s_add_u32 m0, s33, 0x1c000
  s_add_u32 s75, s72, 0x20000
  v_add_u32 v232, s48, v232
  v_add_u32 v233, s48, v233
  v_mfma_f32_32x32x16_bf16 v[160:175], a[196:199], a[4:7], v[160:175]
  ds_read_b128 a[128:131], v232
  ds_read_b128 a[132:135], v233
  buffer_load_dwordx4 v252, s[8:11], s75 offen nt lds
  v_add_u32 v234, s48, v234
  v_mfma_f32_32x32x16_bf16 v[160:175], a[200:203], a[8:11], v[160:175]
  ds_read_b128 a[136:139], v234
  s_add_u32 s74, s72, 0x20c00
  buffer_load_dwordx4 v252, s[8:11], s74 offen offset:1024 nt lds
  v_exp_f32 v224, v176
  v_add_u32 v235, s48, v235
  v_mfma_f32_32x32x16_bf16 v[160:175], a[204:207], a[12:15], v[160:175]
  ds_read_b128 a[140:143], v235
  s_add_u32 s75, s72, 0x21800
  v_exp_f32 v225, v177
  v_add_u32 v236, s48, v236
  v_add_u32 v237, s48, v237
  v_mfma_f32_32x32x16_bf16 v[160:175], a[208:211], a[16:19], v[160:175]
  ds_read_b128 a[144:147], v236
  ds_read_b128 a[148:151], v237
  v_exp_f32 v226, v178
  v_exp_f32 v227, v179
  v_add_u32 v238, s48, v238
  v_mfma_f32_32x32x16_bf16 v[160:175], a[212:215], a[20:23], v[160:175]
  ds_read_b128 a[152:155], v238
  v_add_f32 v246, v224, v225
  v_cvt_pk_bf16_f32 v80, v224, v225
  v_exp_f32 v228, v180
  v_add_u32 v239, s48, v239
  v_mfma_f32_32x32x16_bf16 v[160:175], a[216:219], a[24:27], v[160:175]
  ds_read_b128 a[156:159], v239
  v_exp_f32 v229, v181
  v_add_f32 v247, v226, v227
  v_cvt_pk_bf16_f32 v81, v226, v227
  v_mfma_f32_32x32x16_bf16 v[160:175], a[220:223], a[28:31], v[160:175]
  ds_read_b128 a[160:163], v232 offset:256
  ds_read_b128 a[164:167], v233 offset:256
  v_exp_f32 v230, v182
  v_exp_f32 v231, v183
  v_mfma_f32_32x32x16_bf16 v[160:175], a[224:227], a[32:35], v[160:175]
  ds_read_b128 a[168:171], v234 offset:256
  v_add_f32 v246, v246, v228
  v_add_f32 v247, v247, v229
  v_cvt_pk_bf16_f32 v82, v228, v229
  v_exp_f32 v224, v184
  v_mfma_f32_32x32x16_bf16 v[160:175], a[228:231], a[36:39], v[160:175]
  ds_read_b128 a[172:175], v235 offset:256
  v_exp_f32 v225, v185
  v_add_f32 v246, v246, v230
  v_add_f32 v247, v247, v231
  v_cvt_pk_bf16_f32 v83, v230, v231
  v_mfma_f32_32x32x16_bf16 v[160:175], a[232:235], a[40:43], v[160:175]
  ds_read_b128 a[176:179], v236 offset:256
  ds_read_b128 a[180:183], v237 offset:256
  v_exp_f32 v226, v186
  v_exp_f32 v227, v187
  v_add_f32 v246, v246, v224
  v_mfma_f32_32x32x16_bf16 v[160:175], a[236:239], a[44:47], v[160:175]
  ds_read_b128 a[184:187], v238 offset:256
  v_add_f32 v247, v247, v225
  v_cvt_pk_bf16_f32 v84, v224, v225
  v_exp_f32 v228, v188
  v_mfma_f32_32x32x16_bf16 v[160:175], a[240:243], a[48:51], v[160:175]
  ds_read_b128 a[188:191], v239 offset:256
  v_exp_f32 v229, v189
  v_add_f32 v246, v246, v226
  v_add_f32 v247, v247, v227
  v_cvt_pk_bf16_f32 v85, v226, v227
  v_mfma_f32_32x32x16_bf16 v[160:175], a[244:247], a[52:55], v[160:175]
  v_exp_f32 v230, v190
  v_exp_f32 v231, v191
  v_add_f32 v246, v246, v228
  v_add_f32 v247, v247, v229
  v_cvt_pk_bf16_f32 v86, v228, v229
  v_mfma_f32_32x32x16_bf16 v[160:175], a[248:251], a[56:59], v[160:175]
  v_add_f32 v246, v246, v230
  v_add_f32 v247, v247, v231
  v_cvt_pk_bf16_f32 v87, v230, v231
  v_add_f32 v246, v246, v247
  v_cmp_lt_f32 vcc, s62, v246
  v_add_f32 v244, v244, v246
  v_mfma_f32_32x32x16_bf16 v[160:175], a[252:255], a[60:63], v[160:175]
  s_cbranch_vccnz concat_heads__mha_block_cached__mha_block_cached__near_ridge_kernel_rare13
concat_heads__mha_block_cached__mha_block_cached__near_ridge_kernel_back13:
  s_waitcnt lgkmcnt(0)
  v_mfma_f32_32x32x16_bf16 v[176:191], a[128:131], a[0:3], v[192:207]
  buffer_load_dwordx4 v252, s[8:11], s75 offen offset:2048 nt lds
  s_add_u32 s74, s72, 0x22400
  buffer_load_dwordx4 v252, s[8:11], s74 offen offset:3072 nt lds
  s_add_u32 m0, s33, 0x8000
  s_add_u32 s75, s72, 0x30000
  v_mfma_f32_32x32x16_bf16 v[176:191], a[132:135], a[4:7], v[176:191]
  buffer_load_dwordx4 v252, s[8:11], s75 offen nt lds
  s_add_u32 s74, s72, 0x30c00
  buffer_load_dwordx4 v252, s[8:11], s74 offen offset:1024 nt lds
  s_add_u32 s75, s72, 0x31800
  v_mfma_f32_32x32x16_bf16 v[176:191], a[136:139], a[8:11], v[176:191]
  buffer_load_dwordx4 v252, s[8:11], s75 offen offset:2048 nt lds
  s_add_u32 s74, s72, 0x32400
  buffer_load_dwordx4 v252, s[8:11], s74 offen offset:3072 nt lds
  s_add_u32 m0, s33, 0xc000
  s_add_u32 s75, s72, 0x80
  v_mfma_f32_32x32x16_bf16 v[176:191], a[140:143], a[12:15], v[176:191]
  buffer_load_dwordx4 v252, s[8:11], s75 offen nt lds
  s_add_u32 s74, s72, 0xc80
  buffer_load_dwordx4 v252, s[8:11], s74 offen offset:1024 nt lds
  s_add_u32 s75, s72, 0x1880
  v_exp_f32 v224, v160
  v_mfma_f32_32x32x16_bf16 v[176:191], a[144:147], a[16:19], v[176:191]
  v_exp_f32 v225, v161
  v_exp_f32 v226, v162
  v_exp_f32 v227, v163
  v_mfma_f32_32x32x16_bf16 v[176:191], a[148:151], a[20:23], v[176:191]
  v_add_f32 v246, v224, v225
  v_cvt_pk_bf16_f32 v88, v224, v225
  v_exp_f32 v228, v164
  v_mfma_f32_32x32x16_bf16 v[176:191], a[152:155], a[24:27], v[176:191]
  v_exp_f32 v229, v165
  v_add_f32 v247, v226, v227
  v_cvt_pk_bf16_f32 v89, v226, v227
  v_exp_f32 v230, v166
  v_mfma_f32_32x32x16_bf16 v[176:191], a[156:159], a[28:31], v[176:191]
  v_exp_f32 v231, v167
  v_add_f32 v246, v246, v228
  v_add_f32 v247, v247, v229
  v_mfma_f32_32x32x16_bf16 v[176:191], a[160:163], a[32:35], v[176:191]
  v_cvt_pk_bf16_f32 v90, v228, v229
  v_exp_f32 v224, v168
  v_exp_f32 v225, v169
  v_mfma_f32_32x32x16_bf16 v[176:191], a[164:167], a[36:39], v[176:191]
  v_add_f32 v246, v246, v230
  v_add_f32 v247, v247, v231
  v_cvt_pk_bf16_f32 v91, v230, v231
  v_exp_f32 v226, v170
  v_mfma_f32_32x32x16_bf16 v[176:191], a[168:171], a[40:43], v[176:191]
  v_exp_f32 v227, v171
  v_add_f32 v246, v246, v224
  v_add_f32 v247, v247, v225
  v_cvt_pk_bf16_f32 v92, v224, v225
  v_mfma_f32_32x32x16_bf16 v[176:191], a[172:175], a[44:47], v[176:191]
  v_exp_f32 v228, v172
  v_exp_f32 v229, v173
  v_add_f32 v246, v246, v226
  v_mfma_f32_32x32x16_bf16 v[176:191], a[176:179], a[48:51], v[176:191]
  v_add_f32 v247, v247, v227
  v_cvt_pk_bf16_f32 v93, v226, v227
  v_exp_f32 v230, v174
  v_exp_f32 v231, v175
  v_mfma_f32_32x32x16_bf16 v[176:191], a[180:183], a[52:55], v[176:191]
  v_add_f32 v246, v246, v228
  v_add_f32 v247, v247, v229
  v_cvt_pk_bf16_f32 v94, v228, v229
  v_add_f32 v246, v246, v230
  v_mfma_f32_32x32x16_bf16 v[176:191], a[184:187], a[56:59], v[176:191]
  v_add_f32 v247, v247, v231
  v_cvt_pk_bf16_f32 v95, v230, v231
  v_add_f32 v246, v246, v247
  v_cmp_lt_f32 vcc, s62, v246
  v_add_f32 v244, v244, v246
  v_mfma_f32_32x32x16_bf16 v[176:191], a[188:191], a[60:63], v[176:191]
  s_cbranch_vccnz concat_heads__mha_block_cached__mha_block_cached__near_ridge_kernel_rare14
concat_heads__mha_block_cached__mha_block_cached__near_ridge_kernel_back14:
  s_waitcnt lgkmcnt(0)
  v_mfma_f32_32x32x16_bf16 v[160:175], a[128:131], a[64:67], v[208:223]
  buffer_load_dwordx4 v252, s[8:11], s75 offen offset:2048 nt lds
  s_add_u32 s74, s72, 0x2480
  v_add_u32 v232, s49, v232
  v_add_u32 v233, s49, v233
  v_mfma_f32_32x32x16_bf16 v[160:175], a[132:135], a[68:71], v[160:175]
  ds_read_b128 a[192:195], v232
  ds_read_b128 a[196:199], v233
  buffer_load_dwordx4 v252, s[8:11], s74 offen offset:3072 nt lds
  v_add_u32 v234, s49, v234
  v_mfma_f32_32x32x16_bf16 v[160:175], a[136:139], a[72:75], v[160:175]
  ds_read_b128 a[200:203], v234
  s_add_u32 m0, s33, 0x10000
  s_add_u32 s75, s72, 0x10080
  v_exp_f32 v224, v176
  v_add_u32 v235, s49, v235
  v_mfma_f32_32x32x16_bf16 v[160:175], a[140:143], a[76:79], v[160:175]
  ds_read_b128 a[204:207], v235
  buffer_load_dwordx4 v252, s[8:11], s75 offen nt lds
  v_exp_f32 v225, v177
  v_add_u32 v236, s49, v236
  v_add_u32 v237, s49, v237
  v_mfma_f32_32x32x16_bf16 v[160:175], a[144:147], a[80:83], v[160:175]
  ds_read_b128 a[208:211], v236
  ds_read_b128 a[212:215], v237
  v_exp_f32 v226, v178
  v_exp_f32 v227, v179
  v_add_u32 v238, s49, v238
  v_mfma_f32_32x32x16_bf16 v[160:175], a[148:151], a[84:87], v[160:175]
  ds_read_b128 a[216:219], v238
  v_add_f32 v246, v224, v225
  v_cvt_pk_bf16_f32 v96, v224, v225
  v_exp_f32 v228, v180
  v_add_u32 v239, s49, v239
  v_mfma_f32_32x32x16_bf16 v[160:175], a[152:155], a[88:91], v[160:175]
  ds_read_b128 a[220:223], v239
  v_exp_f32 v229, v181
  v_add_f32 v247, v226, v227
  v_cvt_pk_bf16_f32 v97, v226, v227
  v_mfma_f32_32x32x16_bf16 v[160:175], a[156:159], a[92:95], v[160:175]
  ds_read_b128 a[224:227], v232 offset:256
  ds_read_b128 a[228:231], v233 offset:256
  v_exp_f32 v230, v182
  v_exp_f32 v231, v183
  v_mfma_f32_32x32x16_bf16 v[160:175], a[160:163], a[96:99], v[160:175]
  ds_read_b128 a[232:235], v234 offset:256
  v_add_f32 v246, v246, v228
  v_add_f32 v247, v247, v229
  v_cvt_pk_bf16_f32 v98, v228, v229
  v_exp_f32 v224, v184
  v_mfma_f32_32x32x16_bf16 v[160:175], a[164:167], a[100:103], v[160:175]
  ds_read_b128 a[236:239], v235 offset:256
  v_exp_f32 v225, v185
  v_add_f32 v246, v246, v230
  v_add_f32 v247, v247, v231
  v_cvt_pk_bf16_f32 v99, v230, v231
  v_mfma_f32_32x32x16_bf16 v[160:175], a[168:171], a[104:107], v[160:175]
  ds_read_b128 a[240:243], v236 offset:256
  ds_read_b128 a[244:247], v237 offset:256
  v_exp_f32 v226, v186
  v_exp_f32 v227, v187
  v_add_f32 v246, v246, v224
  v_mfma_f32_32x32x16_bf16 v[160:175], a[172:175], a[108:111], v[160:175]
  ds_read_b128 a[248:251], v238 offset:256
  v_add_f32 v247, v247, v225
  v_cvt_pk_bf16_f32 v100, v224, v225
  v_exp_f32 v228, v188
  v_mfma_f32_32x32x16_bf16 v[160:175], a[176:179], a[112:115], v[160:175]
  ds_read_b128 a[252:255], v239 offset:256
  v_exp_f32 v229, v189
  v_add_f32 v246, v246, v226
  v_add_f32 v247, v247, v227
  v_cvt_pk_bf16_f32 v101, v226, v227
  v_mfma_f32_32x32x16_bf16 v[160:175], a[180:183], a[116:119], v[160:175]
  v_exp_f32 v230, v190
  v_exp_f32 v231, v191
  v_add_f32 v246, v246, v228
  v_add_f32 v247, v247, v229
  v_cvt_pk_bf16_f32 v102, v228, v229
  v_mfma_f32_32x32x16_bf16 v[160:175], a[184:187], a[120:123], v[160:175]
  v_add_f32 v246, v246, v230
  v_add_f32 v247, v247, v231
  v_cvt_pk_bf16_f32 v103, v230, v231
  v_add_f32 v246, v246, v247
  v_cmp_lt_f32 vcc, s62, v246
  v_add_f32 v244, v244, v246
  v_mfma_f32_32x32x16_bf16 v[160:175], a[188:191], a[124:127], v[160:175]
  s_cbranch_vccnz concat_heads__mha_block_cached__mha_block_cached__near_ridge_kernel_rare15
concat_heads__mha_block_cached__mha_block_cached__near_ridge_kernel_back15:
  s_waitcnt lgkmcnt(0)
  v_mfma_f32_32x32x16_bf16 v[176:191], a[192:195], a[0:3], v[192:207]
  s_add_u32 s74, s72, 0x10c80
  buffer_load_dwordx4 v252, s[8:11], s74 offen offset:1024 nt lds
  v_add_u32 v232, s50, v232
  v_add_u32 v233, s50, v233
  v_mfma_f32_32x32x16_bf16 v[176:191], a[196:199], a[4:7], v[176:191]
  ds_read_b128 a[128:131], v232
  ds_read_b128 a[132:135], v233
  s_add_u32 s75, s72, 0x11880
  v_add_u32 v234, s50, v234
  v_mfma_f32_32x32x16_bf16 v[176:191], a[200:203], a[8:11], v[176:191]
  ds_read_b128 a[136:139], v234
  buffer_load_dwordx4 v252, s[8:11], s75 offen offset:2048 nt lds
  s_add_u32 s74, s72, 0x12480
  v_exp_f32 v224, v160
  v_add_u32 v235, s50, v235
  v_mfma_f32_32x32x16_bf16 v[176:191], a[204:207], a[12:15], v[176:191]
  ds_read_b128 a[140:143], v235
  buffer_load_dwordx4 v252, s[8:11], s74 offen offset:3072 nt lds
  v_exp_f32 v225, v161
  v_add_u32 v236, s50, v236
  v_add_u32 v237, s50, v237
  v_mfma_f32_32x32x16_bf16 v[176:191], a[208:211], a[16:19], v[176:191]
  ds_read_b128 a[144:147], v236
  ds_read_b128 a[148:151], v237
  v_exp_f32 v226, v162
  v_exp_f32 v227, v163
  v_add_u32 v238, s50, v238
  v_mfma_f32_32x32x16_bf16 v[176:191], a[212:215], a[20:23], v[176:191]
  ds_read_b128 a[152:155], v238
  v_add_f32 v246, v224, v225
  v_cvt_pk_bf16_f32 v152, v224, v225
  v_exp_f32 v228, v164
  v_add_u32 v239, s50, v239
  v_mfma_f32_32x32x16_bf16 v[176:191], a[216:219], a[24:27], v[176:191]
  ds_read_b128 a[156:159], v239
  v_exp_f32 v229, v165
  v_add_f32 v247, v226, v227
  v_cvt_pk_bf16_f32 v153, v226, v227
  v_mfma_f32_32x32x16_bf16 v[176:191], a[220:223], a[28:31], v[176:191]
  ds_read_b128 a[160:163], v232 offset:256
  ds_read_b128 a[164:167], v233 offset:256
  v_exp_f32 v230, v166
  v_exp_f32 v231, v167
  v_mfma_f32_32x32x16_bf16 v[176:191], a[224:227], a[32:35], v[176:191]
  ds_read_b128 a[168:171], v234 offset:256
  v_add_f32 v246, v246, v228
  v_add_f32 v247, v247, v229
  v_cvt_pk_bf16_f32 v154, v228, v229
  v_exp_f32 v224, v168
  v_mfma_f32_32x32x16_bf16 v[176:191], a[228:231], a[36:39], v[176:191]
  ds_read_b128 a[172:175], v235 offset:256
  v_exp_f32 v225, v169
  v_add_f32 v246, v246, v230
  v_add_f32 v247, v247, v231
  v_cvt_pk_bf16_f32 v155, v230, v231
  v_mfma_f32_32x32x16_bf16 v[176:191], a[232:235], a[40:43], v[176:191]
  ds_read_b128 a[176:179], v236 offset:256
  ds_read_b128 a[180:183], v237 offset:256
  v_exp_f32 v226, v170
  v_exp_f32 v227, v171
  v_add_f32 v246, v246, v224
  v_mfma_f32_32x32x16_bf16 v[176:191], a[236:239], a[44:47], v[176:191]
  ds_read_b128 a[184:187], v238 offset:256
  v_add_f32 v247, v247, v225
  v_cvt_pk_bf16_f32 v156, v224, v225
  v_exp_f32 v228, v172
  v_mfma_f32_32x32x16_bf16 v[176:191], a[240:243], a[48:51], v[176:191]
  ds_read_b128 a[188:191], v239 offset:256
  v_exp_f32 v229, v173
  v_add_f32 v246, v246, v226
  v_add_f32 v247, v247, v227
  v_cvt_pk_bf16_f32 v157, v226, v227
  v_mfma_f32_32x32x16_bf16 v[176:191], a[244:247], a[52:55], v[176:191]
  v_exp_f32 v230, v174
  v_exp_f32 v231, v175
  v_add_f32 v246, v246, v228
  v_add_f32 v247, v247, v229
  v_cvt_pk_bf16_f32 v158, v228, v229
  v_mfma_f32_32x32x16_bf16 v[176:191], a[248:251], a[56:59], v[176:191]
  v_add_f32 v246, v246, v230
  v_add_f32 v247, v247, v231
  v_cvt_pk_bf16_f32 v159, v230, v231
  v_add_f32 v246, v246, v247
  v_cmp_lt_f32 vcc, s62, v246
  v_add_f32 v245, v245, v246
  v_mfma_f32_32x32x16_bf16 v[176:191], a[252:255], a[60:63], v[176:191]
  s_cbranch_vccnz concat_heads__mha_block_cached__mha_block_cached__near_ridge_kernel_rare16
concat_heads__mha_block_cached__mha_block_cached__near_ridge_kernel_back16:
  s_waitcnt lgkmcnt(0)
  v_mfma_f32_32x32x16_bf16 v[160:175], a[128:131], a[0:3], v[192:207]
  v_add_u32 v232, s51, v232
  v_add_u32 v233, s51, v233
  v_mfma_f32_32x32x16_bf16 v[160:175], a[132:135], a[4:7], v[160:175]
  ds_read_b128 a[192:195], v232
  ds_read_b128 a[196:199], v233
  v_add_u32 v234, s51, v234
  v_mfma_f32_32x32x16_bf16 v[160:175], a[136:139], a[8:11], v[160:175]
  ds_read_b128 a[200:203], v234
  s_nop 0
  v_exp_f32 v224, v176
  v_exp_f32 v225, v177
  v_add_u32 v235, s51, v235
  v_mfma_f32_32x32x16_bf16 v[160:175], a[140:143], a[12:15], v[160:175]
  ds_read_b128 a[204:207], v235
  v_exp_f32 v226, v178
  v_add_u32 v236, s51, v236
  v_add_u32 v237, s51, v237
  v_mfma_f32_32x32x16_bf16 v[160:175], a[144:147], a[16:19], v[160:175]
  ds_read_b128 a[208:211], v236
  ds_read_b128 a[212:215], v237
  v_exp_f32 v227, v179
  v_add_f32 v246, v224, v225
  v_cvt_pk_bf16_f32 v104, v224, v225
  v_add_u32 v238, s51, v238
  v_mfma_f32_32x32x16_bf16 v[160:175], a[148:151], a[20:23], v[160:175]
  ds_read_b128 a[216:219], v238
  v_exp_f32 v228, v180
  v_exp_f32 v229, v181
  v_add_u32 v239, s51, v239
  v_mfma_f32_32x32x16_bf16 v[160:175], a[152:155], a[24:27], v[160:175]
  ds_read_b128 a[220:223], v239
  v_add_f32 v247, v226, v227
  v_cvt_pk_bf16_f32 v105, v226, v227
  v_exp_f32 v230, v182
  v_mfma_f32_32x32x16_bf16 v[160:175], a[156:159], a[28:31], v[160:175]
  ds_read_b128 a[224:227], v232 offset:256
  ds_read_b128 a[228:231], v233 offset:256
  v_exp_f32 v231, v183
  v_add_f32 v246, v246, v228
  v_add_f32 v247, v247, v229
  v_mfma_f32_32x32x16_bf16 v[160:175], a[160:163], a[32:35], v[160:175]
  ds_read_b128 a[232:235], v234 offset:256
  v_cvt_pk_bf16_f32 v106, v228, v229
  v_exp_f32 v224, v184
  v_exp_f32 v225, v185
  v_mfma_f32_32x32x16_bf16 v[160:175], a[164:167], a[36:39], v[160:175]
  ds_read_b128 a[236:239], v235 offset:256
  v_add_f32 v246, v246, v230
  v_add_f32 v247, v247, v231
  v_cvt_pk_bf16_f32 v107, v230, v231
  v_exp_f32 v226, v186
  v_mfma_f32_32x32x16_bf16 v[160:175], a[168:171], a[40:43], v[160:175]
  ds_read_b128 a[240:243], v236 offset:256
  ds_read_b128 a[244:247], v237 offset:256
  v_exp_f32 v227, v187
  v_add_f32 v246, v246, v224
  v_add_f32 v247, v247, v225
  v_mfma_f32_32x32x16_bf16 v[160:175], a[172:175], a[44:47], v[160:175]
  ds_read_b128 a[248:251], v238 offset:256
  v_cvt_pk_bf16_f32 v108, v224, v225
  v_exp_f32 v228, v188
  v_exp_f32 v229, v189
  v_mfma_f32_32x32x16_bf16 v[160:175], a[176:179], a[48:51], v[160:175]
  ds_read_b128 a[252:255], v239 offset:256
  v_add_f32 v246, v246, v226
  v_add_f32 v247, v247, v227
  v_cvt_pk_bf16_f32 v109, v226, v227
  v_exp_f32 v230, v190
  v_mfma_f32_32x32x16_bf16 v[160:175], a[180:183], a[52:55], v[160:175]
  v_exp_f32 v231, v191
  v_add_f32 v246, v246, v228
  v_add_f32 v247, v247, v229
  v_cvt_pk_bf16_f32 v110, v228, v229
  v_mfma_f32_32x32x16_bf16 v[160:175], a[184:187], a[56:59], v[160:175]
  v_add_f32 v246, v246, v230
  v_add_f32 v247, v247, v231
  v_cvt_pk_bf16_f32 v111, v230, v231
  v_add_f32 v246, v246, v247
  v_cmp_lt_f32 vcc, s62, v246
  v_add_f32 v244, v244, v246
  v_mfma_f32_32x32x16_bf16 v[160:175], a[188:191], a[60:63], v[160:175]
  s_cbranch_vccnz concat_heads__mha_block_cached__mha_block_cached__near_ridge_kernel_rare17
concat_heads__mha_block_cached__mha_block_cached__near_ridge_kernel_back17:
  s_waitcnt lgkmcnt(0)
  s_barrier
  v_mfma_f32_32x32x16_bf16 v[176:191], a[192:195], a[0:3], v[192:207]
  s_add_u32 m0, s33, 0
  s_add_u32 s75, s72, 0x20080
  v_mfma_f32_32x32x16_bf16 v[176:191], a[196:199], a[4:7], v[176:191]
  buffer_load_dwordx4 v252, s[8:11], s75 offen nt lds
  s_add_u32 s74, s72, 0x20c80
  buffer_load_dwordx4 v252, s[8:11], s74 offen offset:1024 nt lds
  v_mfma_f32_32x32x16_bf16 v[176:191], a[200:203], a[8:11], v[176:191]
  s_add_u32 s75, s72, 0x21880
  buffer_load_dwordx4 v252, s[8:11], s75 offen offset:2048 nt lds
  v_exp_f32 v224, v160
  v_exp_f32 v225, v161
  v_mfma_f32_32x32x16_bf16 v[176:191], a[204:207], a[12:15], v[176:191]
  s_add_u32 s74, s72, 0x22480
  buffer_load_dwordx4 v252, s[8:11], s74 offen offset:3072 nt lds
  v_exp_f32 v226, v162
  v_mfma_f32_32x32x16_bf16 v[176:191], a[208:211], a[16:19], v[176:191]
  v_exp_f32 v227, v163
  v_add_f32 v246, v224, v225
  v_cvt_pk_bf16_f32 v112, v224, v225
  v_mfma_f32_32x32x16_bf16 v[176:191], a[212:215], a[20:23], v[176:191]
  v_exp_f32 v228, v164
  v_exp_f32 v229, v165
  v_add_f32 v247, v226, v227
  v_mfma_f32_32x32x16_bf16 v[176:191], a[216:219], a[24:27], v[176:191]
  v_cvt_pk_bf16_f32 v113, v226, v227
  v_exp_f32 v230, v166
  v_exp_f32 v231, v167
  v_mfma_f32_32x32x16_bf16 v[176:191], a[220:223], a[28:31], v[176:191]
  v_add_f32 v246, v246, v228
  v_add_f32 v247, v247, v229
  v_cvt_pk_bf16_f32 v114, v228, v229
  v_exp_f32 v224, v168
  v_mfma_f32_32x32x16_bf16 v[176:191], a[224:227], a[32:35], v[176:191]
  v_exp_f32 v225, v169
  v_add_f32 v246, v246, v230
  v_add_f32 v247, v247, v231
  v_mfma_f32_32x32x16_bf16 v[176:191], a[228:231], a[36:39], v[176:191]
  v_cvt_pk_bf16_f32 v115, v230, v231
  v_exp_f32 v226, v170
  v_exp_f32 v227, v171
  v_mfma_f32_32x32x16_bf16 v[176:191], a[232:235], a[40:43], v[176:191]
  v_add_f32 v246, v246, v224
  v_add_f32 v247, v247, v225
  v_cvt_pk_bf16_f32 v116, v224, v225
  v_exp_f32 v228, v172
  v_mfma_f32_32x32x16_bf16 v[176:191], a[236:239], a[44:47], v[176:191]
  v_exp_f32 v229, v173
  v_add_f32 v246, v246, v226
  v_add_f32 v247, v247, v227
  v_mfma_f32_32x32x16_bf16 v[176:191], a[240:243], a[48:51], v[176:191]
  v_cvt_pk_bf16_f32 v117, v226, v227
  v_exp_f32 v230, v174
  v_exp_f32 v231, v175
  v_mfma_f32_32x32x16_bf16 v[176:191], a[244:247], a[52:55], v[176:191]
  v_add_f32 v246, v246, v228
  v_add_f32 v247, v247, v229
  v_cvt_pk_bf16_f32 v118, v228, v229
  v_add_f32 v246, v246, v230
  v_mfma_f32_32x32x16_bf16 v[176:191], a[248:251], a[56:59], v[176:191]
  v_add_f32 v247, v247, v231
  v_cvt_pk_bf16_f32 v119, v230, v231
  v_add_f32 v246, v246, v247
  v_cmp_lt_f32 vcc, s62, v246
  v_add_f32 v244, v244, v246
  v_mfma_f32_32x32x16_bf16 v[176:191], a[252:255], a[60:63], v[176:191]
  s_cbranch_vccnz concat_heads__mha_block_cached__mha_block_cached__near_ridge_kernel_rare18
concat_heads__mha_block_cached__mha_block_cached__near_ridge_kernel_back18:
  s_nop 7
  s_nop 3
  v_exp_f32 v224, v176
  v_exp_f32 v225, v177
  v_exp_f32 v226, v178
  v_exp_f32 v227, v179
  v_add_f32 v246, v224, v225
  v_cvt_pk_bf16_f32 v120, v224, v225
  v_exp_f32 v228, v180
  v_exp_f32 v229, v181
  v_add_f32 v247, v226, v227
  v_cvt_pk_bf16_f32 v121, v226, v227
  v_exp_f32 v230, v182
  v_exp_f32 v231, v183
  v_add_f32 v246, v246, v228
  v_add_f32 v247, v247, v229
  v_cvt_pk_bf16_f32 v122, v228, v229
  v_exp_f32 v224, v184
  v_exp_f32 v225, v185
  v_add_f32 v246, v246, v230
  v_add_f32 v247, v247, v231
  v_cvt_pk_bf16_f32 v123, v230, v231
  v_exp_f32 v226, v186
  v_exp_f32 v227, v187
  v_add_f32 v246, v246, v224
  v_add_f32 v247, v247, v225
  v_cvt_pk_bf16_f32 v124, v224, v225
  v_exp_f32 v228, v188
  v_exp_f32 v229, v189
  v_add_f32 v246, v246, v226
  v_add_f32 v247, v247, v227
  v_cvt_pk_bf16_f32 v125, v226, v227
  v_exp_f32 v230, v190
  v_exp_f32 v231, v191
  v_add_f32 v246, v246, v228
  v_add_f32 v247, v247, v229
  v_cvt_pk_bf16_f32 v126, v228, v229
  v_add_f32 v246, v246, v230
  v_add_f32 v247, v247, v231
  v_cvt_pk_bf16_f32 v127, v230, v231
  v_add_f32 v246, v246, v247
  v_cmp_lt_f32 vcc, s62, v246
  v_add_f32 v244, v244, v246
  s_nop 0
  s_cbranch_vccnz concat_heads__mha_block_cached__mha_block_cached__near_ridge_kernel_rare19
concat_heads__mha_block_cached__mha_block_cached__near_ridge_kernel_back19:
concat_heads__mha_block_cached__mha_block_cached__near_ridge_kernel_late:
  v_mov_b32 v253, v244
  s_nop 1
  v_permlane32_swap_b32 v244, v253
  v_add_f32 v244, v244, v253
  v_rcp_f32 v219, v244
  v_mov_b32 v253, v245
  s_nop 1
  v_permlane32_swap_b32 v245, v253
  v_add_f32 v245, v245, v253
  v_and_b32 v160, 31, v255
  v_lshlrev_b32 v160, 3, v160
  s_lshl_b32 s29, s3, 8
  s_add_u32 s29, s29, 0x24000
  v_add_u32 v161, s29, v160
  v_sub_f32 v162, 0, v208
  v_mov_b32 v163, v245
  ds_write_b64 v161, v[162:163]
  s_lshl_b32 s29, s3, 2
  s_add_u32 s29, s29, 0x24400
  v_mov_b32 v164, s29
  v_mov_b32 v165, s35
  ds_write_b32 v164, v165
  s_waitcnt lgkmcnt(0)
  s_barrier
  v_add_u32 v161, 0x24000, v160
  ds_read_b64 v[168:169], v161
  ds_read_b64 v[170:171], v161 offset:256
  ds_read_b64 v[172:173], v161 offset:512
  ds_read_b64 v[174:175], v161 offset:768
  v_mov_b32 v164, 0x24400
  ds_read_b128 v[176:179], v164
  s_waitcnt lgkmcnt(0)
  v_or_b32 v176, v176, v177
  v_or_b32 v178, v178, v179
  v_or_b32 v176, v176, v178
  s_nop 0
  v_readfirstlane_b32 s29, v176
  s_nop 1
  s_andn2_b32 s29, s29, s63
  s_cmp_lg_u32 s29, 0
  s_cbranch_scc1 concat_heads__mha_block_cached__mha_block_cached__near_ridge_kernel_restart
  v_max3_f32 v166, v168, v170, v172
  v_max_f32 v166, v166, v174
  v_sub_f32 v180, v168, v166
  v_cvt_i32_f32 v180, v180
  v_ldexp_f32 v184, v169, v180
  v_sub_f32 v181, v170, v166
  v_cvt_i32_f32 v181, v181
  v_ldexp_f32 v185, v171, v181
  v_sub_f32 v182, v172, v166
  v_cvt_i32_f32 v182, v182
  v_ldexp_f32 v186, v173, v182
  v_sub_f32 v183, v174, v166
  v_cvt_i32_f32 v183, v183
  v_ldexp_f32 v187, v175, v183
  v_add_f32 v184, v184, v185
  v_add_f32 v186, v186, v187
  v_add_f32 v184, v184, v186
  v_rcp_f32 v184, v184
  v_add_f32 v167, v166, v208
  v_cvt_u32_f32 v167, v167
  v_min_u32 v167, 0xff, v167
  v_lshlrev_b32 v167, 7, v167
  v_lshl_or_b32 v167, v167, 16, v167
  v_pk_sub_u16 v128, v128, v167 clamp
  v_pk_sub_u16 v129, v129, v167 clamp
  v_pk_sub_u16 v130, v130, v167 clamp
  v_pk_sub_u16 v131, v131, v167 clamp
  v_pk_sub_u16 v132, v132, v167 clamp
  v_pk_sub_u16 v133, v133, v167 clamp
  v_pk_sub_u16 v134, v134, v167 clamp
  v_pk_sub_u16 v135, v135, v167 clamp
  v_pk_sub_u16 v136, v136, v167 clamp
  v_pk_sub_u16 v137, v137, v167 clamp
  v_pk_sub_u16 v138, v138, v167 clamp
  v_pk_sub_u16 v139, v139, v167 clamp
  v_pk_sub_u16 v140, v140, v167 clamp
  v_pk_sub_u16 v141, v141, v167 clamp
  v_pk_sub_u16 v142, v142, v167 clamp
  v_pk_sub_u16 v143, v143, v167 clamp
  v_pk_sub_u16 v144, v144, v167 clamp
  v_pk_sub_u16 v145, v145, v167 clamp
  v_pk_sub_u16 v146, v146, v167 clamp
  v_pk_sub_u16 v147, v147, v167 clamp
  v_pk_sub_u16 v148, v148, v167 clamp
  v_pk_sub_u16 v149, v149, v167 clamp
  v_pk_sub_u16 v150, v150, v167 clamp
  v_pk_sub_u16 v151, v151, v167 clamp
  v_pk_sub_u16 v152, v152, v167 clamp
  v_pk_sub_u16 v153, v153, v167 clamp
  v_pk_sub_u16 v154, v154, v167 clamp
  v_pk_sub_u16 v155, v155, v167 clamp
  v_pk_sub_u16 v156, v156, v167 clamp
  v_pk_sub_u16 v157, v157, v167 clamp
  v_pk_sub_u16 v158, v158, v167 clamp
  v_pk_sub_u16 v159, v159, v167 clamp
  v_and_b32 v165, 15, v255
  v_lshlrev_b32 v165, 2, v165
  v_add_u32 v164, 64, v165
  ds_bpermute_b32 v220, v165, v184
  ds_bpermute_b32 v221, v164, v184
  v_lshrrev_b32 v160, 4, v255
  v_and_b32 v160, 1, v160
  v_lshlrev_b32 v160, 10, v160
  v_lshrrev_b32 v161, 5, v255
  v_lshlrev_b32 v161, 4, v161
  v_and_b32 v162, 15, v255
  v_add_u32 v161, v161, v162
  v_lshl_add_u32 v160, v161, 4, v160
  s_lshl_b32 s29, s3, 11
  v_add_u32 v160, s29, v160
  v_add_u32 v162, 0x14000, v160
  v_add_u32 v163, 0x20000, v160
  ds_write_b128 v162, v[128:131]
  ds_write_b128 v162, v[132:135] offset:512
  ds_write_b128 v162, v[136:139] offset:8192
  ds_write_b128 v162, v[140:143] offset:8704
  ds_write_b128 v163, v[144:147]
  ds_write_b128 v163, v[148:151] offset:512
  ds_write_b128 v163, v[152:155] offset:8192
  ds_write_b128 v163, v[156:159] offset:8704
  s_waitcnt lgkmcnt(0)
  v_and_b32 v198, 31, v255
  v_lshrrev_b32 v199, 5, v255
  v_lshrrev_b32 v200, 4, v255
  v_and_b32 v201, 15, v255
  v_lshrrev_b32 v202, 2, v201
  v_and_b32 v203, 3, v255
  v_and_b32 v204, 1, v200
  v_lshl_add_u32 v224, v199, 2, v202
  v_lshlrev_b32 v224, 7, v224
  v_and_b32 v225, 1, v203
  v_lshl_add_u32 v224, v225, 3, v224
  v_lshrrev_b32 v225, 1, v203
  v_lshrrev_b32 v226, 1, v202
  v_lshlrev_b32 v226, 2, v226
  v_lshl_add_u32 v227, v204, 1, v225
  v_xor_b32 v227, v227, v226
  v_lshlrev_b32 v228, 1, v199
  v_xor_b32 v227, v227, v228
  s_xor_b32 s29, s3, 0
  s_lshl_b32 s29, s29, 12
  s_add_u32 s29, s29, 0x4000
  v_lshl_add_u32 v229, v227, 4, v224
  v_add_u32 v208, s29, v229
  v_xor_b32 v209, 64, v208
  s_xor_b32 s29, s3, 1
  s_lshl_b32 s29, s29, 12
  s_add_u32 s29, s29, 0x4000
  v_lshl_add_u32 v229, v227, 4, v224
  v_add_u32 v210, s29, v229
  v_xor_b32 v211, 64, v210
  s_xor_b32 s29, s3, 2
  s_lshl_b32 s29, s29, 12
  s_add_u32 s29, s29, 0x4000
  v_lshl_add_u32 v229, v227, 4, v224
  v_add_u32 v212, s29, v229
  v_xor_b32 v213, 64, v212
  s_xor_b32 s29, s3, 3
  s_lshl_b32 s29, s29, 12
  s_add_u32 s29, s29, 0x4000
  v_lshl_add_u32 v229, v227, 4, v224
  v_add_u32 v214, s29, v229
  v_xor_b32 v215, 64, v214
  v_lshlrev_b32 v229, 4, v199
  v_lshl_add_u32 v229, v204, 2, v229
  v_add_u32 v229, v229, v202
  v_lshlrev_b32 v229, 7, v229
  v_and_b32 v230, 1, v203
  v_lshl_add_u32 v229, v230, 3, v229
  s_lshl_b32 s29, s3, 1
  v_add_u32 v230, s29, v225
  v_xor_b32 v230, v230, v226
  v_lshlrev_b32 v231, 1, v204
  v_xor_b32 v230, v230, v231
  v_lshl_add_u32 v229, v230, 4, v229
  v_add_u32 v216, 0x4000, v229
  v_lshl_add_u32 v224, v199, 4, v201
  v_lshlrev_b32 v224, 4, v224
  v_lshl_add_u32 v217, v204, 10, v224
  s_and_b32 s29, s3, 1
  s_lshl_b32 s29, s29, 1
  v_add_u32 v224, s29, v204
  v_lshl_add_u32 v224, v224, 4, v201
  v_lshlrev_b32 v224, 4, v224
  v_lshl_add_u32 v218, v199, 3, v224
  s_waitcnt vmcnt(24)
  s_barrier
  v_lshlrev_b32 v224, 4, v255
  v_add_u32 v225, 0x14000, v224
  v_add_u32 v226, 0x20000, v224
  ds_read_b128 a[0:3], v225
  ds_read_b128 a[4:7], v225 offset:1024
  ds_read_b128 a[8:11], v225 offset:2048
  ds_read_b128 a[12:15], v225 offset:3072
  ds_read_b128 a[16:19], v225 offset:4096
  ds_read_b128 a[20:23], v225 offset:5120
  ds_read_b128 a[24:27], v225 offset:6144
  ds_read_b128 a[28:31], v225 offset:7168
  ds_read_b128 a[32:35], v225 offset:8192
  ds_read_b128 a[36:39], v225 offset:9216
  ds_read_b128 a[40:43], v225 offset:10240
  ds_read_b128 a[44:47], v225 offset:11264
  ds_read_b128 a[48:51], v225 offset:12288
  ds_read_b128 a[52:55], v225 offset:13312
  ds_read_b128 a[56:59], v225 offset:14336
  ds_read_b128 a[60:63], v225 offset:15360
  ds_read_b128 a[64:67], v226
  ds_read_b128 a[68:71], v226 offset:1024
  ds_read_b128 a[72:75], v226 offset:2048
  ds_read_b128 a[76:79], v226 offset:3072
  ds_read_b128 a[80:83], v226 offset:4096
  ds_read_b128 a[84:87], v226 offset:5120
  ds_read_b128 a[88:91], v226 offset:6144
  ds_read_b128 a[92:95], v226 offset:7168
  ds_read_b128 a[96:99], v226 offset:8192
  ds_read_b128 a[100:103], v226 offset:9216
  ds_read_b128 a[104:107], v226 offset:10240
  ds_read_b128 a[108:111], v226 offset:11264
  ds_read_b128 a[112:115], v226 offset:12288
  ds_read_b128 a[116:119], v226 offset:13312
  ds_read_b128 a[120:123], v226 offset:14336
  ds_read_b128 a[124:127], v226 offset:15360
  s_waitcnt lgkmcnt(0)
  ds_read_b64_tr_b16 a[128:129], v208
  ds_read_b64_tr_b16 a[130:131], v208 offset:1024
  ds_read_b64_tr_b16 a[132:133], v209
  ds_read_b64_tr_b16 a[134:135], v209 offset:1024
  ds_read_b64_tr_b16 a[136:137], v208 offset:2048
  ds_read_b64_tr_b16 a[138:139], v208 offset:3072
  ds_read_b64_tr_b16 a[140:141], v209 offset:2048
  ds_read_b64_tr_b16 a[142:143], v209 offset:3072
  ds_read_b64_tr_b16 a[168:169], v216
  ds_read_b64_tr_b16 a[170:171], v216 offset:1024
  ds_read_b64_tr_b16 a[144:145], v210
  ds_read_b64_tr_b16 a[146:147], v210 offset:1024
  s_waitcnt lgkmcnt(10)
  v_mfma_f32_32x32x16_bf16 v[128:143], a[128:131], v[0:3], 0
  ds_read_b64_tr_b16 a[148:149], v211
  ds_read_b64_tr_b16 a[150:151], v211 offset:1024
  s_mov_b32 s16, s52
  s_and_b32 s17, s53, 0xffff
  s_mov_b32 s18, 0x380000
  s_mov_b32 s19, 0x20000
  s_lshl_b32 s29, s25, 10
  s_waitcnt lgkmcnt(10)
  v_mfma_f32_32x32x16_bf16 v[144:159], a[132:135], v[0:3], 0
  ds_read_b64_tr_b16 a[152:153], v210 offset:2048
  ds_read_b64_tr_b16 a[154:155], v210 offset:3072
  s_lshl_b32 s30, s3, 4
  s_add_u32 s29, s29, s30
  s_mul_i32 s64, s29, 0x380
  s_mul_i32 s29, s27, 0xe0
  s_waitcnt lgkmcnt(10)
  v_mfma_f32_32x32x16_bf16 v[128:143], a[136:139], v[4:7], v[128:143]
  ds_read_b64_tr_b16 a[156:157], v211 offset:2048
  ds_read_b64_tr_b16 a[158:159], v211 offset:3072
  s_and_b32 s30, s27, 1
  s_lshl_b32 s30, s30, 5
  s_sub_u32 s29, s29, s30
  s_add_u32 s64, s64, s29
  s_add_u32 s29, s27, 0
  s_waitcnt lgkmcnt(10)
  v_mfma_f32_32x32x16_bf16 v[144:159], a[140:143], v[4:7], v[144:159]
  ds_read_b64_tr_b16 a[172:173], v216 offset:4096
  ds_read_b64_tr_b16 a[174:175], v216 offset:5120
  s_and_b32 s29, s29, 3
  s_mul_i32 s29, s29, 0x38000
  s_add_u32 s62, s64, s29
  s_add_u32 s29, s27, 1
  s_waitcnt lgkmcnt(10)
  v_mfma_f32_16x16x32_bf16 v[160:163], a[168:171], a[0:3], 0
  s_and_b32 s29, s29, 3
  s_mul_i32 s29, s29, 0x38000
  v_mfma_f32_16x16x32_bf16 v[164:167], a[168:171], a[4:7], 0
  ds_read_b64_tr_b16 a[160:161], v212
  ds_read_b64_tr_b16 a[162:163], v212 offset:1024
  s_add_u32 s63, s64, s29
  s_waitcnt lgkmcnt(8)
  v_mfma_f32_32x32x16_bf16 v[128:143], a[144:147], v[8:11], v[128:143]
  ds_read_b64_tr_b16 a[164:165], v213
  ds_read_b64_tr_b16 a[166:167], v213 offset:1024
  s_add_u32 s29, s27, 2
  s_and_b32 s29, s29, 3
  s_mul_i32 s29, s29, 0x38000
  s_add_u32 s73, s64, s29
  v_mfma_f32_32x32x16_bf16 v[144:159], a[148:151], v[8:11], v[144:159]
  ds_read_b64_tr_b16 a[128:129], v212 offset:2048
  ds_read_b64_tr_b16 a[130:131], v212 offset:3072
  s_add_u32 s29, s27, 3
  s_and_b32 s29, s29, 3
  s_mul_i32 s29, s29, 0x38000
  s_add_u32 s35, s64, s29
  v_lshrrev_b32 v224, 4, v255
  s_waitcnt lgkmcnt(8)
  v_mfma_f32_32x32x16_bf16 v[128:143], a[152:155], v[12:15], v[128:143]
  ds_read_b64_tr_b16 a[132:133], v213 offset:2048
  ds_read_b64_tr_b16 a[134:135], v213 offset:3072
  v_and_b32 v225, 15, v255
  v_lshlrev_b32 v230, 1, v224
  v_add_u32 v230, 0, v230
  v_xor_b32 v230, v230, v225
  v_mfma_f32_32x32x16_bf16 v[144:159], a[156:159], v[12:15], v[144:159]
  ds_read_b64_tr_b16 a[176:177], v216 offset:8192
  ds_read_b64_tr_b16 a[178:179], v216 offset:9216
  v_lshlrev_b32 v230, 4, v230
  v_mul_u32_u24 v231, 0x380, v224
  v_add_u32 v222, v230, v231
  v_lshlrev_b32 v230, 1, v224
  v_add_u32 v230, 8, v230
  s_waitcnt lgkmcnt(10)
  v_mfma_f32_16x16x32_bf16 v[160:163], a[172:175], a[8:11], v[160:163]
  v_xor_b32 v230, v230, v225
  v_lshlrev_b32 v230, 4, v230
  v_mfma_f32_16x16x32_bf16 v[164:167], a[172:175], a[12:15], v[164:167]
  ds_read_b64_tr_b16 a[136:137], v214
  ds_read_b64_tr_b16 a[138:139], v214 offset:1024
  s_waitcnt lgkmcnt(8)
  v_mfma_f32_32x32x16_bf16 v[128:143], a[160:163], v[16:19], v[128:143]
  ds_read_b64_tr_b16 a[140:141], v215
  ds_read_b64_tr_b16 a[142:143], v215 offset:1024
  v_mul_u32_u24 v231, 0x380, v224
  v_add_u32 v223, v230, v231
  s_lshl_b32 s29, s26, 2
  s_add_u32 s29, s29, s27
  s_lshl_b32 s29, s29, 5
  v_mfma_f32_32x32x16_bf16 v[144:159], a[164:167], v[16:19], v[144:159]
  ds_read_b64_tr_b16 a[144:145], v214 offset:2048
  ds_read_b64_tr_b16 a[146:147], v214 offset:3072
  s_lshl_b32 s30, s25, 10
  s_add_u32 s29, s29, s30
  s_lshl_b32 s30, s3, 3
  s_add_u32 s29, s29, s30
  s_waitcnt lgkmcnt(8)
  v_mfma_f32_32x32x16_bf16 v[128:143], a[128:131], v[20:23], v[128:143]
  ds_read_b64_tr_b16 a[148:149], v215 offset:2048
  ds_read_b64_tr_b16 a[150:151], v215 offset:3072
  s_mul_i32 s29, s29, 0x380
  v_min_u32 v234, 55, v255
  v_lshlrev_b32 v234, 7, v234
  v_add_u32 v234, s29, v234
  buffer_load_dword a255, v234, s[16:19], 0 offen
  v_mfma_f32_32x32x16_bf16 v[144:159], a[132:135], v[20:23], v[144:159]
  ds_read_b64_tr_b16 a[180:181], v216 offset:12288
  ds_read_b64_tr_b16 a[182:183], v216 offset:13312
  s_waitcnt lgkmcnt(10)
  v_mfma_f32_16x16x32_bf16 v[160:163], a[176:179], a[16:19], v[160:163]
  v_mfma_f32_16x16x32_bf16 v[164:167], a[176:179], a[20:23], v[164:167]
  s_waitcnt lgkmcnt(6)
  v_mfma_f32_32x32x16_bf16 v[128:143], a[136:139], v[24:27], v[128:143]
  s_waitcnt vmcnt(21)
  s_barrier
  v_add_u32 v208, 0x14000, v208
  v_add_u32 v209, 0x14000, v209
  ds_read_b64_tr_b16 a[152:153], v208
  ds_read_b64_tr_b16 a[154:155], v208 offset:1024
  ds_read_b64_tr_b16 a[156:157], v209
  ds_read_b64_tr_b16 a[158:159], v209 offset:1024
  v_mfma_f32_32x32x16_bf16 v[144:159], a[140:143], v[24:27], v[144:159]
  ds_read_b64_tr_b16 a[160:161], v208 offset:2048
  ds_read_b64_tr_b16 a[162:163], v208 offset:3072
  s_add_u32 m0, s33, 0x14000
  s_waitcnt lgkmcnt(8)
  v_mfma_f32_32x32x16_bf16 v[128:143], a[144:147], v[28:31], v[128:143]
  ds_read_b64_tr_b16 a[164:165], v209 offset:2048
  ds_read_b64_tr_b16 a[166:167], v209 offset:3072
  s_add_u32 s75, s72, 0x30080
  v_mfma_f32_32x32x16_bf16 v[144:159], a[148:151], v[28:31], v[144:159]
  v_add_u32 v216, 0x14000, v216
  ds_read_b64_tr_b16 a[168:169], v216
  ds_read_b64_tr_b16 a[170:171], v216 offset:1024
  buffer_load_dwordx4 v252, s[8:11], s75 offen nt lds
  s_waitcnt lgkmcnt(10)
  v_mfma_f32_16x16x32_bf16 v[160:163], a[180:183], a[24:27], v[160:163]
  s_add_u32 s74, s72, 0x30c80
  v_mfma_f32_16x16x32_bf16 v[164:167], a[180:183], a[28:31], v[164:167]
  v_add_u32 v210, 0x14000, v210
  ds_read_b64_tr_b16 a[128:129], v210
  ds_read_b64_tr_b16 a[130:131], v210 offset:1024
  s_waitcnt lgkmcnt(8)
  v_mfma_f32_32x32x16_bf16 v[128:143], a[152:155], v[32:35], v[128:143]
  v_add_u32 v211, 0x14000, v211
  ds_read_b64_tr_b16 a[132:133], v211
  ds_read_b64_tr_b16 a[134:135], v211 offset:1024
  buffer_load_dwordx4 v252, s[8:11], s74 offen offset:1024 nt lds
  v_mfma_f32_32x32x16_bf16 v[144:159], a[156:159], v[32:35], v[144:159]
  ds_read_b64_tr_b16 a[136:137], v210 offset:2048
  ds_read_b64_tr_b16 a[138:139], v210 offset:3072
  s_add_u32 s75, s72, 0x31880
  s_waitcnt lgkmcnt(8)
  v_mfma_f32_32x32x16_bf16 v[128:143], a[160:163], v[36:39], v[128:143]
  ds_read_b64_tr_b16 a[140:141], v211 offset:2048
  ds_read_b64_tr_b16 a[142:143], v211 offset:3072
  buffer_load_dwordx4 v252, s[8:11], s75 offen offset:2048 nt lds
  v_mfma_f32_32x32x16_bf16 v[144:159], a[164:167], v[36:39], v[144:159]
  ds_read_b64_tr_b16 a[172:173], v216 offset:4096
  ds_read_b64_tr_b16 a[174:175], v216 offset:5120
  s_add_u32 s74, s72, 0x32480
  s_waitcnt lgkmcnt(10)
  v_mfma_f32_16x16x32_bf16 v[160:163], a[168:171], a[32:35], v[160:163]
  v_mfma_f32_16x16x32_bf16 v[164:167], a[168:171], a[36:39], v[164:167]
  v_add_u32 v212, 0x14000, v212
  ds_read_b64_tr_b16 a[144:145], v212
  ds_read_b64_tr_b16 a[146:147], v212 offset:1024
  s_waitcnt lgkmcnt(8)
  v_mfma_f32_32x32x16_bf16 v[128:143], a[128:131], v[40:43], v[128:143]
  v_add_u32 v213, 0x14000, v213
  ds_read_b64_tr_b16 a[148:149], v213
  ds_read_b64_tr_b16 a[150:151], v213 offset:1024
  buffer_load_dwordx4 v252, s[8:11], s74 offen offset:3072 nt lds
  v_mfma_f32_32x32x16_bf16 v[144:159], a[132:135], v[40:43], v[144:159]
  ds_read_b64_tr_b16 a[152:153], v212 offset:2048
  ds_read_b64_tr_b16 a[154:155], v212 offset:3072
  s_add_u32 m0, s33, 0x20000
  s_waitcnt lgkmcnt(8)
  v_mfma_f32_32x32x16_bf16 v[128:143], a[136:139], v[44:47], v[128:143]
  ds_read_b64_tr_b16 a[156:157], v213 offset:2048
  ds_read_b64_tr_b16 a[158:159], v213 offset:3072
  s_add_u32 s75, s72, 0x100
  buffer_load_dwordx4 v252, s[8:11], s75 offen nt lds
  v_mfma_f32_32x32x16_bf16 v[144:159], a[140:143], v[44:47], v[144:159]
  ds_read_b64_tr_b16 a[176:177], v216 offset:8192
  ds_read_b64_tr_b16 a[178:179], v216 offset:9216
  s_add_u32 s74, s72, 0xd00
  s_waitcnt lgkmcnt(10)
  v_mfma_f32_16x16x32_bf16 v[160:163], a[172:175], a[40:43], v[160:163]
  v_mfma_f32_16x16x32_bf16 v[164:167], a[172:175], a[44:47], v[164:167]
  v_add_u32 v214, 0x14000, v214
  ds_read_b64_tr_b16 a[160:161], v214
  ds_read_b64_tr_b16 a[162:163], v214 offset:1024
  s_waitcnt lgkmcnt(8)
  v_mfma_f32_32x32x16_bf16 v[128:143], a[144:147], v[48:51], v[128:143]
  v_add_u32 v215, 0x14000, v215
  ds_read_b64_tr_b16 a[164:165], v215
  ds_read_b64_tr_b16 a[166:167], v215 offset:1024
  buffer_load_dwordx4 v252, s[8:11], s74 offen offset:1024 nt lds
  s_add_u32 s12, s60, 0x1800000
  s_addc_u32 s13, s61, 0
  v_mfma_f32_32x32x16_bf16 v[144:159], a[148:151], v[48:51], v[144:159]
  ds_read_b64_tr_b16 a[128:129], v214 offset:2048
  ds_read_b64_tr_b16 a[130:131], v214 offset:3072
  s_add_u32 s75, s72, 0x1900
  s_and_b32 s13, s13, 0xffff
  s_mov_b32 s14, 0x1200000
  s_mov_b32 s15, 0x20000
  s_mov_b32 s4, s54
  s_waitcnt lgkmcnt(8)
  v_mfma_f32_32x32x16_bf16 v[128:143], a[152:155], v[52:55], v[128:143]
  ds_read_b64_tr_b16 a[132:133], v215 offset:2048
  ds_read_b64_tr_b16 a[134:135], v215 offset:3072
  buffer_load_dwordx4 v252, s[8:11], s75 offen offset:2048 nt lds
  s_and_b32 s5, s55, 0xffff
  s_mov_b32 s6, 0x230000
  s_mov_b32 s7, 0x20000
  v_mfma_f32_32x32x16_bf16 v[144:159], a[156:159], v[52:55], v[144:159]
  ds_read_b64_tr_b16 a[180:181], v216 offset:12288
  ds_read_b64_tr_b16 a[182:183], v216 offset:13312
  s_add_u32 s74, s72, 0x2500
  s_lshl_b32 s29, s24, 3
  s_add_u32 s29, s29, s26
  s_lshl_b32 s30, s29, 4
  s_lshl_b32 s31, s25, 2
  s_waitcnt lgkmcnt(10)
  v_mfma_f32_16x16x32_bf16 v[160:163], a[176:179], a[48:51], v[160:163]
  buffer_load_dwordx4 v252, s[8:11], s74 offen offset:3072 nt lds
  s_add_u32 s30, s30, s31
  v_mfma_f32_16x16x32_bf16 v[164:167], a[176:179], a[52:55], v[164:167]
  s_mul_i32 s30, s30, 0x14000
  s_lshl_b32 s31, s3, 11
  s_waitcnt lgkmcnt(6)
  v_mfma_f32_32x32x16_bf16 v[128:143], a[160:163], v[56:59], v[128:143]
  s_waitcnt vmcnt(25)
  s_barrier
  v_add_u32 v208, 0x4000, v208
  v_add_u32 v209, 0x4000, v209
  ds_read_b64_tr_b16 a[136:137], v208
  ds_read_b64_tr_b16 a[138:139], v208 offset:1024
  ds_read_b64_tr_b16 a[140:141], v209
  ds_read_b64_tr_b16 a[142:143], v209 offset:1024
  s_add_u32 s65, s30, s31
  v_mfma_f32_32x32x16_bf16 v[144:159], a[164:167], v[56:59], v[144:159]
  ds_read_b64_tr_b16 a[144:145], v208 offset:2048
  ds_read_b64_tr_b16 a[146:147], v208 offset:3072
  s_add_u32 m0, s33, 0x24000
  s_lshr_b32 s31, s3, 1
  s_add_u32 s31, s31, 8
  s_lshl_b32 s31, s31, 10
  s_waitcnt lgkmcnt(8)
  v_mfma_f32_32x32x16_bf16 v[128:143], a[128:131], v[60:63], v[128:143]
  ds_read_b64_tr_b16 a[148:149], v209 offset:2048
  ds_read_b64_tr_b16 a[150:151], v209 offset:3072
  s_add_u32 s75, s72, 0x10100
  s_add_u32 s66, s30, s31
  s_add_u32 s32, s27, 0
  s_and_b32 s32, s32, 3
  s_mul_i32 s32, s32, 0x14000
  v_mfma_f32_32x32x16_bf16 v[144:159], a[132:135], v[60:63], v[144:159]
  v_add_u32 v216, 0x4000, v216
  ds_read_b64_tr_b16 a[168:169], v216
  ds_read_b64_tr_b16 a[170:171], v216 offset:1024
  buffer_load_dwordx4 v252, s[8:11], s75 offen nt lds
  s_add_u32 s52, s65, s32
  s_add_u32 s68, s66, s32
  s_waitcnt lgkmcnt(10)
  v_mfma_f32_16x16x32_bf16 v[160:163], a[180:183], a[56:59], v[160:163]
  s_add_u32 s74, s72, 0x10d00
  s_add_u32 s32, s27, 1
  v_mfma_f32_16x16x32_bf16 v[164:167], a[180:183], a[60:63], v[164:167]
  v_add_u32 v210, 0x4000, v210
  ds_read_b64_tr_b16 a[152:153], v210
  ds_read_b64_tr_b16 a[154:155], v210 offset:1024
  s_and_b32 s32, s32, 3
  s_waitcnt lgkmcnt(8)
  v_mfma_f32_32x32x16_bf16 v[128:143], a[136:139], v[64:67], v[128:143]
  v_add_u32 v211, 0x4000, v211
  ds_read_b64_tr_b16 a[156:157], v211
  ds_read_b64_tr_b16 a[158:159], v211 offset:1024
  buffer_load_dwordx4 v252, s[8:11], s74 offen offset:1024 nt lds
  s_mul_i32 s32, s32, 0x14000
  s_add_u32 s53, s65, s32
  v_mfma_f32_32x32x16_bf16 v[144:159], a[140:143], v[64:67], v[144:159]
  ds_read_b64_tr_b16 a[160:161], v210 offset:2048
  ds_read_b64_tr_b16 a[162:163], v210 offset:3072
  s_add_u32 s75, s72, 0x11900
  s_add_u32 s69, s66, s32
  s_add_u32 s32, s27, 2
  s_and_b32 s32, s32, 3
  s_waitcnt lgkmcnt(8)
  v_mfma_f32_32x32x16_bf16 v[128:143], a[144:147], v[68:71], v[128:143]
  ds_read_b64_tr_b16 a[164:165], v211 offset:2048
  ds_read_b64_tr_b16 a[166:167], v211 offset:3072
  buffer_load_dwordx4 v252, s[8:11], s75 offen offset:2048 nt lds
  s_mul_i32 s32, s32, 0x14000
  s_add_u32 s54, s65, s32
  s_add_u32 s70, s66, s32
  s_add_u32 s32, s27, 3
  v_mfma_f32_32x32x16_bf16 v[144:159], a[148:151], v[68:71], v[144:159]
  ds_read_b64_tr_b16 a[172:173], v216 offset:4096
  ds_read_b64_tr_b16 a[174:175], v216 offset:5120
  s_add_u32 s74, s72, 0x12500
  s_and_b32 s32, s32, 3
  s_mul_i32 s32, s32, 0x14000
  s_add_u32 s55, s65, s32
  s_add_u32 s71, s66, s32
  s_waitcnt lgkmcnt(10)
  v_mfma_f32_16x16x32_bf16 v[160:163], a[168:171], a[64:67], v[160:163]
  buffer_load_dwordx4 v252, s[8:11], s74 offen offset:3072 nt lds
  s_lshl_b32 s29, s29, 2
  v_mfma_f32_16x16x32_bf16 v[164:167], a[168:171], a[68:71], v[164:167]
  v_add_u32 v212, 0x4000, v212
  ds_read_b64_tr_b16 a[128:129], v212
  ds_read_b64_tr_b16 a[130:131], v212 offset:1024
  s_waitcnt lgkmcnt(8)
  v_mfma_f32_32x32x16_bf16 v[128:143], a[152:155], v[72:75], v[128:143]
  v_add_u32 v213, 0x4000, v213
  ds_read_b64_tr_b16 a[132:133], v213
  ds_read_b64_tr_b16 a[134:135], v213 offset:1024
  s_add_u32 s30, s29, s25
  s_lshl_b32 s30, s30, 9
  s_add_u32 s31, s29, s27
  s_lshl_b32 s32, s31, 2
  v_mfma_f32_32x32x16_bf16 v[144:159], a[156:159], v[72:75], v[144:159]
  ds_read_b64_tr_b16 a[136:137], v212 offset:2048
  ds_read_b64_tr_b16 a[138:139], v212 offset:3072
  s_add_u32 s32, s32, s25
  s_mul_i32 s67, s32, 0x12000
  s_lshl_b32 s31, s29, 2
  s_add_u32 s31, s31, s27
  s_waitcnt lgkmcnt(8)
  v_mfma_f32_32x32x16_bf16 v[128:143], a[160:163], v[76:79], v[128:143]
  ds_read_b64_tr_b16 a[140:141], v213 offset:2048
  ds_read_b64_tr_b16 a[142:143], v213 offset:3072
  s_lshl_b32 s31, s31, 7
  s_add_u32 s31, s31, 64
  v_cmp_eq_u32 vcc, 0, v255
  v_mov_b32 v224, 0x7ffffff0
  v_mov_b32 v225, s30
  v_mfma_f32_32x32x16_bf16 v[144:159], a[164:167], v[76:79], v[144:159]
  ds_read_b64_tr_b16 a[176:177], v216 offset:8192
  ds_read_b64_tr_b16 a[178:179], v216 offset:9216
  v_mov_b32 v226, s31
  v_cndmask_b32 v249, v224, v225, vcc
  v_cndmask_b32 v253, v224, v226, vcc
  s_lshl_b32 s29, s27, 3
  s_lshl_b32 s29, 1, s29
  s_waitcnt lgkmcnt(10)
  v_mfma_f32_16x16x32_bf16 v[160:163], a[172:175], a[72:75], v[160:163]
  v_mov_b32 v250, s29
  s_lshl_b32 s29, s25, 3
  v_mfma_f32_16x16x32_bf16 v[164:167], a[172:175], a[76:79], v[164:167]
  v_add_u32 v214, 0x4000, v214
  ds_read_b64_tr_b16 a[144:145], v214
  ds_read_b64_tr_b16 a[146:147], v214 offset:1024
  s_waitcnt lgkmcnt(8)
  v_mfma_f32_32x32x16_bf16 v[128:143], a[128:131], v[80:83], v[128:143]
  v_add_u32 v215, 0x4000, v215
  ds_read_b64_tr_b16 a[148:149], v215
  ds_read_b64_tr_b16 a[150:151], v215 offset:1024
  s_add_u32 s29, s29, 4
  s_lshl_b32 s29, 1, s29
  v_mov_b32 v254, s29
  s_mul_i32 s43, s3, 0x4800
  v_mfma_f32_32x32x16_bf16 v[144:159], a[132:135], v[80:83], v[144:159]
  ds_read_b64_tr_b16 a[152:153], v214 offset:2048
  ds_read_b64_tr_b16 a[154:155], v214 offset:3072
  s_add_u32 s43, s43, s67
  s_mul_i32 s29, s3, 0x1400
  s_add_u32 s51, s34, s29
  v_min_u32 v247, 39, v255
  s_waitcnt lgkmcnt(8)
  v_mfma_f32_32x32x16_bf16 v[128:143], a[136:139], v[84:87], v[128:143]
  ds_read_b64_tr_b16 a[156:157], v215 offset:2048
  ds_read_b64_tr_b16 a[158:159], v215 offset:3072
  v_lshlrev_b32 v247, 7, v247
  v_lshrrev_b32 v224, 4, v255
  v_and_b32 v225, 15, v255
  v_lshrrev_b32 v226, 2, v225
  v_and_b32 v227, 3, v255
  v_mfma_f32_32x32x16_bf16 v[144:159], a[140:143], v[84:87], v[144:159]
  ds_read_b64_tr_b16 a[180:181], v216 offset:12288
  ds_read_b64_tr_b16 a[182:183], v216 offset:13312
  v_and_b32 v228, 1, v224
  v_lshrrev_b32 v229, 5, v255
  v_lshlrev_b32 v248, 4, v255
  v_lshlrev_b32 v230, 4, v229
  v_lshl_add_u32 v230, v228, 2, v230
  s_waitcnt lgkmcnt(10)
  v_mfma_f32_16x16x32_bf16 v[160:163], a[176:179], a[80:83], v[160:163]
  v_add_u32 v230, v230, v226
  v_lshlrev_b32 v230, 8, v230
  v_mfma_f32_16x16x32_bf16 v[164:167], a[176:179], a[84:87], v[164:167]
  v_and_b32 v231, 1, v227
  v_lshl_add_u32 v230, v231, 3, v230
  v_lshlrev_b32 v231, 3, v228
  s_waitcnt lgkmcnt(6)
  v_mfma_f32_32x32x16_bf16 v[128:143], a[144:147], v[88:91], v[128:143]
  s_waitcnt vmcnt(25)
  s_barrier
  v_add_u32 v208, 0xfffec000, v208
  v_add_u32 v209, 0xfffec000, v209
  ds_read_b64_tr_b16 a[160:161], v208
  ds_read_b64_tr_b16 a[162:163], v208 offset:1024
  ds_read_b64_tr_b16 a[164:165], v209
  ds_read_b64_tr_b16 a[166:167], v209 offset:1024
  v_mfma_f32_32x32x16_bf16 v[144:159], a[148:151], v[88:91], v[144:159]
  ds_read_b64_tr_b16 a[128:129], v208 offset:2048
  ds_read_b64_tr_b16 a[130:131], v208 offset:3072
  s_add_u32 m0, s33, 0x4000
  v_lshl_add_u32 v231, v226, 1, v231
  v_lshrrev_b32 v232, 1, v227
  s_and_b32 s29, s3, 1
  s_waitcnt lgkmcnt(8)
  v_mfma_f32_32x32x16_bf16 v[128:143], a[152:155], v[92:95], v[128:143]
  ds_read_b64_tr_b16 a[132:133], v209 offset:2048
  ds_read_b64_tr_b16 a[134:135], v209 offset:3072
  s_add_u32 s75, s72, 0x20100
  s_lshl_b32 s29, s29, 2
  s_and_b32 s30, s27, 1
  s_add_u32 s31, s29, 0
  v_mfma_f32_32x32x16_bf16 v[144:159], a[156:159], v[92:95], v[144:159]
  v_add_u32 v216, 0xfffec000, v216
  ds_read_b64_tr_b16 a[168:169], v216
  ds_read_b64_tr_b16 a[170:171], v216 offset:1024
  buffer_load_dwordx4 v252, s[8:11], s75 offen nt lds
  s_cmp_ge_u32 s31, 7
  s_cselect_b32 s32, 7, 0
  s_sub_u32 s31, s31, s32
  s_waitcnt lgkmcnt(10)
  v_mfma_f32_16x16x32_bf16 v[160:163], a[180:183], a[88:91], v[160:163]
  s_add_u32 s74, s72, 0x20d00
  s_lshl_b32 s36, s31, 10
  v_mfma_f32_16x16x32_bf16 v[164:167], a[180:183], a[92:95], v[164:167]
  v_add_u32 v210, 0xfffec000, v210
  ds_read_b64_tr_b16 a[136:137], v210
  ds_read_b64_tr_b16 a[138:139], v210 offset:1024
  s_add_u32 s31, s31, s30
  s_waitcnt lgkmcnt(8)
  v_mfma_f32_32x32x16_bf16 v[128:143], a[160:163], v[96:99], v[128:143]
  v_add_u32 v211, 0xfffec000, v211
  ds_read_b64_tr_b16 a[140:141], v211
  ds_read_b64_tr_b16 a[142:143], v211 offset:1024
  buffer_load_dwordx4 v252, s[8:11], s74 offen offset:1024 nt lds
  s_lshl_b32 s31, s31, 1
  v_add_u32 v233, s31, v232
  v_mfma_f32_32x32x16_bf16 v[144:159], a[164:167], v[96:99], v[144:159]
  ds_read_b64_tr_b16 a[144:145], v210 offset:2048
  ds_read_b64_tr_b16 a[146:147], v210 offset:3072
  s_add_u32 s75, s72, 0x21900
  v_xor_b32 v233, v233, v231
  v_lshl_add_u32 v240, v233, 4, v230
  s_add_u32 s31, s29, 1
  s_waitcnt lgkmcnt(8)
  v_mfma_f32_32x32x16_bf16 v[128:143], a[128:131], v[100:103], v[128:143]
  ds_read_b64_tr_b16 a[148:149], v211 offset:2048
  ds_read_b64_tr_b16 a[150:151], v211 offset:3072
  buffer_load_dwordx4 v252, s[8:11], s75 offen offset:2048 nt lds
  s_cmp_ge_u32 s31, 7
  s_cselect_b32 s32, 7, 0
  s_sub_u32 s31, s31, s32
  s_lshl_b32 s37, s31, 10
  v_mfma_f32_32x32x16_bf16 v[144:159], a[132:135], v[100:103], v[144:159]
  ds_read_b64_tr_b16 a[172:173], v216 offset:4096
  ds_read_b64_tr_b16 a[174:175], v216 offset:5120
  s_add_u32 s74, s72, 0x22500
  s_add_u32 s31, s31, s30
  s_lshl_b32 s31, s31, 1
  v_add_u32 v233, s31, v232
  v_xor_b32 v233, v233, v231
  s_waitcnt lgkmcnt(10)
  v_mfma_f32_16x16x32_bf16 v[160:163], a[168:171], a[96:99], v[160:163]
  buffer_load_dwordx4 v252, s[8:11], s74 offen offset:3072 nt lds
  v_lshl_add_u32 v241, v233, 4, v230
  v_mfma_f32_16x16x32_bf16 v[164:167], a[168:171], a[100:103], v[164:167]
  v_add_u32 v212, 0xfffec000, v212
  ds_read_b64_tr_b16 a[152:153], v212
  ds_read_b64_tr_b16 a[154:155], v212 offset:1024
  s_waitcnt lgkmcnt(8)
  v_mfma_f32_32x32x16_bf16 v[128:143], a[136:139], v[104:107], v[128:143]
  v_add_u32 v213, 0xfffec000, v213
  ds_read_b64_tr_b16 a[156:157], v213
  ds_read_b64_tr_b16 a[158:159], v213 offset:1024
  s_add_u32 s31, s29, 2
  s_cmp_ge_u32 s31, 7
  s_cselect_b32 s32, 7, 0
  s_sub_u32 s31, s31, s32
  v_mfma_f32_32x32x16_bf16 v[144:159], a[140:143], v[104:107], v[144:159]
  ds_read_b64_tr_b16 a[160:161], v212 offset:2048
  ds_read_b64_tr_b16 a[162:163], v212 offset:3072
  s_lshl_b32 s38, s31, 10
  s_add_u32 s31, s31, s30
  s_lshl_b32 s31, s31, 1
  v_add_u32 v233, s31, v232
  s_waitcnt lgkmcnt(8)
  v_mfma_f32_32x32x16_bf16 v[128:143], a[144:147], v[108:111], v[128:143]
  ds_read_b64_tr_b16 a[164:165], v213 offset:2048
  ds_read_b64_tr_b16 a[166:167], v213 offset:3072
  v_xor_b32 v233, v233, v231
  v_lshl_add_u32 v242, v233, 4, v230
  s_add_u32 s31, s29, 3
  s_cmp_ge_u32 s31, 7
  s_cselect_b32 s32, 7, 0
  v_mfma_f32_32x32x16_bf16 v[144:159], a[148:151], v[108:111], v[144:159]
  ds_read_b64_tr_b16 a[176:177], v216 offset:8192
  ds_read_b64_tr_b16 a[178:179], v216 offset:9216
  s_sub_u32 s31, s31, s32
  s_lshl_b32 s39, s31, 10
  s_add_u32 s31, s31, s30
  s_lshl_b32 s31, s31, 1
  v_add_u32 v233, s31, v232
  s_waitcnt lgkmcnt(10)
  v_mfma_f32_16x16x32_bf16 v[160:163], a[172:175], a[104:107], v[160:163]
  v_xor_b32 v233, v233, v231
  v_lshl_add_u32 v243, v233, 4, v230
  v_mfma_f32_16x16x32_bf16 v[164:167], a[172:175], a[108:111], v[164:167]
  v_add_u32 v214, 0xfffec000, v214
  ds_read_b64_tr_b16 a[128:129], v214
  ds_read_b64_tr_b16 a[130:131], v214 offset:1024
  s_waitcnt lgkmcnt(8)
  v_mfma_f32_32x32x16_bf16 v[128:143], a[152:155], v[112:115], v[128:143]
  v_add_u32 v215, 0xfffec000, v215
  ds_read_b64_tr_b16 a[132:133], v215
  ds_read_b64_tr_b16 a[134:135], v215 offset:1024
  s_add_u32 s31, s29, 4
  s_cmp_ge_u32 s31, 7
  s_cselect_b32 s32, 7, 0
  s_sub_u32 s31, s31, s32
  v_mfma_f32_32x32x16_bf16 v[144:159], a[156:159], v[112:115], v[144:159]
  ds_read_b64_tr_b16 a[136:137], v214 offset:2048
  ds_read_b64_tr_b16 a[138:139], v214 offset:3072
  s_lshl_b32 s40, s31, 10
  s_add_u32 s31, s31, s30
  s_lshl_b32 s31, s31, 1
  v_add_u32 v233, s31, v232
  v_xor_b32 v233, v233, v231
  s_waitcnt lgkmcnt(8)
  v_mfma_f32_32x32x16_bf16 v[128:143], a[160:163], v[116:119], v[128:143]
  ds_read_b64_tr_b16 a[140:141], v215 offset:2048
  ds_read_b64_tr_b16 a[142:143], v215 offset:3072
  v_lshl_add_u32 v244, v233, 4, v230
  s_add_u32 s31, s29, 5
  s_cmp_ge_u32 s31, 7
  s_cselect_b32 s32, 7, 0
  v_mfma_f32_32x32x16_bf16 v[144:159], a[164:167], v[116:119], v[144:159]
  ds_read_b64_tr_b16 a[180:181], v216 offset:12288
  ds_read_b64_tr_b16 a[182:183], v216 offset:13312
  s_sub_u32 s31, s31, s32
  s_lshl_b32 s41, s31, 10
  s_add_u32 s31, s31, s30
  s_lshl_b32 s31, s31, 1
  v_add_u32 v233, s31, v232
  s_waitcnt lgkmcnt(10)
  v_mfma_f32_16x16x32_bf16 v[160:163], a[176:179], a[112:115], v[160:163]
  v_xor_b32 v233, v233, v231
  v_lshl_add_u32 v245, v233, 4, v230
  v_mfma_f32_16x16x32_bf16 v[164:167], a[176:179], a[116:119], v[164:167]
  s_add_u32 s31, s29, 6
  s_cmp_ge_u32 s31, 7
  s_cselect_b32 s32, 7, 0
  s_waitcnt lgkmcnt(6)
  v_mfma_f32_32x32x16_bf16 v[128:143], a[128:131], v[120:123], v[128:143]
  s_waitcnt vmcnt(25)
  s_barrier
  v_add_u32 v208, 0x4000, v208
  v_add_u32 v209, 0x4000, v209
  ds_read_b64_tr_b16 a[144:145], v208
  ds_read_b64_tr_b16 a[146:147], v208 offset:1024
  ds_read_b64_tr_b16 a[148:149], v209
  ds_read_b64_tr_b16 a[150:151], v209 offset:1024
  v_mfma_f32_32x32x16_bf16 v[144:159], a[132:135], v[120:123], v[144:159]
  ds_read_b64_tr_b16 a[152:153], v208 offset:2048
  ds_read_b64_tr_b16 a[154:155], v208 offset:3072
  s_add_u32 m0, s33, 0x18000
  s_sub_u32 s31, s31, s32
  s_lshl_b32 s42, s31, 10
  s_add_u32 s31, s31, s30
  s_waitcnt lgkmcnt(8)
  v_mfma_f32_32x32x16_bf16 v[128:143], a[136:139], v[124:127], v[128:143]
  ds_read_b64_tr_b16 a[156:157], v209 offset:2048
  ds_read_b64_tr_b16 a[158:159], v209 offset:3072
  s_add_u32 s75, s72, 0x30100
  s_lshl_b32 s31, s31, 1
  v_add_u32 v233, s31, v232
  v_xor_b32 v233, v233, v231
  v_lshl_add_u32 v246, v233, 4, v230
  v_mfma_f32_32x32x16_bf16 v[144:159], a[140:143], v[124:127], v[144:159]
  v_add_u32 v216, 0x4000, v216
  ds_read_b64_tr_b16 a[168:169], v216
  ds_read_b64_tr_b16 a[170:171], v216 offset:1024
  buffer_load_dwordx4 v252, s[8:11], s75 offen nt lds
  s_waitcnt lgkmcnt(10)
  v_mfma_f32_16x16x32_bf16 v[160:163], a[180:183], a[120:123], v[160:163]
  s_add_u32 s74, s72, 0x30d00
  v_mfma_f32_16x16x32_bf16 v[164:167], a[180:183], a[124:127], v[164:167]
  v_add_u32 v210, 0x4000, v210
  ds_read_b64_tr_b16 a[160:161], v210
  ds_read_b64_tr_b16 a[162:163], v210 offset:1024
  s_waitcnt lgkmcnt(8)
  v_mfma_f32_32x32x16_bf16 v[168:183], a[144:147], v[0:3], 0
  v_add_u32 v211, 0x4000, v211
  ds_read_b64_tr_b16 a[164:165], v211
  ds_read_b64_tr_b16 a[166:167], v211 offset:1024
  buffer_load_dwordx4 v252, s[8:11], s74 offen offset:1024 nt lds
  v_mfma_f32_32x32x16_bf16 v[184:199], a[148:151], v[0:3], 0
  ds_read_b64_tr_b16 a[128:129], v210 offset:2048
  ds_read_b64_tr_b16 a[130:131], v210 offset:3072
  s_add_u32 s75, s72, 0x31900
  s_waitcnt lgkmcnt(8)
  v_mfma_f32_32x32x16_bf16 v[168:183], a[152:155], v[4:7], v[168:183]
  ds_read_b64_tr_b16 a[132:133], v211 offset:2048
  ds_read_b64_tr_b16 a[134:135], v211 offset:3072
  buffer_load_dwordx4 v252, s[8:11], s75 offen offset:2048 nt lds
  v_mul_f32 v128, v128, v219
  v_mul_f32 v129, v129, v219
  v_mul_f32 v130, v130, v219
  v_mul_f32 v131, v131, v219
  v_mfma_f32_32x32x16_bf16 v[184:199], a[156:159], v[4:7], v[184:199]
  ds_read_b64_tr_b16 a[172:173], v216 offset:4096
  ds_read_b64_tr_b16 a[174:175], v216 offset:5120
  s_add_u32 s74, s72, 0x32500
  v_mul_f32 v132, v132, v219
  v_mul_f32 v133, v133, v219
  v_mul_f32 v134, v134, v219
  v_mul_f32 v135, v135, v219
  s_waitcnt lgkmcnt(10)
  v_mfma_f32_16x16x32_bf16 v[200:203], a[168:171], a[0:3], 0
  buffer_load_dwordx4 v252, s[8:11], s74 offen offset:3072 nt lds
  v_cvt_pk_bf16_f32 v224, v128, v129
  v_cvt_pk_bf16_f32 v225, v130, v131
  v_mfma_f32_16x16x32_bf16 v[204:207], a[168:171], a[4:7], 0
  v_add_u32 v212, 0x4000, v212
  ds_read_b64_tr_b16 a[136:137], v212
  ds_read_b64_tr_b16 a[138:139], v212 offset:1024
  s_waitcnt lgkmcnt(8)
  v_mfma_f32_32x32x16_bf16 v[168:183], a[160:163], v[8:11], v[168:183]
  v_add_u32 v213, 0x4000, v213
  ds_read_b64_tr_b16 a[140:141], v213
  ds_read_b64_tr_b16 a[142:143], v213 offset:1024
  v_cvt_pk_bf16_f32 v226, v132, v133
  v_cvt_pk_bf16_f32 v227, v134, v135
  s_add_u32 s77, s78, 0
  buffer_store_dwordx4 v[224:227], v217, s[20:23], s77 offen sc1
  v_mfma_f32_32x32x16_bf16 v[184:199], a[164:167], v[8:11], v[184:199]
  ds_read_b64_tr_b16 a[144:145], v212 offset:2048
  ds_read_b64_tr_b16 a[146:147], v212 offset:3072
  v_mul_f32 v136, v136, v219
  v_mul_f32 v137, v137, v219
  v_mul_f32 v138, v138, v219
  v_mul_f32 v139, v139, v219
  v_mul_f32 v140, v140, v219
  v_mul_f32 v141, v141, v219
  s_waitcnt lgkmcnt(8)
  v_mfma_f32_32x32x16_bf16 v[168:183], a[128:131], v[12:15], v[168:183]
  ds_read_b64_tr_b16 a[148:149], v213 offset:2048
  ds_read_b64_tr_b16 a[150:151], v213 offset:3072
  v_mul_f32 v142, v142, v219
  v_mul_f32 v143, v143, v219
  v_cvt_pk_bf16_f32 v228, v136, v137
  v_cvt_pk_bf16_f32 v229, v138, v139
  v_cvt_pk_bf16_f32 v230, v140, v141
  v_mfma_f32_32x32x16_bf16 v[184:199], a[132:135], v[12:15], v[184:199]
  ds_read_b64_tr_b16 a[176:177], v216 offset:8192
  ds_read_b64_tr_b16 a[178:179], v216 offset:9216
  v_cvt_pk_bf16_f32 v231, v142, v143
  s_add_u32 s76, s78, 0
  buffer_store_dwordx4 v[228:231], v217, s[20:23], s76 offen offset:512 sc1
  v_mul_f32 v144, v144, v219
  v_mul_f32 v145, v145, v219
  v_mul_f32 v146, v146, v219
  s_waitcnt lgkmcnt(10)
  v_mfma_f32_16x16x32_bf16 v[200:203], a[172:175], a[8:11], v[200:203]
  v_mul_f32 v147, v147, v219
  v_mul_f32 v148, v148, v219
  v_mul_f32 v149, v149, v219
  v_mfma_f32_16x16x32_bf16 v[204:207], a[172:175], a[12:15], v[204:207]
  v_add_u32 v214, 0x4000, v214
  ds_read_b64_tr_b16 a[152:153], v214
  ds_read_b64_tr_b16 a[154:155], v214 offset:1024
  s_waitcnt lgkmcnt(8)
  v_mfma_f32_32x32x16_bf16 v[168:183], a[136:139], v[16:19], v[168:183]
  v_add_u32 v215, 0x4000, v215
  ds_read_b64_tr_b16 a[156:157], v215
  ds_read_b64_tr_b16 a[158:159], v215 offset:1024
  v_mul_f32 v150, v150, v219
  v_mul_f32 v151, v151, v219
  v_cvt_pk_bf16_f32 v232, v144, v145
  v_cvt_pk_bf16_f32 v233, v146, v147
  v_mfma_f32_32x32x16_bf16 v[184:199], a[140:143], v[16:19], v[184:199]
  ds_read_b64_tr_b16 a[160:161], v214 offset:2048
  ds_read_b64_tr_b16 a[162:163], v214 offset:3072
  v_cvt_pk_bf16_f32 v234, v148, v149
  v_cvt_pk_bf16_f32 v235, v150, v151
  s_add_u32 s77, s78, 0x2800
  buffer_store_dwordx4 v[232:235], v217, s[20:23], s77 offen sc1
  v_mul_f32 v152, v152, v219
  v_mul_f32 v153, v153, v219
  s_waitcnt lgkmcnt(8)
  v_mfma_f32_32x32x16_bf16 v[168:183], a[144:147], v[20:23], v[168:183]
  ds_read_b64_tr_b16 a[164:165], v215 offset:2048
  ds_read_b64_tr_b16 a[166:167], v215 offset:3072
  v_mul_f32 v154, v154, v219
  v_mul_f32 v155, v155, v219
  v_mul_f32 v156, v156, v219
  v_mul_f32 v157, v157, v219
  v_mul_f32 v158, v158, v219
  v_mfma_f32_32x32x16_bf16 v[184:199], a[148:151], v[20:23], v[184:199]
  ds_read_b64_tr_b16 a[180:181], v216 offset:12288
  ds_read_b64_tr_b16 a[182:183], v216 offset:13312
  v_mul_f32 v159, v159, v219
  v_cvt_pk_bf16_f32 v224, v152, v153
  v_cvt_pk_bf16_f32 v225, v154, v155
  v_cvt_pk_bf16_f32 v226, v156, v157
  v_cvt_pk_bf16_f32 v227, v158, v159
  s_add_u32 s76, s78, 0x2800
  s_waitcnt lgkmcnt(10)
  v_mfma_f32_16x16x32_bf16 v[200:203], a[176:179], a[16:19], v[200:203]
  buffer_store_dwordx4 v[224:227], v217, s[20:23], s76 offen offset:512 sc1
  v_mul_f32 v160, v160, v220
  v_mul_f32 v161, v161, v220
  v_mfma_f32_16x16x32_bf16 v[204:207], a[176:179], a[20:23], v[204:207]
  v_mul_f32 v162, v162, v220
  v_mul_f32 v163, v163, v220
  v_cvt_pk_bf16_f32 v236, v160, v161
  s_waitcnt lgkmcnt(6)
  v_mfma_f32_32x32x16_bf16 v[168:183], a[152:155], v[24:27], v[168:183]
  s_waitcnt vmcnt(29)
  s_barrier
  v_add_u32 v208, 0x4000, v208
  v_add_u32 v209, 0x4000, v209
  ds_read_b64_tr_b16 a[128:129], v208
  ds_read_b64_tr_b16 a[130:131], v208 offset:1024
  ds_read_b64_tr_b16 a[132:133], v209
  ds_read_b64_tr_b16 a[134:135], v209 offset:1024
  v_mfma_f32_32x32x16_bf16 v[184:199], a[156:159], v[24:27], v[184:199]
  ds_read_b64_tr_b16 a[136:137], v208 offset:2048
  ds_read_b64_tr_b16 a[138:139], v208 offset:3072
  s_add_u32 m0, s33, 0x1c000
  v_cvt_pk_bf16_f32 v237, v162, v163
  s_add_u32 s77, s79, 0
  buffer_store_dwordx2 v[236:237], v218, s[20:23], s77 offen sc1
  v_mul_f32 v164, v164, v221
  s_waitcnt lgkmcnt(8)
  v_mfma_f32_32x32x16_bf16 v[168:183], a[160:163], v[28:31], v[168:183]
  ds_read_b64_tr_b16 a[140:141], v209 offset:2048
  ds_read_b64_tr_b16 a[142:143], v209 offset:3072
  s_add_u32 s75, s72, 0x180
  v_mul_f32 v165, v165, v221
  v_mul_f32 v166, v166, v221
  v_mul_f32 v167, v167, v221
  v_cvt_pk_bf16_f32 v238, v164, v165
  v_mfma_f32_32x32x16_bf16 v[184:199], a[164:167], v[28:31], v[184:199]
  v_add_u32 v216, 0x4000, v216
  ds_read_b64_tr_b16 a[168:169], v216
  ds_read_b64_tr_b16 a[170:171], v216 offset:1024
  buffer_load_dwordx4 v252, s[8:11], s75 offen nt lds
  v_cvt_pk_bf16_f32 v239, v166, v167
  s_add_u32 s76, s79, 0x400
  buffer_store_dwordx2 v[238:239], v218, s[20:23], s76 offen sc1
  s_waitcnt lgkmcnt(10)
  v_mfma_f32_16x16x32_bf16 v[200:203], a[180:183], a[24:27], v[200:203]
  s_add_u32 s74, s72, 0xd80
  v_mfma_f32_16x16x32_bf16 v[204:207], a[180:183], a[28:31], v[204:207]
  v_add_u32 v210, 0x4000, v210
  ds_read_b64_tr_b16 a[144:145], v210
  ds_read_b64_tr_b16 a[146:147], v210 offset:1024
  s_waitcnt lgkmcnt(8)
  v_mfma_f32_32x32x16_bf16 v[168:183], a[128:131], v[32:35], v[168:183]
  v_add_u32 v211, 0x4000, v211
  ds_read_b64_tr_b16 a[148:149], v211
  ds_read_b64_tr_b16 a[150:151], v211 offset:1024
  buffer_load_dwordx4 v252, s[8:11], s74 offen offset:1024 nt lds
  v_mfma_f32_32x32x16_bf16 v[184:199], a[132:135], v[32:35], v[184:199]
  ds_read_b64_tr_b16 a[152:153], v210 offset:2048
  ds_read_b64_tr_b16 a[154:155], v210 offset:3072
  s_add_u32 s75, s72, 0x1980
  s_waitcnt lgkmcnt(8)
  v_mfma_f32_32x32x16_bf16 v[168:183], a[136:139], v[36:39], v[168:183]
  ds_read_b64_tr_b16 a[156:157], v211 offset:2048
  ds_read_b64_tr_b16 a[158:159], v211 offset:3072
  buffer_load_dwordx4 v252, s[8:11], s75 offen offset:2048 nt lds
  v_mfma_f32_32x32x16_bf16 v[184:199], a[140:143], v[36:39], v[184:199]
  ds_read_b64_tr_b16 a[172:173], v216 offset:4096
  ds_read_b64_tr_b16 a[174:175], v216 offset:5120
  s_add_u32 s74, s72, 0x2580
  s_waitcnt lgkmcnt(10)
  v_mfma_f32_16x16x32_bf16 v[200:203], a[168:171], a[32:35], v[200:203]
  buffer_load_dwordx4 v252, s[8:11], s74 offen offset:3072 nt lds
  v_mfma_f32_16x16x32_bf16 v[204:207], a[168:171], a[36:39], v[204:207]
  v_add_u32 v212, 0x4000, v212
  ds_read_b64_tr_b16 a[160:161], v212
  ds_read_b64_tr_b16 a[162:163], v212 offset:1024
  s_waitcnt lgkmcnt(8)
  v_mfma_f32_32x32x16_bf16 v[168:183], a[144:147], v[40:43], v[168:183]
  v_add_u32 v213, 0x4000, v213
  ds_read_b64_tr_b16 a[164:165], v213
  ds_read_b64_tr_b16 a[166:167], v213 offset:1024
  v_mfma_f32_32x32x16_bf16 v[184:199], a[148:151], v[40:43], v[184:199]
  ds_read_b64_tr_b16 a[128:129], v212 offset:2048
  ds_read_b64_tr_b16 a[130:131], v212 offset:3072
  s_waitcnt lgkmcnt(8)
  v_mfma_f32_32x32x16_bf16 v[168:183], a[152:155], v[44:47], v[168:183]
  ds_read_b64_tr_b16 a[132:133], v213 offset:2048
  ds_read_b64_tr_b16 a[134:135], v213 offset:3072
  v_mfma_f32_32x32x16_bf16 v[184:199], a[156:159], v[44:47], v[184:199]
  ds_read_b64_tr_b16 a[176:177], v216 offset:8192
  ds_read_b64_tr_b16 a[178:179], v216 offset:9216
  s_waitcnt lgkmcnt(10)
  v_mfma_f32_16x16x32_bf16 v[200:203], a[172:175], a[40:43], v[200:203]
  v_mfma_f32_16x16x32_bf16 v[204:207], a[172:175], a[44:47], v[204:207]
  v_add_u32 v214, 0x4000, v214
  ds_read_b64_tr_b16 a[136:137], v214
  ds_read_b64_tr_b16 a[138:139], v214 offset:1024
  s_waitcnt lgkmcnt(8)
  v_mfma_f32_32x32x16_bf16 v[168:183], a[160:163], v[48:51], v[168:183]
  v_add_u32 v215, 0x4000, v215
  ds_read_b64_tr_b16 a[140:141], v215
  ds_read_b64_tr_b16 a[142:143], v215 offset:1024
  v_mfma_f32_32x32x16_bf16 v[184:199], a[164:167], v[48:51], v[184:199]
  ds_read_b64_tr_b16 a[144:145], v214 offset:2048
  ds_read_b64_tr_b16 a[146:147], v214 offset:3072
  s_waitcnt lgkmcnt(8)
  v_mfma_f32_32x32x16_bf16 v[168:183], a[128:131], v[52:55], v[168:183]
  ds_read_b64_tr_b16 a[148:149], v215 offset:2048
  ds_read_b64_tr_b16 a[150:151], v215 offset:3072
  v_mfma_f32_32x32x16_bf16 v[184:199], a[132:135], v[52:55], v[184:199]
  ds_read_b64_tr_b16 a[180:181], v216 offset:12288
  ds_read_b64_tr_b16 a[182:183], v216 offset:13312
  s_waitcnt lgkmcnt(10)
  v_mfma_f32_16x16x32_bf16 v[200:203], a[176:179], a[48:51], v[200:203]
  v_mfma_f32_16x16x32_bf16 v[204:207], a[176:179], a[52:55], v[204:207]
  s_waitcnt lgkmcnt(6)
  v_mfma_f32_32x32x16_bf16 v[168:183], a[136:139], v[56:59], v[168:183]
  s_waitcnt vmcnt(31)
  s_barrier
  v_add_u32 v208, 0xffff0000, v208
  v_add_u32 v209, 0xffff0000, v209
  ds_read_b64_tr_b16 a[152:153], v208
  ds_read_b64_tr_b16 a[154:155], v208 offset:1024
  ds_read_b64_tr_b16 a[156:157], v209
  ds_read_b64_tr_b16 a[158:159], v209 offset:1024
  v_mfma_f32_32x32x16_bf16 v[184:199], a[140:143], v[56:59], v[184:199]
  ds_read_b64_tr_b16 a[160:161], v208 offset:2048
  ds_read_b64_tr_b16 a[162:163], v208 offset:3072
  s_add_u32 m0, s33, 0x8000
  s_waitcnt lgkmcnt(8)
  v_mfma_f32_32x32x16_bf16 v[168:183], a[144:147], v[60:63], v[168:183]
  ds_read_b64_tr_b16 a[164:165], v209 offset:2048
  ds_read_b64_tr_b16 a[166:167], v209 offset:3072
  s_add_u32 s75, s72, 0x10180
  v_mfma_f32_32x32x16_bf16 v[184:199], a[148:151], v[60:63], v[184:199]
  v_add_u32 v216, 0xffff0000, v216
  ds_read_b64_tr_b16 a[168:169], v216
  ds_read_b64_tr_b16 a[170:171], v216 offset:1024
  buffer_load_dwordx4 v252, s[8:11], s75 offen nt lds
  s_waitcnt lgkmcnt(10)
  v_mfma_f32_16x16x32_bf16 v[200:203], a[180:183], a[56:59], v[200:203]
  s_add_u32 s74, s72, 0x10d80
  v_mfma_f32_16x16x32_bf16 v[204:207], a[180:183], a[60:63], v[204:207]
  v_add_u32 v210, 0xffff0000, v210
  ds_read_b64_tr_b16 a[128:129], v210
  ds_read_b64_tr_b16 a[130:131], v210 offset:1024
  s_waitcnt lgkmcnt(8)
  v_mfma_f32_32x32x16_bf16 v[168:183], a[152:155], v[64:67], v[168:183]
  v_add_u32 v211, 0xffff0000, v211
  ds_read_b64_tr_b16 a[132:133], v211
  ds_read_b64_tr_b16 a[134:135], v211 offset:1024
  buffer_load_dwordx4 v252, s[8:11], s74 offen offset:1024 nt lds
  v_mfma_f32_32x32x16_bf16 v[184:199], a[156:159], v[64:67], v[184:199]
  ds_read_b64_tr_b16 a[136:137], v210 offset:2048
  ds_read_b64_tr_b16 a[138:139], v210 offset:3072
  s_add_u32 s75, s72, 0x11980
  s_waitcnt lgkmcnt(8)
  v_mfma_f32_32x32x16_bf16 v[168:183], a[160:163], v[68:71], v[168:183]
  ds_read_b64_tr_b16 a[140:141], v211 offset:2048
  ds_read_b64_tr_b16 a[142:143], v211 offset:3072
  buffer_load_dwordx4 v252, s[8:11], s75 offen offset:2048 nt lds
  v_mfma_f32_32x32x16_bf16 v[184:199], a[164:167], v[68:71], v[184:199]
  ds_read_b64_tr_b16 a[172:173], v216 offset:4096
  ds_read_b64_tr_b16 a[174:175], v216 offset:5120
  s_add_u32 s74, s72, 0x12580
  s_waitcnt lgkmcnt(10)
  v_mfma_f32_16x16x32_bf16 v[200:203], a[168:171], a[64:67], v[200:203]
  buffer_load_dwordx4 v252, s[8:11], s74 offen offset:3072 nt lds
  v_mfma_f32_16x16x32_bf16 v[204:207], a[168:171], a[68:71], v[204:207]
  v_add_u32 v212, 0xffff0000, v212
  ds_read_b64_tr_b16 a[144:145], v212
  ds_read_b64_tr_b16 a[146:147], v212 offset:1024
  s_waitcnt lgkmcnt(8)
  v_mfma_f32_32x32x16_bf16 v[168:183], a[128:131], v[72:75], v[168:183]
  v_add_u32 v213, 0xffff0000, v213
  ds_read_b64_tr_b16 a[148:149], v213
  ds_read_b64_tr_b16 a[150:151], v213 offset:1024
  v_mfma_f32_32x32x16_bf16 v[184:199], a[132:135], v[72:75], v[184:199]
  ds_read_b64_tr_b16 a[152:153], v212 offset:2048
  ds_read_b64_tr_b16 a[154:155], v212 offset:3072
  s_waitcnt lgkmcnt(8)
  v_mfma_f32_32x32x16_bf16 v[168:183], a[136:139], v[76:79], v[168:183]
  ds_read_b64_tr_b16 a[156:157], v213 offset:2048
  ds_read_b64_tr_b16 a[158:159], v213 offset:3072
  v_mfma_f32_32x32x16_bf16 v[184:199], a[140:143], v[76:79], v[184:199]
  ds_read_b64_tr_b16 a[176:177], v216 offset:8192
  ds_read_b64_tr_b16 a[178:179], v216 offset:9216
  s_waitcnt lgkmcnt(10)
  v_mfma_f32_16x16x32_bf16 v[200:203], a[172:175], a[72:75], v[200:203]
  v_mfma_f32_16x16x32_bf16 v[204:207], a[172:175], a[76:79], v[204:207]
  v_add_u32 v214, 0xffff0000, v214
  ds_read_b64_tr_b16 a[160:161], v214
  ds_read_b64_tr_b16 a[162:163], v214 offset:1024
  s_waitcnt lgkmcnt(8)
  v_mfma_f32_32x32x16_bf16 v[168:183], a[144:147], v[80:83], v[168:183]
  v_add_u32 v215, 0xffff0000, v215
  ds_read_b64_tr_b16 a[164:165], v215
  ds_read_b64_tr_b16 a[166:167], v215 offset:1024
  v_mfma_f32_32x32x16_bf16 v[184:199], a[148:151], v[80:83], v[184:199]
  ds_read_b64_tr_b16 a[128:129], v214 offset:2048
  ds_read_b64_tr_b16 a[130:131], v214 offset:3072
  s_waitcnt lgkmcnt(8)
  v_mfma_f32_32x32x16_bf16 v[168:183], a[152:155], v[84:87], v[168:183]
  ds_read_b64_tr_b16 a[132:133], v215 offset:2048
  ds_read_b64_tr_b16 a[134:135], v215 offset:3072
  v_mfma_f32_32x32x16_bf16 v[184:199], a[156:159], v[84:87], v[184:199]
  ds_read_b64_tr_b16 a[180:181], v216 offset:12288
  ds_read_b64_tr_b16 a[182:183], v216 offset:13312
  s_waitcnt lgkmcnt(10)
  v_mfma_f32_16x16x32_bf16 v[200:203], a[176:179], a[80:83], v[200:203]
  v_mfma_f32_16x16x32_bf16 v[204:207], a[176:179], a[84:87], v[204:207]
  s_waitcnt lgkmcnt(6)
  v_mfma_f32_32x32x16_bf16 v[168:183], a[160:163], v[88:91], v[168:183]
  s_waitcnt vmcnt(30)
  s_barrier
  v_add_u32 v208, 0x14000, v208
  v_add_u32 v209, 0x14000, v209
  ds_read_b64_tr_b16 a[136:137], v208
  ds_read_b64_tr_b16 a[138:139], v208 offset:1024
  ds_read_b64_tr_b16 a[140:141], v209
  ds_read_b64_tr_b16 a[142:143], v209 offset:1024
  v_mfma_f32_32x32x16_bf16 v[184:199], a[164:167], v[88:91], v[184:199]
  ds_read_b64_tr_b16 a[144:145], v208 offset:2048
  ds_read_b64_tr_b16 a[146:147], v208 offset:3072
  s_add_u32 m0, s33, 0xc000
  s_waitcnt lgkmcnt(8)
  v_mfma_f32_32x32x16_bf16 v[168:183], a[128:131], v[92:95], v[168:183]
  ds_read_b64_tr_b16 a[148:149], v209 offset:2048
  ds_read_b64_tr_b16 a[150:151], v209 offset:3072
  s_add_u32 s75, s72, 0x20180
  v_mfma_f32_32x32x16_bf16 v[184:199], a[132:135], v[92:95], v[184:199]
  v_add_u32 v216, 0x14000, v216
  ds_read_b64_tr_b16 a[168:169], v216
  ds_read_b64_tr_b16 a[170:171], v216 offset:1024
  buffer_load_dwordx4 v252, s[8:11], s75 offen nt lds
  s_waitcnt lgkmcnt(10)
  v_mfma_f32_16x16x32_bf16 v[200:203], a[180:183], a[88:91], v[200:203]
  s_add_u32 s74, s72, 0x20d80
  v_mfma_f32_16x16x32_bf16 v[204:207], a[180:183], a[92:95], v[204:207]
  v_add_u32 v210, 0x14000, v210
  ds_read_b64_tr_b16 a[152:153], v210
  ds_read_b64_tr_b16 a[154:155], v210 offset:1024
  s_waitcnt lgkmcnt(8)
  v_mfma_f32_32x32x16_bf16 v[168:183], a[136:139], v[96:99], v[168:183]
  v_add_u32 v211, 0x14000, v211
  ds_read_b64_tr_b16 a[156:157], v211
  ds_read_b64_tr_b16 a[158:159], v211 offset:1024
  buffer_load_dwordx4 v252, s[8:11], s74 offen offset:1024 nt lds
  v_mfma_f32_32x32x16_bf16 v[184:199], a[140:143], v[96:99], v[184:199]
  ds_read_b64_tr_b16 a[160:161], v210 offset:2048
  ds_read_b64_tr_b16 a[162:163], v210 offset:3072
  s_add_u32 s75, s72, 0x21980
  s_waitcnt lgkmcnt(8)
  v_mfma_f32_32x32x16_bf16 v[168:183], a[144:147], v[100:103], v[168:183]
  ds_read_b64_tr_b16 a[164:165], v211 offset:2048
  ds_read_b64_tr_b16 a[166:167], v211 offset:3072
  buffer_load_dwordx4 v252, s[8:11], s75 offen offset:2048 nt lds
  v_mfma_f32_32x32x16_bf16 v[184:199], a[148:151], v[100:103], v[184:199]
  ds_read_b64_tr_b16 a[172:173], v216 offset:4096
  ds_read_b64_tr_b16 a[174:175], v216 offset:5120
  s_add_u32 s74, s72, 0x22580
  s_waitcnt lgkmcnt(10)
  v_mfma_f32_16x16x32_bf16 v[200:203], a[168:171], a[96:99], v[200:203]
  buffer_load_dwordx4 v252, s[8:11], s74 offen offset:3072 nt lds
  v_mfma_f32_16x16x32_bf16 v[204:207], a[168:171], a[100:103], v[204:207]
  v_add_u32 v212, 0x14000, v212
  ds_read_b64_tr_b16 a[128:129], v212
  ds_read_b64_tr_b16 a[130:131], v212 offset:1024
  s_waitcnt lgkmcnt(8)
  v_mfma_f32_32x32x16_bf16 v[168:183], a[152:155], v[104:107], v[168:183]
  v_add_u32 v213, 0x14000, v213
  ds_read_b64_tr_b16 a[132:133], v213
  ds_read_b64_tr_b16 a[134:135], v213 offset:1024
  v_mfma_f32_32x32x16_bf16 v[184:199], a[156:159], v[104:107], v[184:199]
  ds_read_b64_tr_b16 a[136:137], v212 offset:2048
  ds_read_b64_tr_b16 a[138:139], v212 offset:3072
  s_waitcnt lgkmcnt(8)
  v_mfma_f32_32x32x16_bf16 v[168:183], a[160:163], v[108:111], v[168:183]
  ds_read_b64_tr_b16 a[140:141], v213 offset:2048
  ds_read_b64_tr_b16 a[142:143], v213 offset:3072
  v_mfma_f32_32x32x16_bf16 v[184:199], a[164:167], v[108:111], v[184:199]
  ds_read_b64_tr_b16 a[176:177], v216 offset:8192
  ds_read_b64_tr_b16 a[178:179], v216 offset:9216
  s_waitcnt lgkmcnt(10)
  v_mfma_f32_16x16x32_bf16 v[200:203], a[172:175], a[104:107], v[200:203]
  v_mfma_f32_16x16x32_bf16 v[204:207], a[172:175], a[108:111], v[204:207]
  v_add_u32 v214, 0x14000, v214
  ds_read_b64_tr_b16 a[144:145], v214
  ds_read_b64_tr_b16 a[146:147], v214 offset:1024
  s_waitcnt lgkmcnt(8)
  v_mfma_f32_32x32x16_bf16 v[168:183], a[128:131], v[112:115], v[168:183]
  v_add_u32 v215, 0x14000, v215
  ds_read_b64_tr_b16 a[148:149], v215
  ds_read_b64_tr_b16 a[150:151], v215 offset:1024
  v_mfma_f32_32x32x16_bf16 v[184:199], a[132:135], v[112:115], v[184:199]
  ds_read_b64_tr_b16 a[152:153], v214 offset:2048
  ds_read_b64_tr_b16 a[154:155], v214 offset:3072
  s_waitcnt lgkmcnt(8)
  v_mfma_f32_32x32x16_bf16 v[168:183], a[136:139], v[116:119], v[168:183]
  ds_read_b64_tr_b16 a[156:157], v215 offset:2048
  ds_read_b64_tr_b16 a[158:159], v215 offset:3072
  v_mfma_f32_32x32x16_bf16 v[184:199], a[140:143], v[116:119], v[184:199]
  ds_read_b64_tr_b16 a[180:181], v216 offset:12288
  ds_read_b64_tr_b16 a[182:183], v216 offset:13312
  s_waitcnt lgkmcnt(10)
  v_mfma_f32_16x16x32_bf16 v[200:203], a[176:179], a[112:115], v[200:203]
  v_mfma_f32_16x16x32_bf16 v[204:207], a[176:179], a[116:119], v[204:207]
  s_waitcnt lgkmcnt(6)
  v_mfma_f32_32x32x16_bf16 v[168:183], a[144:147], v[120:123], v[168:183]
  s_waitcnt vmcnt(30)
  s_barrier
  v_add_u32 v208, 0xc000, v208
  v_add_u32 v209, 0xc000, v209
  ds_read_b64_tr_b16 a[160:161], v208
  ds_read_b64_tr_b16 a[162:163], v208 offset:1024
  ds_read_b64_tr_b16 a[164:165], v209
  ds_read_b64_tr_b16 a[166:167], v209 offset:1024
  v_mfma_f32_32x32x16_bf16 v[184:199], a[148:151], v[120:123], v[184:199]
  ds_read_b64_tr_b16 a[128:129], v208 offset:2048
  ds_read_b64_tr_b16 a[130:131], v208 offset:3072
  s_add_u32 m0, s33, 0x10000
  s_waitcnt lgkmcnt(8)
  v_mfma_f32_32x32x16_bf16 v[168:183], a[152:155], v[124:127], v[168:183]
  ds_read_b64_tr_b16 a[132:133], v209 offset:2048
  ds_read_b64_tr_b16 a[134:135], v209 offset:3072
  s_add_u32 s75, s72, 0x30180
  v_mfma_f32_32x32x16_bf16 v[184:199], a[156:159], v[124:127], v[184:199]
  v_add_u32 v216, 0xc000, v216
  ds_read_b64_tr_b16 a[168:169], v216
  ds_read_b64_tr_b16 a[170:171], v216 offset:1024
  buffer_load_dwordx4 v252, s[8:11], s75 offen nt lds
  s_waitcnt lgkmcnt(10)
  v_mfma_f32_16x16x32_bf16 v[200:203], a[180:183], a[120:123], v[200:203]
  s_add_u32 s74, s72, 0x30d80
  v_mfma_f32_16x16x32_bf16 v[204:207], a[180:183], a[124:127], v[204:207]
  v_add_u32 v210, 0xc000, v210
  ds_read_b64_tr_b16 a[136:137], v210
  ds_read_b64_tr_b16 a[138:139], v210 offset:1024
  s_waitcnt lgkmcnt(8)
  v_mfma_f32_32x32x16_bf16 v[128:143], a[160:163], v[0:3], 0
  v_add_u32 v211, 0xc000, v211
  ds_read_b64_tr_b16 a[140:141], v211
  ds_read_b64_tr_b16 a[142:143], v211 offset:1024
  buffer_load_dwordx4 v252, s[8:11], s74 offen offset:1024 nt lds
  v_mfma_f32_32x32x16_bf16 v[144:159], a[164:167], v[0:3], 0
  ds_read_b64_tr_b16 a[144:145], v210 offset:2048
  ds_read_b64_tr_b16 a[146:147], v210 offset:3072
  s_add_u32 s75, s72, 0x31980
  s_waitcnt lgkmcnt(8)
  v_mfma_f32_32x32x16_bf16 v[128:143], a[128:131], v[4:7], v[128:143]
  ds_read_b64_tr_b16 a[148:149], v211 offset:2048
  ds_read_b64_tr_b16 a[150:151], v211 offset:3072
  buffer_load_dwordx4 v252, s[8:11], s75 offen offset:2048 nt lds
  v_mul_f32 v168, v168, v219
  v_mul_f32 v169, v169, v219
  v_mul_f32 v170, v170, v219
  v_mul_f32 v171, v171, v219
  v_mfma_f32_32x32x16_bf16 v[144:159], a[132:135], v[4:7], v[144:159]
  ds_read_b64_tr_b16 a[172:173], v216 offset:4096
  ds_read_b64_tr_b16 a[174:175], v216 offset:5120
  s_add_u32 s74, s72, 0x32580
  v_mul_f32 v172, v172, v219
  v_mul_f32 v173, v173, v219
  v_mul_f32 v174, v174, v219
  v_mul_f32 v175, v175, v219
  s_waitcnt lgkmcnt(10)
  v_mfma_f32_16x16x32_bf16 v[160:163], a[168:171], a[0:3], 0
  buffer_load_dwordx4 v252, s[8:11], s74 offen offset:3072 nt lds
  v_cvt_pk_bf16_f32 v224, v168, v169
  v_cvt_pk_bf16_f32 v225, v170, v171
  v_mfma_f32_16x16x32_bf16 v[164:167], a[168:171], a[4:7], 0
  v_add_u32 v212, 0xc000, v212
  ds_read_b64_tr_b16 a[152:153], v212
  ds_read_b64_tr_b16 a[154:155], v212 offset:1024
  s_waitcnt lgkmcnt(8)
  v_mfma_f32_32x32x16_bf16 v[128:143], a[136:139], v[8:11], v[128:143]
  v_add_u32 v213, 0xc000, v213
  ds_read_b64_tr_b16 a[156:157], v213
  ds_read_b64_tr_b16 a[158:159], v213 offset:1024
  v_cvt_pk_bf16_f32 v226, v172, v173
  v_cvt_pk_bf16_f32 v227, v174, v175
  s_add_u32 s77, s78, 0x5000
  buffer_store_dwordx4 v[224:227], v217, s[20:23], s77 offen sc1
  v_mfma_f32_32x32x16_bf16 v[144:159], a[140:143], v[8:11], v[144:159]
  ds_read_b64_tr_b16 a[160:161], v212 offset:2048
  ds_read_b64_tr_b16 a[162:163], v212 offset:3072
  v_mul_f32 v176, v176, v219
  v_mul_f32 v177, v177, v219
  v_mul_f32 v178, v178, v219
  v_mul_f32 v179, v179, v219
  v_mul_f32 v180, v180, v219
  v_mul_f32 v181, v181, v219
  s_waitcnt lgkmcnt(8)
  v_mfma_f32_32x32x16_bf16 v[128:143], a[144:147], v[12:15], v[128:143]
  ds_read_b64_tr_b16 a[164:165], v213 offset:2048
  ds_read_b64_tr_b16 a[166:167], v213 offset:3072
  v_mul_f32 v182, v182, v219
  v_mul_f32 v183, v183, v219
  v_cvt_pk_bf16_f32 v228, v176, v177
  v_cvt_pk_bf16_f32 v229, v178, v179
  v_cvt_pk_bf16_f32 v230, v180, v181
  v_mfma_f32_32x32x16_bf16 v[144:159], a[148:151], v[12:15], v[144:159]
  ds_read_b64_tr_b16 a[176:177], v216 offset:8192
  ds_read_b64_tr_b16 a[178:179], v216 offset:9216
  v_cvt_pk_bf16_f32 v231, v182, v183
  s_add_u32 s76, s78, 0x5000
  buffer_store_dwordx4 v[228:231], v217, s[20:23], s76 offen offset:512 sc1
  v_mul_f32 v184, v184, v219
  v_mul_f32 v185, v185, v219
  v_mul_f32 v186, v186, v219
  s_waitcnt lgkmcnt(10)
  v_mfma_f32_16x16x32_bf16 v[160:163], a[172:175], a[8:11], v[160:163]
  v_mul_f32 v187, v187, v219
  v_mul_f32 v188, v188, v219
  v_mul_f32 v189, v189, v219
  v_mfma_f32_16x16x32_bf16 v[164:167], a[172:175], a[12:15], v[164:167]
  v_add_u32 v214, 0xc000, v214
  ds_read_b64_tr_b16 a[128:129], v214
  ds_read_b64_tr_b16 a[130:131], v214 offset:1024
  s_waitcnt lgkmcnt(8)
  v_mfma_f32_32x32x16_bf16 v[128:143], a[152:155], v[16:19], v[128:143]
  v_add_u32 v215, 0xc000, v215
  ds_read_b64_tr_b16 a[132:133], v215
  ds_read_b64_tr_b16 a[134:135], v215 offset:1024
  v_mul_f32 v190, v190, v219
  v_mul_f32 v191, v191, v219
  v_cvt_pk_bf16_f32 v232, v184, v185
  v_cvt_pk_bf16_f32 v233, v186, v187
  v_mfma_f32_32x32x16_bf16 v[144:159], a[156:159], v[16:19], v[144:159]
  ds_read_b64_tr_b16 a[136:137], v214 offset:2048
  ds_read_b64_tr_b16 a[138:139], v214 offset:3072
  v_cvt_pk_bf16_f32 v234, v188, v189
  v_cvt_pk_bf16_f32 v235, v190, v191
  s_add_u32 s77, s78, 0x7800
  buffer_store_dwordx4 v[232:235], v217, s[20:23], s77 offen sc1
  v_mul_f32 v192, v192, v219
  v_mul_f32 v193, v193, v219
  s_waitcnt lgkmcnt(8)
  v_mfma_f32_32x32x16_bf16 v[128:143], a[160:163], v[20:23], v[128:143]
  ds_read_b64_tr_b16 a[140:141], v215 offset:2048
  ds_read_b64_tr_b16 a[142:143], v215 offset:3072
  v_mul_f32 v194, v194, v219
  v_mul_f32 v195, v195, v219
  v_mul_f32 v196, v196, v219
  v_mul_f32 v197, v197, v219
  v_mul_f32 v198, v198, v219
  v_mfma_f32_32x32x16_bf16 v[144:159], a[164:167], v[20:23], v[144:159]
  ds_read_b64_tr_b16 a[180:181], v216 offset:12288
  ds_read_b64_tr_b16 a[182:183], v216 offset:13312
  v_mul_f32 v199, v199, v219
  v_cvt_pk_bf16_f32 v224, v192, v193
  v_cvt_pk_bf16_f32 v225, v194, v195
  v_cvt_pk_bf16_f32 v226, v196, v197
  v_cvt_pk_bf16_f32 v227, v198, v199
  s_add_u32 s76, s78, 0x7800
  s_waitcnt lgkmcnt(10)
  v_mfma_f32_16x16x32_bf16 v[160:163], a[176:179], a[16:19], v[160:163]
  buffer_store_dwordx4 v[224:227], v217, s[20:23], s76 offen offset:512 sc1
  v_mul_f32 v200, v200, v220
  v_mul_f32 v201, v201, v220
  v_mfma_f32_16x16x32_bf16 v[164:167], a[176:179], a[20:23], v[164:167]
  v_mul_f32 v202, v202, v220
  v_mul_f32 v203, v203, v220
  v_cvt_pk_bf16_f32 v236, v200, v201
  s_waitcnt lgkmcnt(6)
  v_mfma_f32_32x32x16_bf16 v[128:143], a[128:131], v[24:27], v[128:143]
  s_waitcnt vmcnt(34)
  s_barrier
  v_add_u32 v208, 0x4000, v208
  v_add_u32 v209, 0x4000, v209
  ds_read_b64_tr_b16 a[144:145], v208
  ds_read_b64_tr_b16 a[146:147], v208 offset:1024
  ds_read_b64_tr_b16 a[148:149], v209
  ds_read_b64_tr_b16 a[150:151], v209 offset:1024
  v_mfma_f32_32x32x16_bf16 v[144:159], a[132:135], v[24:27], v[144:159]
  ds_read_b64_tr_b16 a[152:153], v208 offset:2048
  ds_read_b64_tr_b16 a[154:155], v208 offset:3072
  s_add_u32 m0, s33, 0
  v_cvt_pk_bf16_f32 v237, v202, v203
  s_add_u32 s77, s79, 0x5000
  buffer_store_dwordx2 v[236:237], v218, s[20:23], s77 offen sc1
  v_mul_f32 v204, v204, v221
  s_waitcnt lgkmcnt(8)
  v_mfma_f32_32x32x16_bf16 v[128:143], a[136:139], v[28:31], v[128:143]
  ds_read_b64_tr_b16 a[156:157], v209 offset:2048
  ds_read_b64_tr_b16 a[158:159], v209 offset:3072
  s_add_u32 s75, s62, 0
  v_mul_f32 v205, v205, v221
  v_mul_f32 v206, v206, v221
  v_mul_f32 v207, v207, v221
  v_cvt_pk_bf16_f32 v238, v204, v205
  v_mfma_f32_32x32x16_bf16 v[144:159], a[140:143], v[28:31], v[144:159]
  v_add_u32 v216, 0x4000, v216
  ds_read_b64_tr_b16 a[168:169], v216
  ds_read_b64_tr_b16 a[170:171], v216 offset:1024
  buffer_load_dwordx4 v222, s[16:19], s75 offen lds
  v_cvt_pk_bf16_f32 v239, v206, v207
  s_add_u32 s76, s79, 0x5400
  buffer_store_dwordx2 v[238:239], v218, s[20:23], s76 offen sc1
  s_waitcnt lgkmcnt(10)
  v_mfma_f32_16x16x32_bf16 v[160:163], a[180:183], a[24:27], v[160:163]
  s_add_u32 s74, s62, 0xa00
  v_mfma_f32_16x16x32_bf16 v[164:167], a[180:183], a[28:31], v[164:167]
  v_add_u32 v210, 0x4000, v210
  ds_read_b64_tr_b16 a[160:161], v210
  ds_read_b64_tr_b16 a[162:163], v210 offset:1024
  s_waitcnt lgkmcnt(8)
  v_mfma_f32_32x32x16_bf16 v[128:143], a[144:147], v[32:35], v[128:143]
  v_add_u32 v211, 0x4000, v211
  ds_read_b64_tr_b16 a[164:165], v211
  ds_read_b64_tr_b16 a[166:167], v211 offset:1024
  buffer_load_dwordx4 v223, s[16:19], s74 offen offset:1024 lds
  v_mfma_f32_32x32x16_bf16 v[144:159], a[148:151], v[32:35], v[144:159]
  ds_read_b64_tr_b16 a[128:129], v210 offset:2048
  ds_read_b64_tr_b16 a[130:131], v210 offset:3072
  s_add_u32 s75, s62, 0x1400
  s_waitcnt lgkmcnt(8)
  v_mfma_f32_32x32x16_bf16 v[128:143], a[152:155], v[36:39], v[128:143]
  ds_read_b64_tr_b16 a[132:133], v211 offset:2048
  ds_read_b64_tr_b16 a[134:135], v211 offset:3072
  buffer_load_dwordx4 v222, s[16:19], s75 offen offset:2048 lds
  v_mfma_f32_32x32x16_bf16 v[144:159], a[156:159], v[36:39], v[144:159]
  ds_read_b64_tr_b16 a[172:173], v216 offset:4096
  ds_read_b64_tr_b16 a[174:175], v216 offset:5120
  s_add_u32 s74, s62, 0x1e00
  s_waitcnt lgkmcnt(10)
  v_mfma_f32_16x16x32_bf16 v[160:163], a[168:171], a[32:35], v[160:163]
  v_mfma_f32_16x16x32_bf16 v[164:167], a[168:171], a[36:39], v[164:167]
  v_add_u32 v212, 0x4000, v212
  ds_read_b64_tr_b16 a[136:137], v212
  ds_read_b64_tr_b16 a[138:139], v212 offset:1024
  s_waitcnt lgkmcnt(8)
  v_mfma_f32_32x32x16_bf16 v[128:143], a[160:163], v[40:43], v[128:143]
  v_add_u32 v213, 0x4000, v213
  ds_read_b64_tr_b16 a[140:141], v213
  ds_read_b64_tr_b16 a[142:143], v213 offset:1024
  buffer_load_dwordx4 v223, s[16:19], s74 offen offset:3072 lds
  v_mfma_f32_32x32x16_bf16 v[144:159], a[164:167], v[40:43], v[144:159]
  ds_read_b64_tr_b16 a[144:145], v212 offset:2048
  ds_read_b64_tr_b16 a[146:147], v212 offset:3072
  s_add_u32 m0, s33, 0x14000
  s_waitcnt lgkmcnt(8)
  v_mfma_f32_32x32x16_bf16 v[128:143], a[128:131], v[44:47], v[128:143]
  ds_read_b64_tr_b16 a[148:149], v213 offset:2048
  ds_read_b64_tr_b16 a[150:151], v213 offset:3072
  s_add_u32 s75, s63, 0
  buffer_load_dwordx4 v222, s[16:19], s75 offen lds
  v_mfma_f32_32x32x16_bf16 v[144:159], a[132:135], v[44:47], v[144:159]
  ds_read_b64_tr_b16 a[176:177], v216 offset:8192
  ds_read_b64_tr_b16 a[178:179], v216 offset:9216
  s_add_u32 s74, s63, 0xa00
  s_waitcnt lgkmcnt(10)
  v_mfma_f32_16x16x32_bf16 v[160:163], a[172:175], a[40:43], v[160:163]
  v_mfma_f32_16x16x32_bf16 v[164:167], a[172:175], a[44:47], v[164:167]
  v_add_u32 v214, 0x4000, v214
  ds_read_b64_tr_b16 a[152:153], v214
  ds_read_b64_tr_b16 a[154:155], v214 offset:1024
  s_waitcnt lgkmcnt(8)
  v_mfma_f32_32x32x16_bf16 v[128:143], a[136:139], v[48:51], v[128:143]
  v_add_u32 v215, 0x4000, v215
  ds_read_b64_tr_b16 a[156:157], v215
  ds_read_b64_tr_b16 a[158:159], v215 offset:1024
  buffer_load_dwordx4 v223, s[16:19], s74 offen offset:1024 lds
  v_mfma_f32_32x32x16_bf16 v[144:159], a[140:143], v[48:51], v[144:159]
  ds_read_b64_tr_b16 a[160:161], v214 offset:2048
  ds_read_b64_tr_b16 a[162:163], v214 offset:3072
  s_add_u32 s75, s63, 0x1400
  s_waitcnt lgkmcnt(8)
  v_mfma_f32_32x32x16_bf16 v[128:143], a[144:147], v[52:55], v[128:143]
  ds_read_b64_tr_b16 a[164:165], v215 offset:2048
  ds_read_b64_tr_b16 a[166:167], v215 offset:3072
  buffer_load_dwordx4 v222, s[16:19], s75 offen offset:2048 lds
  v_mfma_f32_32x32x16_bf16 v[144:159], a[148:151], v[52:55], v[144:159]
  ds_read_b64_tr_b16 a[180:181], v216 offset:12288
  ds_read_b64_tr_b16 a[182:183], v216 offset:13312
  s_add_u32 s74, s63, 0x1e00
  s_waitcnt lgkmcnt(10)
  v_mfma_f32_16x16x32_bf16 v[160:163], a[176:179], a[48:51], v[160:163]
  buffer_load_dwordx4 v223, s[16:19], s74 offen offset:3072 lds
  v_mfma_f32_16x16x32_bf16 v[164:167], a[176:179], a[52:55], v[164:167]
  s_waitcnt lgkmcnt(6)
  v_mfma_f32_32x32x16_bf16 v[128:143], a[152:155], v[56:59], v[128:143]
  s_waitcnt vmcnt(40)
  s_barrier
  v_add_u32 v208, 0xfffe0000, v208
  v_add_u32 v209, 0xfffe0000, v209
  ds_read_b64_tr_b16 a[128:129], v208
  ds_read_b64_tr_b16 a[130:131], v208 offset:1024
  ds_read_b64_tr_b16 a[132:133], v209
  ds_read_b64_tr_b16 a[134:135], v209 offset:1024
  v_mfma_f32_32x32x16_bf16 v[144:159], a[156:159], v[56:59], v[144:159]
  ds_read_b64_tr_b16 a[136:137], v208 offset:2048
  ds_read_b64_tr_b16 a[138:139], v208 offset:3072
  s_add_u32 m0, s33, 0x20000
  s_waitcnt lgkmcnt(8)
  v_mfma_f32_32x32x16_bf16 v[128:143], a[160:163], v[60:63], v[128:143]
  ds_read_b64_tr_b16 a[140:141], v209 offset:2048
  ds_read_b64_tr_b16 a[142:143], v209 offset:3072
  s_add_u32 s75, s73, 0
  v_mfma_f32_32x32x16_bf16 v[144:159], a[164:167], v[60:63], v[144:159]
  v_add_u32 v216, 0xfffe0000, v216
  ds_read_b64_tr_b16 a[168:169], v216
  ds_read_b64_tr_b16 a[170:171], v216 offset:1024
  buffer_load_dwordx4 v222, s[16:19], s75 offen lds
  s_waitcnt lgkmcnt(10)
  v_mfma_f32_16x16x32_bf16 v[160:163], a[180:183], a[56:59], v[160:163]
  s_add_u32 s74, s73, 0xa00
  v_mfma_f32_16x16x32_bf16 v[164:167], a[180:183], a[60:63], v[164:167]
  v_add_u32 v210, 0xfffe0000, v210
  ds_read_b64_tr_b16 a[144:145], v210
  ds_read_b64_tr_b16 a[146:147], v210 offset:1024
  s_waitcnt lgkmcnt(8)
  v_mfma_f32_32x32x16_bf16 v[128:143], a[128:131], v[64:67], v[128:143]
  v_add_u32 v211, 0xfffe0000, v211
  ds_read_b64_tr_b16 a[148:149], v211
  ds_read_b64_tr_b16 a[150:151], v211 offset:1024
  buffer_load_dwordx4 v223, s[16:19], s74 offen offset:1024 lds
  v_mfma_f32_32x32x16_bf16 v[144:159], a[132:135], v[64:67], v[144:159]
  ds_read_b64_tr_b16 a[152:153], v210 offset:2048
  ds_read_b64_tr_b16 a[154:155], v210 offset:3072
  s_add_u32 s75, s73, 0x1400
  s_waitcnt lgkmcnt(8)
  v_mfma_f32_32x32x16_bf16 v[128:143], a[136:139], v[68:71], v[128:143]
  ds_read_b64_tr_b16 a[156:157], v211 offset:2048
  ds_read_b64_tr_b16 a[158:159], v211 offset:3072
  buffer_load_dwordx4 v222, s[16:19], s75 offen offset:2048 lds
  v_mfma_f32_32x32x16_bf16 v[144:159], a[140:143], v[68:71], v[144:159]
  ds_read_b64_tr_b16 a[172:173], v216 offset:4096
  ds_read_b64_tr_b16 a[174:175], v216 offset:5120
  s_add_u32 s74, s73, 0x1e00
  s_waitcnt lgkmcnt(10)
  v_mfma_f32_16x16x32_bf16 v[160:163], a[168:171], a[64:67], v[160:163]
  buffer_load_dwordx4 v223, s[16:19], s74 offen offset:3072 lds
  v_mfma_f32_16x16x32_bf16 v[164:167], a[168:171], a[68:71], v[164:167]
  v_add_u32 v212, 0xfffe0000, v212
  ds_read_b64_tr_b16 a[160:161], v212
  ds_read_b64_tr_b16 a[162:163], v212 offset:1024
  s_waitcnt lgkmcnt(8)
  v_mfma_f32_32x32x16_bf16 v[128:143], a[144:147], v[72:75], v[128:143]
  v_add_u32 v213, 0xfffe0000, v213
  ds_read_b64_tr_b16 a[164:165], v213
  ds_read_b64_tr_b16 a[166:167], v213 offset:1024
  v_mfma_f32_32x32x16_bf16 v[144:159], a[148:151], v[72:75], v[144:159]
  ds_read_b64_tr_b16 a[128:129], v212 offset:2048
  ds_read_b64_tr_b16 a[130:131], v212 offset:3072
  s_waitcnt lgkmcnt(8)
  v_mfma_f32_32x32x16_bf16 v[128:143], a[152:155], v[76:79], v[128:143]
  ds_read_b64_tr_b16 a[132:133], v213 offset:2048
  ds_read_b64_tr_b16 a[134:135], v213 offset:3072
  v_mfma_f32_32x32x16_bf16 v[144:159], a[156:159], v[76:79], v[144:159]
  ds_read_b64_tr_b16 a[176:177], v216 offset:8192
  ds_read_b64_tr_b16 a[178:179], v216 offset:9216
  s_waitcnt lgkmcnt(10)
  v_mfma_f32_16x16x32_bf16 v[160:163], a[172:175], a[72:75], v[160:163]
  v_mfma_f32_16x16x32_bf16 v[164:167], a[172:175], a[76:79], v[164:167]
  v_add_u32 v214, 0xfffe0000, v214
  ds_read_b64_tr_b16 a[136:137], v214
  ds_read_b64_tr_b16 a[138:139], v214 offset:1024
  s_waitcnt lgkmcnt(8)
  v_mfma_f32_32x32x16_bf16 v[128:143], a[160:163], v[80:83], v[128:143]
  v_add_u32 v215, 0xfffe0000, v215
  ds_read_b64_tr_b16 a[140:141], v215
  ds_read_b64_tr_b16 a[142:143], v215 offset:1024
  v_mfma_f32_32x32x16_bf16 v[144:159], a[164:167], v[80:83], v[144:159]
  ds_read_b64_tr_b16 a[144:145], v214 offset:2048
  ds_read_b64_tr_b16 a[146:147], v214 offset:3072
  s_waitcnt lgkmcnt(8)
  v_mfma_f32_32x32x16_bf16 v[128:143], a[128:131], v[84:87], v[128:143]
  ds_read_b64_tr_b16 a[148:149], v215 offset:2048
  ds_read_b64_tr_b16 a[150:151], v215 offset:3072
  v_mfma_f32_32x32x16_bf16 v[144:159], a[132:135], v[84:87], v[144:159]
  ds_read_b64_tr_b16 a[180:181], v216 offset:12288
  ds_read_b64_tr_b16 a[182:183], v216 offset:13312
  s_waitcnt lgkmcnt(10)
  v_mfma_f32_16x16x32_bf16 v[160:163], a[176:179], a[80:83], v[160:163]
  v_mfma_f32_16x16x32_bf16 v[164:167], a[176:179], a[84:87], v[164:167]
  s_waitcnt lgkmcnt(6)
  v_mfma_f32_32x32x16_bf16 v[128:143], a[136:139], v[88:91], v[128:143]
  s_waitcnt vmcnt(40)
  s_waitcnt vmcnt(33)
  s_barrier
  s_cmp_eq_u32 s3, 0
  s_cbranch_scc0 concat_heads__mha_block_cached__mha_block_cached__near_ridge_kernel_sig11
  buffer_atomic_add v250, v249, s[56:59], 0 offen
concat_heads__mha_block_cached__mha_block_cached__near_ridge_kernel_sig11:
  v_add_u32 v208, 0x14000, v208
  v_add_u32 v209, 0x14000, v209
  ds_read_b64_tr_b16 a[152:153], v208
  ds_read_b64_tr_b16 a[154:155], v208 offset:1024
  ds_read_b64_tr_b16 a[156:157], v209
  ds_read_b64_tr_b16 a[158:159], v209 offset:1024
  v_mfma_f32_32x32x16_bf16 v[144:159], a[140:143], v[88:91], v[144:159]
  ds_read_b64_tr_b16 a[160:161], v208 offset:2048
  ds_read_b64_tr_b16 a[162:163], v208 offset:3072
  s_add_u32 m0, s33, 0x24000
  s_waitcnt lgkmcnt(8)
  v_mfma_f32_32x32x16_bf16 v[128:143], a[144:147], v[92:95], v[128:143]
  ds_read_b64_tr_b16 a[164:165], v209 offset:2048
  ds_read_b64_tr_b16 a[166:167], v209 offset:3072
  s_add_u32 s75, s35, 0
  v_mfma_f32_32x32x16_bf16 v[144:159], a[148:151], v[92:95], v[144:159]
  v_add_u32 v216, 0x14000, v216
  ds_read_b64_tr_b16 a[168:169], v216
  ds_read_b64_tr_b16 a[170:171], v216 offset:1024
  buffer_load_dwordx4 v222, s[16:19], s75 offen lds
  s_waitcnt lgkmcnt(10)
  v_mfma_f32_16x16x32_bf16 v[160:163], a[180:183], a[88:91], v[160:163]
  s_add_u32 s74, s35, 0xa00
  v_mfma_f32_16x16x32_bf16 v[164:167], a[180:183], a[92:95], v[164:167]
  v_add_u32 v210, 0x14000, v210
  ds_read_b64_tr_b16 a[128:129], v210
  ds_read_b64_tr_b16 a[130:131], v210 offset:1024
  s_waitcnt lgkmcnt(8)
  v_mfma_f32_32x32x16_bf16 v[128:143], a[152:155], v[96:99], v[128:143]
  v_add_u32 v211, 0x14000, v211
  ds_read_b64_tr_b16 a[132:133], v211
  ds_read_b64_tr_b16 a[134:135], v211 offset:1024
  buffer_load_dwordx4 v223, s[16:19], s74 offen offset:1024 lds
  v_mfma_f32_32x32x16_bf16 v[144:159], a[156:159], v[96:99], v[144:159]
  ds_read_b64_tr_b16 a[136:137], v210 offset:2048
  ds_read_b64_tr_b16 a[138:139], v210 offset:3072
  s_add_u32 s75, s35, 0x1400
  s_waitcnt lgkmcnt(8)
  v_mfma_f32_32x32x16_bf16 v[128:143], a[160:163], v[100:103], v[128:143]
  ds_read_b64_tr_b16 a[140:141], v211 offset:2048
  ds_read_b64_tr_b16 a[142:143], v211 offset:3072
  buffer_load_dwordx4 v222, s[16:19], s75 offen offset:2048 lds
  v_mfma_f32_32x32x16_bf16 v[144:159], a[164:167], v[100:103], v[144:159]
  ds_read_b64_tr_b16 a[172:173], v216 offset:4096
  ds_read_b64_tr_b16 a[174:175], v216 offset:5120
  s_add_u32 s74, s35, 0x1e00
  s_waitcnt lgkmcnt(10)
  v_mfma_f32_16x16x32_bf16 v[160:163], a[168:171], a[96:99], v[160:163]
  buffer_load_dwordx4 v223, s[16:19], s74 offen offset:3072 lds
  v_mfma_f32_16x16x32_bf16 v[164:167], a[168:171], a[100:103], v[164:167]
  v_add_u32 v212, 0x14000, v212
  ds_read_b64_tr_b16 a[144:145], v212
  ds_read_b64_tr_b16 a[146:147], v212 offset:1024
  s_waitcnt lgkmcnt(8)
  v_mfma_f32_32x32x16_bf16 v[128:143], a[128:131], v[104:107], v[128:143]
  v_add_u32 v213, 0x14000, v213
  ds_read_b64_tr_b16 a[148:149], v213
  ds_read_b64_tr_b16 a[150:151], v213 offset:1024
  v_mfma_f32_32x32x16_bf16 v[144:159], a[132:135], v[104:107], v[144:159]
  ds_read_b64_tr_b16 a[152:153], v212 offset:2048
  ds_read_b64_tr_b16 a[154:155], v212 offset:3072
  s_waitcnt lgkmcnt(8)
  v_mfma_f32_32x32x16_bf16 v[128:143], a[136:139], v[108:111], v[128:143]
  ds_read_b64_tr_b16 a[156:157], v213 offset:2048
  ds_read_b64_tr_b16 a[158:159], v213 offset:3072
  v_mfma_f32_32x32x16_bf16 v[144:159], a[140:143], v[108:111], v[144:159]
  ds_read_b64_tr_b16 a[176:177], v216 offset:8192
  ds_read_b64_tr_b16 a[178:179], v216 offset:9216
  s_waitcnt lgkmcnt(10)
  v_mfma_f32_16x16x32_bf16 v[160:163], a[172:175], a[104:107], v[160:163]
  v_mfma_f32_16x16x32_bf16 v[164:167], a[172:175], a[108:111], v[164:167]
  v_add_u32 v214, 0x14000, v214
  ds_read_b64_tr_b16 a[160:161], v214
  ds_read_b64_tr_b16 a[162:163], v214 offset:1024
  s_waitcnt lgkmcnt(8)
  v_mfma_f32_32x32x16_bf16 v[128:143], a[144:147], v[112:115], v[128:143]
  v_add_u32 v215, 0x14000, v215
  ds_read_b64_tr_b16 a[164:165], v215
  ds_read_b64_tr_b16 a[166:167], v215 offset:1024
  v_mfma_f32_32x32x16_bf16 v[144:159], a[148:151], v[112:115], v[144:159]
  ds_read_b64_tr_b16 a[128:129], v214 offset:2048
  ds_read_b64_tr_b16 a[130:131], v214 offset:3072
  s_waitcnt lgkmcnt(8)
  v_mfma_f32_32x32x16_bf16 v[128:143], a[152:155], v[116:119], v[128:143]
  ds_read_b64_tr_b16 a[132:133], v215 offset:2048
  ds_read_b64_tr_b16 a[134:135], v215 offset:3072
  v_mfma_f32_32x32x16_bf16 v[144:159], a[156:159], v[116:119], v[144:159]
  ds_read_b64_tr_b16 a[180:181], v216 offset:12288
  ds_read_b64_tr_b16 a[182:183], v216 offset:13312
  s_waitcnt lgkmcnt(10)
  v_mfma_f32_16x16x32_bf16 v[160:163], a[176:179], a[112:115], v[160:163]
  v_mfma_f32_16x16x32_bf16 v[164:167], a[176:179], a[116:119], v[164:167]
  s_waitcnt lgkmcnt(6)
  v_mfma_f32_32x32x16_bf16 v[128:143], a[160:163], v[120:123], v[128:143]
  s_waitcnt vmcnt(34)
  s_barrier
  v_add_u32 v208, 0x4000, v208
  v_add_u32 v209, 0x4000, v209
  ds_read_b64_tr_b16 a[136:137], v208
  ds_read_b64_tr_b16 a[138:139], v208 offset:1024
  ds_read_b64_tr_b16 a[140:141], v209
  ds_read_b64_tr_b16 a[142:143], v209 offset:1024
  v_mfma_f32_32x32x16_bf16 v[144:159], a[164:167], v[120:123], v[144:159]
  ds_read_b64_tr_b16 a[144:145], v208 offset:2048
  ds_read_b64_tr_b16 a[146:147], v208 offset:3072
  s_add_u32 m0, s33, 0x4000
  s_waitcnt lgkmcnt(8)
  v_mfma_f32_32x32x16_bf16 v[128:143], a[128:131], v[124:127], v[128:143]
  ds_read_b64_tr_b16 a[148:149], v209 offset:2048
  ds_read_b64_tr_b16 a[150:151], v209 offset:3072
  s_add_u32 s75, s62, 0xe000
  v_mfma_f32_32x32x16_bf16 v[144:159], a[132:135], v[124:127], v[144:159]
  v_add_u32 v216, 0x4000, v216
  ds_read_b64_tr_b16 a[168:169], v216
  ds_read_b64_tr_b16 a[170:171], v216 offset:1024
  buffer_load_dwordx4 v222, s[16:19], s75 offen lds
  s_waitcnt lgkmcnt(10)
  v_mfma_f32_16x16x32_bf16 v[160:163], a[180:183], a[120:123], v[160:163]
  s_add_u32 s74, s62, 0xea00
  v_mfma_f32_16x16x32_bf16 v[164:167], a[180:183], a[124:127], v[164:167]
  v_add_u32 v210, 0x4000, v210
  ds_read_b64_tr_b16 a[152:153], v210
  ds_read_b64_tr_b16 a[154:155], v210 offset:1024
  s_waitcnt lgkmcnt(8)
  v_mfma_f32_32x32x16_bf16 v[168:183], a[136:139], v[0:3], 0
  v_add_u32 v211, 0x4000, v211
  ds_read_b64_tr_b16 a[156:157], v211
  ds_read_b64_tr_b16 a[158:159], v211 offset:1024
  buffer_load_dwordx4 v223, s[16:19], s74 offen offset:1024 lds
  v_mfma_f32_32x32x16_bf16 v[184:199], a[140:143], v[0:3], 0
  ds_read_b64_tr_b16 a[160:161], v210 offset:2048
  ds_read_b64_tr_b16 a[162:163], v210 offset:3072
  s_add_u32 s75, s62, 0xf400
  s_waitcnt lgkmcnt(8)
  v_mfma_f32_32x32x16_bf16 v[168:183], a[144:147], v[4:7], v[168:183]
  ds_read_b64_tr_b16 a[164:165], v211 offset:2048
  ds_read_b64_tr_b16 a[166:167], v211 offset:3072
  buffer_load_dwordx4 v222, s[16:19], s75 offen offset:2048 lds
  v_mul_f32 v128, v128, v219
  v_mul_f32 v129, v129, v219
  v_mul_f32 v130, v130, v219
  v_mul_f32 v131, v131, v219
  v_mfma_f32_32x32x16_bf16 v[184:199], a[148:151], v[4:7], v[184:199]
  ds_read_b64_tr_b16 a[172:173], v216 offset:4096
  ds_read_b64_tr_b16 a[174:175], v216 offset:5120
  s_add_u32 s74, s62, 0xfe00
  v_mul_f32 v132, v132, v219
  v_mul_f32 v133, v133, v219
  v_mul_f32 v134, v134, v219
  v_mul_f32 v135, v135, v219
  s_waitcnt lgkmcnt(10)
  v_mfma_f32_16x16x32_bf16 v[200:203], a[168:171], a[0:3], 0
  buffer_load_dwordx4 v223, s[16:19], s74 offen offset:3072 lds
  v_cvt_pk_bf16_f32 v224, v128, v129
  v_cvt_pk_bf16_f32 v225, v130, v131
  v_mfma_f32_16x16x32_bf16 v[204:207], a[168:171], a[4:7], 0
  v_add_u32 v212, 0x4000, v212
  ds_read_b64_tr_b16 a[128:129], v212
  ds_read_b64_tr_b16 a[130:131], v212 offset:1024
  s_waitcnt lgkmcnt(8)
  v_mfma_f32_32x32x16_bf16 v[168:183], a[152:155], v[8:11], v[168:183]
  v_add_u32 v213, 0x4000, v213
  ds_read_b64_tr_b16 a[132:133], v213
  ds_read_b64_tr_b16 a[134:135], v213 offset:1024
  v_cvt_pk_bf16_f32 v226, v132, v133
  v_cvt_pk_bf16_f32 v227, v134, v135
  s_add_u32 s77, s78, 0xa000
  buffer_store_dwordx4 v[224:227], v217, s[20:23], s77 offen sc1
  v_mfma_f32_32x32x16_bf16 v[184:199], a[156:159], v[8:11], v[184:199]
  ds_read_b64_tr_b16 a[136:137], v212 offset:2048
  ds_read_b64_tr_b16 a[138:139], v212 offset:3072
  v_mul_f32 v136, v136, v219
  v_mul_f32 v137, v137, v219
  v_mul_f32 v138, v138, v219
  v_mul_f32 v139, v139, v219
  v_mul_f32 v140, v140, v219
  v_mul_f32 v141, v141, v219
  s_waitcnt lgkmcnt(8)
  v_mfma_f32_32x32x16_bf16 v[168:183], a[160:163], v[12:15], v[168:183]
  ds_read_b64_tr_b16 a[140:141], v213 offset:2048
  ds_read_b64_tr_b16 a[142:143], v213 offset:3072
  v_mul_f32 v142, v142, v219
  v_mul_f32 v143, v143, v219
  v_cvt_pk_bf16_f32 v228, v136, v137
  v_cvt_pk_bf16_f32 v229, v138, v139
  v_cvt_pk_bf16_f32 v230, v140, v141
  v_mfma_f32_32x32x16_bf16 v[184:199], a[164:167], v[12:15], v[184:199]
  ds_read_b64_tr_b16 a[176:177], v216 offset:8192
  ds_read_b64_tr_b16 a[178:179], v216 offset:9216
  v_cvt_pk_bf16_f32 v231, v142, v143
  s_add_u32 s76, s78, 0xa000
  buffer_store_dwordx4 v[228:231], v217, s[20:23], s76 offen offset:512 sc1
  v_mul_f32 v144, v144, v219
  v_mul_f32 v145, v145, v219
  v_mul_f32 v146, v146, v219
  s_waitcnt lgkmcnt(10)
  v_mfma_f32_16x16x32_bf16 v[200:203], a[172:175], a[8:11], v[200:203]
  v_mul_f32 v147, v147, v219
  v_mul_f32 v148, v148, v219
  v_mul_f32 v149, v149, v219
  v_mfma_f32_16x16x32_bf16 v[204:207], a[172:175], a[12:15], v[204:207]
  v_add_u32 v214, 0x4000, v214
  ds_read_b64_tr_b16 a[144:145], v214
  ds_read_b64_tr_b16 a[146:147], v214 offset:1024
  s_waitcnt lgkmcnt(8)
  v_mfma_f32_32x32x16_bf16 v[168:183], a[128:131], v[16:19], v[168:183]
  v_add_u32 v215, 0x4000, v215
  ds_read_b64_tr_b16 a[148:149], v215
  ds_read_b64_tr_b16 a[150:151], v215 offset:1024
  v_mul_f32 v150, v150, v219
  v_mul_f32 v151, v151, v219
  v_cvt_pk_bf16_f32 v232, v144, v145
  v_cvt_pk_bf16_f32 v233, v146, v147
  v_mfma_f32_32x32x16_bf16 v[184:199], a[132:135], v[16:19], v[184:199]
  ds_read_b64_tr_b16 a[152:153], v214 offset:2048
  ds_read_b64_tr_b16 a[154:155], v214 offset:3072
  v_cvt_pk_bf16_f32 v234, v148, v149
  v_cvt_pk_bf16_f32 v235, v150, v151
  s_add_u32 s77, s78, 0xc800
  buffer_store_dwordx4 v[232:235], v217, s[20:23], s77 offen sc1
  v_mul_f32 v152, v152, v219
  v_mul_f32 v153, v153, v219
  s_waitcnt lgkmcnt(8)
  v_mfma_f32_32x32x16_bf16 v[168:183], a[136:139], v[20:23], v[168:183]
  ds_read_b64_tr_b16 a[156:157], v215 offset:2048
  ds_read_b64_tr_b16 a[158:159], v215 offset:3072
  v_mul_f32 v154, v154, v219
  v_mul_f32 v155, v155, v219
  v_mul_f32 v156, v156, v219
  v_mul_f32 v157, v157, v219
  v_mul_f32 v158, v158, v219
  v_mfma_f32_32x32x16_bf16 v[184:199], a[140:143], v[20:23], v[184:199]
  ds_read_b64_tr_b16 a[180:181], v216 offset:12288
  ds_read_b64_tr_b16 a[182:183], v216 offset:13312
  v_mul_f32 v159, v159, v219
  v_cvt_pk_bf16_f32 v224, v152, v153
  v_cvt_pk_bf16_f32 v225, v154, v155
  v_cvt_pk_bf16_f32 v226, v156, v157
  v_cvt_pk_bf16_f32 v227, v158, v159
  s_add_u32 s76, s78, 0xc800
  s_waitcnt lgkmcnt(10)
  v_mfma_f32_16x16x32_bf16 v[200:203], a[176:179], a[16:19], v[200:203]
  buffer_store_dwordx4 v[224:227], v217, s[20:23], s76 offen offset:512 sc1
  v_mul_f32 v160, v160, v220
  v_mul_f32 v161, v161, v220
  v_mfma_f32_16x16x32_bf16 v[204:207], a[176:179], a[20:23], v[204:207]
  v_mul_f32 v162, v162, v220
  v_mul_f32 v163, v163, v220
  v_cvt_pk_bf16_f32 v236, v160, v161
  s_waitcnt lgkmcnt(6)
  v_mfma_f32_32x32x16_bf16 v[168:183], a[144:147], v[24:27], v[168:183]
  s_waitcnt vmcnt(38)
  s_barrier
  buffer_load_dword v251, v249, s[56:59], 0 offen sc1
  v_add_u32 v208, 0xfffec000, v208
  v_add_u32 v209, 0xfffec000, v209
  ds_read_b64_tr_b16 a[160:161], v208
  ds_read_b64_tr_b16 a[162:163], v208 offset:1024
  ds_read_b64_tr_b16 a[164:165], v209
  ds_read_b64_tr_b16 a[166:167], v209 offset:1024
  v_mfma_f32_32x32x16_bf16 v[184:199], a[148:151], v[24:27], v[184:199]
  ds_read_b64_tr_b16 a[128:129], v208 offset:2048
  ds_read_b64_tr_b16 a[130:131], v208 offset:3072
  s_add_u32 m0, s33, 0x18000
  v_cvt_pk_bf16_f32 v237, v162, v163
  s_add_u32 s77, s79, 0xa000
  buffer_store_dwordx2 v[236:237], v218, s[20:23], s77 offen sc1
  v_mul_f32 v164, v164, v221
  s_waitcnt lgkmcnt(8)
  v_mfma_f32_32x32x16_bf16 v[168:183], a[152:155], v[28:31], v[168:183]
  ds_read_b64_tr_b16 a[132:133], v209 offset:2048
  ds_read_b64_tr_b16 a[134:135], v209 offset:3072
  s_add_u32 s75, s63, 0xe000
  v_mul_f32 v165, v165, v221
  v_mul_f32 v166, v166, v221
  v_mul_f32 v167, v167, v221
  v_cvt_pk_bf16_f32 v238, v164, v165
  v_mfma_f32_32x32x16_bf16 v[184:199], a[156:159], v[28:31], v[184:199]
  v_add_u32 v216, 0xfffec000, v216
  ds_read_b64_tr_b16 a[168:169], v216
  ds_read_b64_tr_b16 a[170:171], v216 offset:1024
  buffer_load_dwordx4 v222, s[16:19], s75 offen lds
  v_cvt_pk_bf16_f32 v239, v166, v167
  s_add_u32 s76, s79, 0xa400
  buffer_store_dwordx2 v[238:239], v218, s[20:23], s76 offen sc1
  s_waitcnt lgkmcnt(10)
  v_mfma_f32_16x16x32_bf16 v[200:203], a[180:183], a[24:27], v[200:203]
  s_add_u32 s74, s63, 0xea00
  v_mfma_f32_16x16x32_bf16 v[204:207], a[180:183], a[28:31], v[204:207]
  v_add_u32 v210, 0xfffec000, v210
  ds_read_b64_tr_b16 a[136:137], v210
  ds_read_b64_tr_b16 a[138:139], v210 offset:1024
  s_waitcnt lgkmcnt(8)
  v_mfma_f32_32x32x16_bf16 v[168:183], a[160:163], v[32:35], v[168:183]
  v_add_u32 v211, 0xfffec000, v211
  ds_read_b64_tr_b16 a[140:141], v211
  ds_read_b64_tr_b16 a[142:143], v211 offset:1024
  buffer_load_dwordx4 v223, s[16:19], s74 offen offset:1024 lds
  v_mfma_f32_32x32x16_bf16 v[184:199], a[164:167], v[32:35], v[184:199]
  ds_read_b64_tr_b16 a[144:145], v210 offset:2048
  ds_read_b64_tr_b16 a[146:147], v210 offset:3072
  s_add_u32 s75, s63, 0xf400
  s_waitcnt lgkmcnt(8)
  v_mfma_f32_32x32x16_bf16 v[168:183], a[128:131], v[36:39], v[168:183]
  ds_read_b64_tr_b16 a[148:149], v211 offset:2048
  ds_read_b64_tr_b16 a[150:151], v211 offset:3072
  buffer_load_dwordx4 v222, s[16:19], s75 offen offset:2048 lds
  v_mfma_f32_32x32x16_bf16 v[184:199], a[132:135], v[36:39], v[184:199]
  ds_read_b64_tr_b16 a[172:173], v216 offset:4096
  ds_read_b64_tr_b16 a[174:175], v216 offset:5120
  s_add_u32 s74, s63, 0xfe00
  s_waitcnt lgkmcnt(10)
  v_mfma_f32_16x16x32_bf16 v[200:203], a[168:171], a[32:35], v[200:203]
  buffer_load_dwordx4 v223, s[16:19], s74 offen offset:3072 lds
  v_mfma_f32_16x16x32_bf16 v[204:207], a[168:171], a[36:39], v[204:207]
  v_add_u32 v212, 0xfffec000, v212
  ds_read_b64_tr_b16 a[152:153], v212
  ds_read_b64_tr_b16 a[154:155], v212 offset:1024
  s_waitcnt lgkmcnt(8)
  v_mfma_f32_32x32x16_bf16 v[168:183], a[136:139], v[40:43], v[168:183]
  v_add_u32 v213, 0xfffec000, v213
  ds_read_b64_tr_b16 a[156:157], v213
  ds_read_b64_tr_b16 a[158:159], v213 offset:1024
  v_mfma_f32_32x32x16_bf16 v[184:199], a[140:143], v[40:43], v[184:199]
  ds_read_b64_tr_b16 a[160:161], v212 offset:2048
  ds_read_b64_tr_b16 a[162:163], v212 offset:3072
  s_waitcnt lgkmcnt(8)
  v_mfma_f32_32x32x16_bf16 v[168:183], a[144:147], v[44:47], v[168:183]
  ds_read_b64_tr_b16 a[164:165], v213 offset:2048
  ds_read_b64_tr_b16 a[166:167], v213 offset:3072
  v_mfma_f32_32x32x16_bf16 v[184:199], a[148:151], v[44:47], v[184:199]
  ds_read_b64_tr_b16 a[176:177], v216 offset:8192
  ds_read_b64_tr_b16 a[178:179], v216 offset:9216
  s_waitcnt lgkmcnt(10)
  v_mfma_f32_16x16x32_bf16 v[200:203], a[172:175], a[40:43], v[200:203]
  v_mfma_f32_16x16x32_bf16 v[204:207], a[172:175], a[44:47], v[204:207]
  v_add_u32 v214, 0xfffec000, v214
  ds_read_b64_tr_b16 a[128:129], v214
  ds_read_b64_tr_b16 a[130:131], v214 offset:1024
  s_waitcnt lgkmcnt(8)
  v_mfma_f32_32x32x16_bf16 v[168:183], a[152:155], v[48:51], v[168:183]
  v_add_u32 v215, 0xfffec000, v215
  ds_read_b64_tr_b16 a[132:133], v215
  ds_read_b64_tr_b16 a[134:135], v215 offset:1024
  v_mfma_f32_32x32x16_bf16 v[184:199], a[156:159], v[48:51], v[184:199]
  ds_read_b64_tr_b16 a[136:137], v214 offset:2048
  ds_read_b64_tr_b16 a[138:139], v214 offset:3072
  s_waitcnt lgkmcnt(8)
  v_mfma_f32_32x32x16_bf16 v[168:183], a[160:163], v[52:55], v[168:183]
  ds_read_b64_tr_b16 a[140:141], v215 offset:2048
  ds_read_b64_tr_b16 a[142:143], v215 offset:3072
  v_mfma_f32_32x32x16_bf16 v[184:199], a[164:167], v[52:55], v[184:199]
  ds_read_b64_tr_b16 a[180:181], v216 offset:12288
  ds_read_b64_tr_b16 a[182:183], v216 offset:13312
  s_waitcnt lgkmcnt(10)
  v_mfma_f32_16x16x32_bf16 v[200:203], a[176:179], a[48:51], v[200:203]
  v_mfma_f32_16x16x32_bf16 v[204:207], a[176:179], a[52:55], v[204:207]
  s_waitcnt lgkmcnt(6)
  v_mfma_f32_32x32x16_bf16 v[168:183], a[128:131], v[56:59], v[168:183]
  s_waitcnt vmcnt(41)
  s_barrier
  v_add_u32 v208, 0x4000, v208
  v_add_u32 v209, 0x4000, v209
  ds_read_b64_tr_b16 a[144:145], v208
  ds_read_b64_tr_b16 a[146:147], v208 offset:1024
  ds_read_b64_tr_b16 a[148:149], v209
  ds_read_b64_tr_b16 a[150:151], v209 offset:1024
  v_mfma_f32_32x32x16_bf16 v[184:199], a[132:135], v[56:59], v[184:199]
  ds_read_b64_tr_b16 a[152:153], v208 offset:2048
  ds_read_b64_tr_b16 a[154:155], v208 offset:3072
  s_add_u32 m0, s33, 0x1c000
  s_waitcnt lgkmcnt(8)
  v_mfma_f32_32x32x16_bf16 v[168:183], a[136:139], v[60:63], v[168:183]
  ds_read_b64_tr_b16 a[156:157], v209 offset:2048
  ds_read_b64_tr_b16 a[158:159], v209 offset:3072
  s_add_u32 s75, s73, 0xe000
  v_mfma_f32_32x32x16_bf16 v[184:199], a[140:143], v[60:63], v[184:199]
  v_add_u32 v216, 0x4000, v216
  ds_read_b64_tr_b16 a[168:169], v216
  ds_read_b64_tr_b16 a[170:171], v216 offset:1024
  buffer_load_dwordx4 v222, s[16:19], s75 offen lds
  s_waitcnt lgkmcnt(10)
  v_mfma_f32_16x16x32_bf16 v[200:203], a[180:183], a[56:59], v[200:203]
  s_add_u32 s74, s73, 0xea00
  v_mfma_f32_16x16x32_bf16 v[204:207], a[180:183], a[60:63], v[204:207]
  v_add_u32 v210, 0x4000, v210
  ds_read_b64_tr_b16 a[160:161], v210
  ds_read_b64_tr_b16 a[162:163], v210 offset:1024
  s_waitcnt lgkmcnt(8)
  v_mfma_f32_32x32x16_bf16 v[168:183], a[144:147], v[64:67], v[168:183]
  v_add_u32 v211, 0x4000, v211
  ds_read_b64_tr_b16 a[164:165], v211
  ds_read_b64_tr_b16 a[166:167], v211 offset:1024
  buffer_load_dwordx4 v223, s[16:19], s74 offen offset:1024 lds
  v_mfma_f32_32x32x16_bf16 v[184:199], a[148:151], v[64:67], v[184:199]
  ds_read_b64_tr_b16 a[128:129], v210 offset:2048
  ds_read_b64_tr_b16 a[130:131], v210 offset:3072
  s_add_u32 s75, s73, 0xf400
  s_waitcnt lgkmcnt(8)
  v_mfma_f32_32x32x16_bf16 v[168:183], a[152:155], v[68:71], v[168:183]
  ds_read_b64_tr_b16 a[132:133], v211 offset:2048
  ds_read_b64_tr_b16 a[134:135], v211 offset:3072
  buffer_load_dwordx4 v222, s[16:19], s75 offen offset:2048 lds
  v_mfma_f32_32x32x16_bf16 v[184:199], a[156:159], v[68:71], v[184:199]
  ds_read_b64_tr_b16 a[172:173], v216 offset:4096
  ds_read_b64_tr_b16 a[174:175], v216 offset:5120
  s_add_u32 s74, s73, 0xfe00
  s_waitcnt lgkmcnt(10)
  v_mfma_f32_16x16x32_bf16 v[200:203], a[168:171], a[64:67], v[200:203]
  buffer_load_dwordx4 v223, s[16:19], s74 offen offset:3072 lds
  v_mfma_f32_16x16x32_bf16 v[204:207], a[168:171], a[68:71], v[204:207]
  v_add_u32 v212, 0x4000, v212
  ds_read_b64_tr_b16 a[136:137], v212
  ds_read_b64_tr_b16 a[138:139], v212 offset:1024
  s_waitcnt lgkmcnt(8)
  v_mfma_f32_32x32x16_bf16 v[168:183], a[160:163], v[72:75], v[168:183]
  v_add_u32 v213, 0x4000, v213
  ds_read_b64_tr_b16 a[140:141], v213
  ds_read_b64_tr_b16 a[142:143], v213 offset:1024
  v_mfma_f32_32x32x16_bf16 v[184:199], a[164:167], v[72:75], v[184:199]
  ds_read_b64_tr_b16 a[144:145], v212 offset:2048
  ds_read_b64_tr_b16 a[146:147], v212 offset:3072
  s_waitcnt lgkmcnt(8)
  v_mfma_f32_32x32x16_bf16 v[168:183], a[128:131], v[76:79], v[168:183]
  ds_read_b64_tr_b16 a[148:149], v213 offset:2048
  ds_read_b64_tr_b16 a[150:151], v213 offset:3072
  v_mfma_f32_32x32x16_bf16 v[184:199], a[132:135], v[76:79], v[184:199]
  ds_read_b64_tr_b16 a[176:177], v216 offset:8192
  ds_read_b64_tr_b16 a[178:179], v216 offset:9216
  s_waitcnt lgkmcnt(10)
  v_mfma_f32_16x16x32_bf16 v[200:203], a[172:175], a[72:75], v[200:203]
  v_mfma_f32_16x16x32_bf16 v[204:207], a[172:175], a[76:79], v[204:207]
  v_add_u32 v214, 0x4000, v214
  ds_read_b64_tr_b16 a[152:153], v214
  ds_read_b64_tr_b16 a[154:155], v214 offset:1024
  s_waitcnt lgkmcnt(8)
  v_mfma_f32_32x32x16_bf16 v[168:183], a[136:139], v[80:83], v[168:183]
  v_add_u32 v215, 0x4000, v215
  ds_read_b64_tr_b16 a[156:157], v215
  ds_read_b64_tr_b16 a[158:159], v215 offset:1024
  v_mfma_f32_32x32x16_bf16 v[184:199], a[140:143], v[80:83], v[184:199]
  ds_read_b64_tr_b16 a[160:161], v214 offset:2048
  ds_read_b64_tr_b16 a[162:163], v214 offset:3072
  s_waitcnt lgkmcnt(8)
  v_mfma_f32_32x32x16_bf16 v[168:183], a[144:147], v[84:87], v[168:183]
  ds_read_b64_tr_b16 a[164:165], v215 offset:2048
  ds_read_b64_tr_b16 a[166:167], v215 offset:3072
  v_mfma_f32_32x32x16_bf16 v[184:199], a[148:151], v[84:87], v[184:199]
  ds_read_b64_tr_b16 a[180:181], v216 offset:12288
  ds_read_b64_tr_b16 a[182:183], v216 offset:13312
  s_waitcnt lgkmcnt(10)
  v_mfma_f32_16x16x32_bf16 v[200:203], a[176:179], a[80:83], v[200:203]
  v_mfma_f32_16x16x32_bf16 v[204:207], a[176:179], a[84:87], v[204:207]
  s_waitcnt lgkmcnt(6)
  v_mfma_f32_32x32x16_bf16 v[168:183], a[152:155], v[88:91], v[168:183]
  s_waitcnt vmcnt(41)
  s_waitcnt vmcnt(34)
  s_waitcnt vmcnt(7)
  s_barrier
  s_cmp_eq_u32 s3, 0
  s_cbranch_scc0 concat_heads__mha_block_cached__mha_block_cached__near_ridge_kernel_sig12
  buffer_atomic_add v250, v249, s[56:59], 0 offen
  buffer_atomic_add v250, v249, s[56:59], 0 offen
concat_heads__mha_block_cached__mha_block_cached__near_ridge_kernel_sig12:
  v_readfirstlane_b32 s44, v251
  s_nop 1
  s_and_b32 s44, s44, 0xf0f0f0f
  s_add_u32 s44, s44, 0x7f7f7f7f
  s_and_b32 s44, s44, 0x80808080
  s_cmp_eq_u32 s44, 0x80808080
  s_cbranch_scc0 concat_heads__mha_block_cached__mha_block_cached__near_ridge_kernel_spin13
concat_heads__mha_block_cached__mha_block_cached__near_ridge_kernel_go13:
  buffer_load_dword v251, v249, s[56:59], 0 offen sc1
  v_add_u32 v208, 0x4000, v208
  v_add_u32 v209, 0x4000, v209
  ds_read_b64_tr_b16 a[128:129], v208
  ds_read_b64_tr_b16 a[130:131], v208 offset:1024
  ds_read_b64_tr_b16 a[132:133], v209
  ds_read_b64_tr_b16 a[134:135], v209 offset:1024
  v_mfma_f32_32x32x16_bf16 v[184:199], a[156:159], v[88:91], v[184:199]
  ds_read_b64_tr_b16 a[136:137], v208 offset:2048
  ds_read_b64_tr_b16 a[138:139], v208 offset:3072
  s_add_u32 m0, s33, 0x8000
  s_waitcnt lgkmcnt(8)
  v_mfma_f32_32x32x16_bf16 v[168:183], a[160:163], v[92:95], v[168:183]
  ds_read_b64_tr_b16 a[140:141], v209 offset:2048
  ds_read_b64_tr_b16 a[142:143], v209 offset:3072
  s_add_u32 s75, s35, 0xe000
  v_mfma_f32_32x32x16_bf16 v[184:199], a[164:167], v[92:95], v[184:199]
  v_add_u32 v216, 0x4000, v216
  ds_read_b64_tr_b16 a[168:169], v216
  ds_read_b64_tr_b16 a[170:171], v216 offset:1024
  buffer_load_dwordx4 v222, s[16:19], s75 offen lds
  s_add_u32 s47, s52, 0
  s_waitcnt lgkmcnt(10)
  v_mfma_f32_16x16x32_bf16 v[200:203], a[180:183], a[88:91], v[200:203]
  s_add_u32 s74, s35, 0xea00
  v_mfma_f32_16x16x32_bf16 v[204:207], a[180:183], a[92:95], v[204:207]
  v_add_u32 v210, 0x4000, v210
  ds_read_b64_tr_b16 a[144:145], v210
  ds_read_b64_tr_b16 a[146:147], v210 offset:1024
  s_waitcnt lgkmcnt(8)
  v_mfma_f32_32x32x16_bf16 v[168:183], a[128:131], v[96:99], v[168:183]
  v_add_u32 v211, 0x4000, v211
  ds_read_b64_tr_b16 a[148:149], v211
  ds_read_b64_tr_b16 a[150:151], v211 offset:1024
  buffer_load_dwordx4 v223, s[16:19], s74 offen offset:1024 lds
  v_mfma_f32_32x32x16_bf16 v[184:199], a[132:135], v[96:99], v[184:199]
  ds_read_b64_tr_b16 a[152:153], v210 offset:2048
  ds_read_b64_tr_b16 a[154:155], v210 offset:3072
  s_add_u32 s75, s35, 0xf400
  buffer_load_dwordx4 a[0:3], v248, s[20:23], s47 offen sc1
  s_waitcnt lgkmcnt(8)
  v_mfma_f32_32x32x16_bf16 v[168:183], a[136:139], v[100:103], v[168:183]
  ds_read_b64_tr_b16 a[156:157], v211 offset:2048
  ds_read_b64_tr_b16 a[158:159], v211 offset:3072
  buffer_load_dwordx4 v222, s[16:19], s75 offen offset:2048 lds
  buffer_load_dwordx4 a[4:7], v248, s[20:23], s47 offen offset:1024 sc1
  v_mfma_f32_32x32x16_bf16 v[184:199], a[140:143], v[100:103], v[184:199]
  ds_read_b64_tr_b16 a[172:173], v216 offset:4096
  ds_read_b64_tr_b16 a[174:175], v216 offset:5120
  s_add_u32 s74, s35, 0xfe00
  s_add_u32 s46, s68, 0
  s_waitcnt lgkmcnt(10)
  v_mfma_f32_16x16x32_bf16 v[200:203], a[168:171], a[96:99], v[200:203]
  buffer_load_dwordx4 v223, s[16:19], s74 offen offset:3072 lds
  v_mfma_f32_16x16x32_bf16 v[204:207], a[168:171], a[100:103], v[204:207]
  v_add_u32 v212, 0x4000, v212
  ds_read_b64_tr_b16 a[160:161], v212
  ds_read_b64_tr_b16 a[162:163], v212 offset:1024
  s_waitcnt lgkmcnt(8)
  v_mfma_f32_32x32x16_bf16 v[168:183], a[144:147], v[104:107], v[168:183]
  v_add_u32 v213, 0x4000, v213
  ds_read_b64_tr_b16 a[164:165], v213
  ds_read_b64_tr_b16 a[166:167], v213 offset:1024
  buffer_load_dwordx4 a[8:11], v248, s[20:23], s46 offen sc1
  v_mfma_f32_32x32x16_bf16 v[184:199], a[148:151], v[104:107], v[184:199]
  ds_read_b64_tr_b16 a[128:129], v212 offset:2048
  ds_read_b64_tr_b16 a[130:131], v212 offset:3072
  s_add_u32 s47, s52, 0x2800
  s_waitcnt lgkmcnt(8)
  v_mfma_f32_32x32x16_bf16 v[168:183], a[152:155], v[108:111], v[168:183]
  ds_read_b64_tr_b16 a[132:133], v213 offset:2048
  ds_read_b64_tr_b16 a[134:135], v213 offset:3072
  buffer_load_dwordx4 a[12:15], v248, s[20:23], s47 offen sc1
  v_mfma_f32_32x32x16_bf16 v[184:199], a[156:159], v[108:111], v[184:199]
  ds_read_b64_tr_b16 a[176:177], v216 offset:8192
  ds_read_b64_tr_b16 a[178:179], v216 offset:9216
  buffer_load_dwordx4 a[16:19], v248, s[20:23], s47 offen offset:1024 sc1
  s_waitcnt lgkmcnt(10)
  v_mfma_f32_16x16x32_bf16 v[200:203], a[172:175], a[104:107], v[200:203]
  v_mfma_f32_16x16x32_bf16 v[204:207], a[172:175], a[108:111], v[204:207]
  v_add_u32 v214, 0x4000, v214
  ds_read_b64_tr_b16 a[136:137], v214
  ds_read_b64_tr_b16 a[138:139], v214 offset:1024
  s_waitcnt lgkmcnt(8)
  v_mfma_f32_32x32x16_bf16 v[168:183], a[160:163], v[112:115], v[168:183]
  v_add_u32 v215, 0x4000, v215
  ds_read_b64_tr_b16 a[140:141], v215
  ds_read_b64_tr_b16 a[142:143], v215 offset:1024
  s_add_u32 s46, s68, 0x2800
  v_mfma_f32_32x32x16_bf16 v[184:199], a[164:167], v[112:115], v[184:199]
  ds_read_b64_tr_b16 a[144:145], v214 offset:2048
  ds_read_b64_tr_b16 a[146:147], v214 offset:3072
  buffer_load_dwordx4 a[20:23], v248, s[20:23], s46 offen sc1
  s_waitcnt lgkmcnt(8)
  v_mfma_f32_32x32x16_bf16 v[168:183], a[128:131], v[116:119], v[168:183]
  ds_read_b64_tr_b16 a[148:149], v215 offset:2048
  ds_read_b64_tr_b16 a[150:151], v215 offset:3072
  s_add_u32 s47, s53, 0
  v_mfma_f32_32x32x16_bf16 v[184:199], a[132:135], v[116:119], v[184:199]
  ds_read_b64_tr_b16 a[180:181], v216 offset:12288
  ds_read_b64_tr_b16 a[182:183], v216 offset:13312
  buffer_load_dwordx4 a[24:27], v248, s[20:23], s47 offen sc1
  s_waitcnt lgkmcnt(10)
  v_mfma_f32_16x16x32_bf16 v[200:203], a[176:179], a[112:115], v[200:203]
  v_mfma_f32_16x16x32_bf16 v[204:207], a[176:179], a[116:119], v[204:207]
  buffer_load_dwordx4 a[28:31], v248, s[20:23], s47 offen offset:1024 sc1
  s_waitcnt lgkmcnt(6)
  v_mfma_f32_32x32x16_bf16 v[168:183], a[136:139], v[120:123], v[168:183]
  s_add_u32 s46, s69, 0
  v_mfma_f32_32x32x16_bf16 v[184:199], a[140:143], v[120:123], v[184:199]
  buffer_load_dwordx4 a[32:35], v248, s[20:23], s46 offen sc1
  s_add_u32 s47, s53, 0x2800
  s_waitcnt lgkmcnt(2)
  v_mfma_f32_32x32x16_bf16 v[168:183], a[144:147], v[124:127], v[168:183]
  buffer_load_dwordx4 a[36:39], v248, s[20:23], s47 offen sc1
  v_mfma_f32_32x32x16_bf16 v[184:199], a[148:151], v[124:127], v[184:199]
  buffer_load_dwordx4 a[40:43], v248, s[20:23], s47 offen offset:1024 sc1
  s_add_u32 s46, s69, 0x2800
  s_waitcnt lgkmcnt(0)
  v_mfma_f32_16x16x32_bf16 v[200:203], a[180:183], a[120:123], v[200:203]
  v_mfma_f32_16x16x32_bf16 v[204:207], a[180:183], a[124:127], v[204:207]
  buffer_load_dwordx4 a[44:47], v248, s[20:23], s46 offen sc1
  s_barrier
  v_add_u32 v240, 0, v240
  v_add_u32 v241, 0, v241
  ds_read_b64_tr_b16 a[184:185], v240
  ds_read_b64_tr_b16 a[186:187], v240 offset:2048
  ds_read_b64_tr_b16 a[188:189], v241
  s_waitcnt vmcnt(13) lgkmcnt(1)
  v_mfma_f32_16x16x32_bf16 v[0:3], a[184:187], a[0:3], 0
  v_add_u32 v242, 0, v242
  ds_read_b64_tr_b16 a[190:191], v241 offset:2048
  ds_read_b64_tr_b16 a[192:193], v242
  s_waitcnt vmcnt(11)
  v_mfma_f32_16x16x32_bf16 v[28:31], a[184:187], a[4:7], 0
  v_add_u32 v243, 0, v243
  ds_read_b64_tr_b16 a[194:195], v242 offset:2048
  ds_read_b64_tr_b16 a[196:197], v243
  s_waitcnt vmcnt(9)
  v_mfma_f32_16x16x32_bf16 v[56:59], a[184:187], a[8:11], 0
  v_add_u32 v244, 0, v244
  ds_read_b64_tr_b16 a[198:199], v243 offset:2048
  ds_read_b64_tr_b16 a[200:201], v244
  s_add_u32 m0, s33, 0xc000
  s_waitcnt lgkmcnt(5)
  v_mfma_f32_16x16x32_bf16 v[4:7], a[188:191], a[0:3], 0
  v_add_u32 v245, 0, v245
  ds_read_b64_tr_b16 a[202:203], v244 offset:2048
  ds_read_b64_tr_b16 a[204:205], v245
  v_mul_f32 v168, v168, v219
  v_mfma_f32_16x16x32_bf16 v[32:35], a[188:191], a[4:7], 0
  ds_read_b64_tr_b16 a[206:207], v245 offset:2048
  s_add_u32 s47, s54, 0
  v_mfma_f32_16x16x32_bf16 v[60:63], a[188:191], a[8:11], 0
  v_add_u32 v246, 0, v246
  ds_read_b64_tr_b16 a[208:209], v246
  s_add_u32 s75, s62, 0x1c000
  v_mul_f32 v169, v169, v219
  s_waitcnt lgkmcnt(5)
  v_mfma_f32_16x16x32_bf16 v[8:11], a[192:195], a[0:3], 0
  ds_read_b64_tr_b16 a[210:211], v246 offset:2048
  buffer_load_dwordx4 a[48:51], v248, s[20:23], s47 offen sc1
  v_mfma_f32_16x16x32_bf16 v[36:39], a[192:195], a[4:7], 0
  ds_read_b64_tr_b16 a[212:213], v240 offset:8192
  buffer_load_dwordx4 v222, s[16:19], s75 offen lds
  v_mul_f32 v170, v170, v219
  v_mfma_f32_16x16x32_bf16 v[64:67], a[192:195], a[8:11], 0
  ds_read_b64_tr_b16 a[214:215], v240 offset:10240
  s_add_u32 s74, s62, 0x1ca00
  v_mfma_f32_16x16x32_bf16 v[12:15], a[196:199], a[0:3], 0
  buffer_load_dwordx4 v223, s[16:19], s74 offen offset:1024 lds
  v_mul_f32 v171, v171, v219
  v_mul_f32 v172, v172, v219
  v_mfma_f32_16x16x32_bf16 v[40:43], a[196:199], a[4:7], 0
  ds_read_b64_tr_b16 a[216:217], v241 offset:8192
  s_add_u32 s75, s62, 0x1d400
  buffer_load_dwordx4 a[52:55], v248, s[20:23], s47 offen offset:1024 sc1
  v_mul_f32 v173, v173, v219
  s_waitcnt lgkmcnt(5)
  v_mfma_f32_16x16x32_bf16 v[68:71], a[196:199], a[8:11], 0
  ds_read_b64_tr_b16 a[218:219], v241 offset:10240
  buffer_load_dwordx4 v222, s[16:19], s75 offen offset:2048 lds
  v_mfma_f32_16x16x32_bf16 v[16:19], a[200:203], a[0:3], 0
  s_add_u32 s74, s62, 0x1de00
  v_mul_f32 v174, v174, v219
  v_mul_f32 v175, v175, v219
  v_mfma_f32_16x16x32_bf16 v[44:47], a[200:203], a[4:7], 0
  ds_read_b64_tr_b16 a[220:221], v242 offset:8192
  buffer_load_dwordx4 v223, s[16:19], s74 offen offset:3072 lds
  v_cvt_pk_bf16_f32 v224, v168, v169
  v_mfma_f32_16x16x32_bf16 v[20:23], a[204:207], a[0:3], 0
  ds_read_b64_tr_b16 a[222:223], v242 offset:10240
  s_add_u32 s46, s70, 0
  v_mfma_f32_16x16x32_bf16 v[48:51], a[204:207], a[4:7], 0
  buffer_load_dwordx4 a[56:59], v248, s[20:23], s46 offen sc1
  v_cvt_pk_bf16_f32 v225, v170, v171
  v_cvt_pk_bf16_f32 v226, v172, v173
  s_waitcnt vmcnt(13) lgkmcnt(4)
  v_mfma_f32_16x16x32_bf16 v[24:27], a[208:211], a[0:3], 0
  ds_read_b64_tr_b16 a[224:225], v243 offset:8192
  v_cvt_pk_bf16_f32 v227, v174, v175
  s_add_u32 s77, s78, 0xf000
  buffer_store_dwordx4 v[224:227], v217, s[20:23], s77 offen sc1
  v_mfma_f32_16x16x32_bf16 v[52:55], a[208:211], a[4:7], 0
  ds_read_b64_tr_b16 a[226:227], v243 offset:10240
  v_mul_f32 v176, v176, v219
  v_mul_f32 v177, v177, v219
  v_mfma_f32_16x16x32_bf16 v[0:3], a[212:215], a[12:15], v[0:3]
  v_mul_f32 v178, v178, v219
  v_mul_f32 v179, v179, v219
  v_mul_f32 v180, v180, v219
  v_mul_f32 v181, v181, v219
  v_mfma_f32_16x16x32_bf16 v[28:31], a[212:215], a[16:19], v[28:31]
  ds_read_b64_tr_b16 a[228:229], v244 offset:8192
  v_mul_f32 v182, v182, v219
  v_mul_f32 v183, v183, v219
  v_mfma_f32_16x16x32_bf16 v[56:59], a[212:215], a[20:23], v[56:59]
  ds_read_b64_tr_b16 a[230:231], v244 offset:10240
  s_add_u32 s47, s54, 0x2800
  s_waitcnt lgkmcnt(4)
  v_mfma_f32_16x16x32_bf16 v[4:7], a[216:219], a[12:15], v[4:7]
  ds_read_b64_tr_b16 a[232:233], v245 offset:8192
  v_cvt_pk_bf16_f32 v228, v176, v177
  v_cvt_pk_bf16_f32 v229, v178, v179
  v_cvt_pk_bf16_f32 v230, v180, v181
  v_mfma_f32_16x16x32_bf16 v[32:35], a[216:219], a[16:19], v[32:35]
  ds_read_b64_tr_b16 a[234:235], v245 offset:10240
  v_cvt_pk_bf16_f32 v231, v182, v183
  s_add_u32 s76, s78, 0xf000
  v_mfma_f32_16x16x32_bf16 v[60:63], a[216:219], a[20:23], v[60:63]
  ds_read_b64_tr_b16 a[236:237], v246 offset:8192
  buffer_load_dwordx4 a[60:63], v248, s[20:23], s47 offen sc1
  v_mfma_f32_16x16x32_bf16 v[8:11], a[220:223], a[12:15], v[8:11]
  ds_read_b64_tr_b16 a[238:239], v246 offset:10240
  buffer_store_dwordx4 v[228:231], v217, s[20:23], s76 offen offset:512 sc1
  v_mul_f32 v184, v184, v219
  v_mfma_f32_16x16x32_bf16 v[36:39], a[220:223], a[16:19], v[36:39]
  buffer_load_dwordx4 a[64:67], v248, s[20:23], s47 offen offset:1024 sc1
  v_mul_f32 v185, v185, v219
  v_mul_f32 v186, v186, v219
  s_waitcnt lgkmcnt(4)
  v_mfma_f32_16x16x32_bf16 v[64:67], a[220:223], a[20:23], v[64:67]
  s_barrier
  v_add_u32 v240, 0x14000, v240
  ds_read_b64_tr_b16 a[184:185], v240
  v_mul_f32 v187, v187, v219
  v_mfma_f32_16x16x32_bf16 v[12:15], a[224:227], a[12:15], v[12:15]
  ds_read_b64_tr_b16 a[186:187], v240 offset:2048
  v_mul_f32 v188, v188, v219
  v_mul_f32 v189, v189, v219
  v_mfma_f32_16x16x32_bf16 v[40:43], a[224:227], a[16:19], v[40:43]
  v_add_u32 v241, 0x14000, v241
  ds_read_b64_tr_b16 a[188:189], v241
  v_mfma_f32_16x16x32_bf16 v[68:71], a[224:227], a[20:23], v[68:71]
  ds_read_b64_tr_b16 a[190:191], v241 offset:2048
  v_mul_f32 v190, v190, v219
  v_mul_f32 v191, v191, v219
  v_cvt_pk_bf16_f32 v232, v184, v185
  v_mfma_f32_16x16x32_bf16 v[16:19], a[228:231], a[12:15], v[16:19]
  s_add_u32 s46, s70, 0x2800
  v_cvt_pk_bf16_f32 v233, v186, v187
  v_cvt_pk_bf16_f32 v234, v188, v189
  s_waitcnt lgkmcnt(4)
  v_mfma_f32_16x16x32_bf16 v[44:47], a[228:231], a[16:19], v[44:47]
  v_add_u32 v242, 0x14000, v242
  ds_read_b64_tr_b16 a[192:193], v242
  v_mfma_f32_16x16x32_bf16 v[20:23], a[232:235], a[12:15], v[20:23]
  ds_read_b64_tr_b16 a[194:195], v242 offset:2048
  v_cvt_pk_bf16_f32 v235, v190, v191
  s_add_u32 s77, s78, 0x11800
  v_mfma_f32_16x16x32_bf16 v[48:51], a[232:235], a[16:19], v[48:51]
  buffer_load_dwordx4 a[68:71], v248, s[20:23], s46 offen sc1
  buffer_store_dwordx4 v[232:235], v217, s[20:23], s77 offen sc1
  v_mul_f32 v192, v192, v219
  v_mfma_f32_16x16x32_bf16 v[24:27], a[236:239], a[12:15], v[24:27]
  v_add_u32 v243, 0x14000, v243
  ds_read_b64_tr_b16 a[196:197], v243
  v_mul_f32 v193, v193, v219
  v_mfma_f32_16x16x32_bf16 v[52:55], a[236:239], a[16:19], v[52:55]
  ds_read_b64_tr_b16 a[198:199], v243 offset:2048
  v_mul_f32 v194, v194, v219
  v_mul_f32 v195, v195, v219
  s_waitcnt vmcnt(16) lgkmcnt(4)
  v_mfma_f32_16x16x32_bf16 v[0:3], a[184:187], a[24:27], v[0:3]
  v_mul_f32 v196, v196, v219
  v_mul_f32 v197, v197, v219
  v_mul_f32 v198, v198, v219
  v_mul_f32 v199, v199, v219
  v_mfma_f32_16x16x32_bf16 v[28:31], a[184:187], a[28:31], v[28:31]
  v_add_u32 v244, 0x14000, v244
  ds_read_b64_tr_b16 a[200:201], v244
  v_cvt_pk_bf16_f32 v224, v192, v193
  v_mfma_f32_16x16x32_bf16 v[56:59], a[184:187], a[32:35], v[56:59]
  ds_read_b64_tr_b16 a[202:203], v244 offset:2048
  v_cvt_pk_bf16_f32 v225, v194, v195
  v_cvt_pk_bf16_f32 v226, v196, v197
  v_mfma_f32_16x16x32_bf16 v[4:7], a[188:191], a[24:27], v[4:7]
  v_add_u32 v245, 0x14000, v245
  ds_read_b64_tr_b16 a[204:205], v245
  v_mfma_f32_16x16x32_bf16 v[32:35], a[188:191], a[28:31], v[32:35]
  ds_read_b64_tr_b16 a[206:207], v245 offset:2048
  s_add_u32 s47, s55, 0
  v_cvt_pk_bf16_f32 v227, v198, v199
  s_waitcnt lgkmcnt(4)
  v_mfma_f32_16x16x32_bf16 v[60:63], a[188:191], a[32:35], v[60:63]
  v_add_u32 v246, 0x14000, v246
  ds_read_b64_tr_b16 a[208:209], v246
  v_mfma_f32_16x16x32_bf16 v[8:11], a[192:195], a[24:27], v[8:11]
  ds_read_b64_tr_b16 a[210:211], v246 offset:2048
  s_add_u32 s76, s78, 0x11800
  buffer_store_dwordx4 v[224:227], v217, s[20:23], s76 offen offset:512 sc1
  v_mfma_f32_16x16x32_bf16 v[36:39], a[192:195], a[28:31], v[36:39]
  ds_read_b64_tr_b16 a[212:213], v240 offset:8192
  buffer_load_dwordx4 a[72:75], v248, s[20:23], s47 offen sc1
  v_mul_f32 v200, v200, v220
  v_mfma_f32_16x16x32_bf16 v[64:67], a[192:195], a[32:35], v[64:67]
  ds_read_b64_tr_b16 a[214:215], v240 offset:10240
  v_mul_f32 v201, v201, v220
  v_mul_f32 v202, v202, v220
  v_mfma_f32_16x16x32_bf16 v[12:15], a[196:199], a[24:27], v[12:15]
  v_mul_f32 v203, v203, v220
  v_cvt_pk_bf16_f32 v236, v200, v201
  v_cvt_pk_bf16_f32 v237, v202, v203
  s_add_u32 s77, s79, 0xf000
  s_waitcnt lgkmcnt(4)
  v_mfma_f32_16x16x32_bf16 v[40:43], a[196:199], a[28:31], v[40:43]
  ds_read_b64_tr_b16 a[216:217], v241 offset:8192
  buffer_load_dwordx4 a[76:79], v248, s[20:23], s47 offen offset:1024 sc1
  buffer_store_dwordx2 v[236:237], v218, s[20:23], s77 offen sc1
  v_mfma_f32_16x16x32_bf16 v[68:71], a[196:199], a[32:35], v[68:71]
  ds_read_b64_tr_b16 a[218:219], v241 offset:10240
  v_mul_f32 v204, v204, v221
  v_mul_f32 v205, v205, v221
  v_mfma_f32_16x16x32_bf16 v[16:19], a[200:203], a[24:27], v[16:19]
  s_add_u32 s46, s71, 0
  v_mul_f32 v206, v206, v221
  v_mul_f32 v207, v207, v221
  v_mfma_f32_16x16x32_bf16 v[44:47], a[200:203], a[28:31], v[44:47]
  ds_read_b64_tr_b16 a[220:221], v242 offset:8192
  v_cvt_pk_bf16_f32 v238, v204, v205
  v_cvt_pk_bf16_f32 v239, v206, v207
  v_mfma_f32_16x16x32_bf16 v[20:23], a[204:207], a[24:27], v[20:23]
  ds_read_b64_tr_b16 a[222:223], v242 offset:10240
  s_add_u32 s76, s79, 0xf400
  buffer_store_dwordx2 v[238:239], v218, s[20:23], s76 offen sc1
  s_waitcnt vmcnt(19) lgkmcnt(4)
  v_mfma_f32_16x16x32_bf16 v[48:51], a[204:207], a[28:31], v[48:51]
  buffer_load_dwordx4 a[80:83], v248, s[20:23], s46 offen sc1
  v_mfma_f32_16x16x32_bf16 v[24:27], a[208:211], a[24:27], v[24:27]
  ds_read_b64_tr_b16 a[224:225], v243 offset:8192
  v_mfma_f32_16x16x32_bf16 v[52:55], a[208:211], a[28:31], v[52:55]
  ds_read_b64_tr_b16 a[226:227], v243 offset:10240
  v_mfma_f32_16x16x32_bf16 v[0:3], a[212:215], a[36:39], v[0:3]
  v_mfma_f32_16x16x32_bf16 v[28:31], a[212:215], a[40:43], v[28:31]
  ds_read_b64_tr_b16 a[228:229], v244 offset:8192
  s_waitcnt vmcnt(19) lgkmcnt(3)
  v_mfma_f32_16x16x32_bf16 v[56:59], a[212:215], a[44:47], v[56:59]
  ds_read_b64_tr_b16 a[230:231], v244 offset:10240
  s_add_u32 s47, s55, 0x2800
  v_mfma_f32_16x16x32_bf16 v[4:7], a[216:219], a[36:39], v[4:7]
  ds_read_b64_tr_b16 a[232:233], v245 offset:8192
  v_mfma_f32_16x16x32_bf16 v[32:35], a[216:219], a[40:43], v[32:35]
  ds_read_b64_tr_b16 a[234:235], v245 offset:10240
  buffer_load_dwordx4 a[84:87], v248, s[20:23], s47 offen sc1
  v_mfma_f32_16x16x32_bf16 v[60:63], a[216:219], a[44:47], v[60:63]
  ds_read_b64_tr_b16 a[236:237], v246 offset:8192
  v_mfma_f32_16x16x32_bf16 v[8:11], a[220:223], a[36:39], v[8:11]
  ds_read_b64_tr_b16 a[238:239], v246 offset:10240
  buffer_load_dwordx4 a[88:91], v248, s[20:23], s47 offen offset:1024 sc1
  s_waitcnt lgkmcnt(6)
  v_mfma_f32_16x16x32_bf16 v[36:39], a[220:223], a[40:43], v[36:39]
  v_mfma_f32_16x16x32_bf16 v[64:67], a[220:223], a[44:47], v[64:67]
  s_barrier
  v_add_u32 v240, 0xc000, v240
  ds_read_b64_tr_b16 a[184:185], v240
  s_add_u32 s46, s71, 0x2800
  v_mfma_f32_16x16x32_bf16 v[12:15], a[224:227], a[36:39], v[12:15]
  ds_read_b64_tr_b16 a[186:187], v240 offset:2048
  s_add_u32 m0, s33, 0x10000
  v_mfma_f32_16x16x32_bf16 v[40:43], a[224:227], a[40:43], v[40:43]
  v_add_u32 v241, 0xc000, v241
  ds_read_b64_tr_b16 a[188:189], v241
  v_mfma_f32_16x16x32_bf16 v[68:71], a[224:227], a[44:47], v[68:71]
  ds_read_b64_tr_b16 a[190:191], v241 offset:2048
  s_add_u32 s75, s63, 0x1c000
  s_waitcnt lgkmcnt(4)
  v_mfma_f32_16x16x32_bf16 v[16:19], a[228:231], a[36:39], v[16:19]
  buffer_load_dwordx4 v222, s[16:19], s75 offen lds
  v_mfma_f32_16x16x32_bf16 v[44:47], a[228:231], a[40:43], v[44:47]
  v_add_u32 v242, 0xc000, v242
  ds_read_b64_tr_b16 a[192:193], v242
  v_mfma_f32_16x16x32_bf16 v[20:23], a[232:235], a[36:39], v[20:23]
  ds_read_b64_tr_b16 a[194:195], v242 offset:2048
  s_add_u32 s74, s63, 0x1ca00
  buffer_load_dwordx4 a[92:95], v248, s[20:23], s46 offen sc1
  v_mfma_f32_16x16x32_bf16 v[48:51], a[232:235], a[40:43], v[48:51]
  buffer_load_dwordx4 v223, s[16:19], s74 offen offset:1024 lds
  v_mfma_f32_16x16x32_bf16 v[24:27], a[236:239], a[36:39], v[24:27]
  v_add_u32 v243, 0xc000, v243
  ds_read_b64_tr_b16 a[196:197], v243
  s_waitcnt vmcnt(17) lgkmcnt(3)
  v_mfma_f32_16x16x32_bf16 v[52:55], a[236:239], a[40:43], v[52:55]
  ds_read_b64_tr_b16 a[198:199], v243 offset:2048
  s_add_u32 s75, s63, 0x1d400
  v_mfma_f32_16x16x32_bf16 v[0:3], a[184:187], a[48:51], v[0:3]
  buffer_load_dwordx4 v222, s[16:19], s75 offen offset:2048 lds
  v_readfirstlane_b32 s44, v251
  s_nop 1
  s_and_b32 s44, s44, 0xf0f0f0f
  s_add_u32 s44, s44, 0x7d7d7d7d
  s_and_b32 s44, s44, 0x80808080
  s_cmp_eq_u32 s44, 0x80808080
  s_cbranch_scc0 concat_heads__mha_block_cached__mha_block_cached__near_ridge_kernel_spin15
concat_heads__mha_block_cached__mha_block_cached__near_ridge_kernel_go15:
  v_mfma_f32_16x16x32_bf16 v[28:31], a[184:187], a[52:55], v[28:31]
  v_add_u32 v244, 0xc000, v244
  ds_read_b64_tr_b16 a[200:201], v244
  v_mfma_f32_16x16x32_bf16 v[56:59], a[184:187], a[56:59], v[56:59]
  ds_read_b64_tr_b16 a[202:203], v244 offset:2048
  s_add_u32 s74, s63, 0x1de00
  v_mfma_f32_16x16x32_bf16 v[4:7], a[188:191], a[48:51], v[4:7]
  v_add_u32 v245, 0xc000, v245
  ds_read_b64_tr_b16 a[204:205], v245
  s_waitcnt lgkmcnt(5)
  v_mfma_f32_16x16x32_bf16 v[32:35], a[188:191], a[52:55], v[32:35]
  ds_read_b64_tr_b16 a[206:207], v245 offset:2048
  buffer_load_dwordx4 v223, s[16:19], s74 offen offset:3072 lds
  v_mfma_f32_16x16x32_bf16 v[60:63], a[188:191], a[56:59], v[60:63]
  v_add_u32 v246, 0xc000, v246
  ds_read_b64_tr_b16 a[208:209], v246
  v_mfma_f32_16x16x32_bf16 v[8:11], a[192:195], a[48:51], v[8:11]
  ds_read_b64_tr_b16 a[210:211], v246 offset:2048
  s_add_u32 s47, s52, 0x5000
  v_mfma_f32_16x16x32_bf16 v[36:39], a[192:195], a[52:55], v[36:39]
  ds_read_b64_tr_b16 a[212:213], v240 offset:8192
  v_mfma_f32_16x16x32_bf16 v[64:67], a[192:195], a[56:59], v[64:67]
  ds_read_b64_tr_b16 a[214:215], v240 offset:10240
  s_waitcnt lgkmcnt(6)
  v_mfma_f32_16x16x32_bf16 v[12:15], a[196:199], a[48:51], v[12:15]
  buffer_load_dwordx4 a[0:3], v248, s[20:23], s47 offen sc1
  v_mfma_f32_16x16x32_bf16 v[40:43], a[196:199], a[52:55], v[40:43]
  ds_read_b64_tr_b16 a[216:217], v241 offset:8192
  buffer_load_dwordx4 a[4:7], v248, s[20:23], s47 offen offset:1024 sc1
  v_mfma_f32_16x16x32_bf16 v[68:71], a[196:199], a[56:59], v[68:71]
  ds_read_b64_tr_b16 a[218:219], v241 offset:10240
  v_mfma_f32_16x16x32_bf16 v[16:19], a[200:203], a[48:51], v[16:19]
  s_add_u32 s46, s68, 0x5000
  v_mfma_f32_16x16x32_bf16 v[44:47], a[200:203], a[52:55], v[44:47]
  ds_read_b64_tr_b16 a[220:221], v242 offset:8192
  s_waitcnt vmcnt(19) lgkmcnt(3)
  v_mfma_f32_16x16x32_bf16 v[20:23], a[204:207], a[48:51], v[20:23]
  ds_read_b64_tr_b16 a[222:223], v242 offset:10240
  v_mfma_f32_16x16x32_bf16 v[48:51], a[204:207], a[52:55], v[48:51]
  buffer_load_dwordx4 a[8:11], v248, s[20:23], s46 offen sc1
  v_mfma_f32_16x16x32_bf16 v[24:27], a[208:211], a[48:51], v[24:27]
  ds_read_b64_tr_b16 a[224:225], v243 offset:8192
  v_mfma_f32_16x16x32_bf16 v[52:55], a[208:211], a[52:55], v[52:55]
  ds_read_b64_tr_b16 a[226:227], v243 offset:10240
  v_mfma_f32_16x16x32_bf16 v[0:3], a[212:215], a[60:63], v[0:3]
  s_waitcnt vmcnt(17) lgkmcnt(4)
  v_mfma_f32_16x16x32_bf16 v[28:31], a[212:215], a[64:67], v[28:31]
  ds_read_b64_tr_b16 a[228:229], v244 offset:8192
  v_mfma_f32_16x16x32_bf16 v[56:59], a[212:215], a[68:71], v[56:59]
  ds_read_b64_tr_b16 a[230:231], v244 offset:10240
  s_add_u32 s47, s52, 0x7800
  v_mfma_f32_16x16x32_bf16 v[4:7], a[216:219], a[60:63], v[4:7]
  ds_read_b64_tr_b16 a[232:233], v245 offset:8192
  v_mfma_f32_16x16x32_bf16 v[32:35], a[216:219], a[64:67], v[32:35]
  ds_read_b64_tr_b16 a[234:235], v245 offset:10240
  buffer_load_dwordx4 a[12:15], v248, s[20:23], s47 offen sc1
  v_mfma_f32_16x16x32_bf16 v[60:63], a[216:219], a[68:71], v[60:63]
  ds_read_b64_tr_b16 a[236:237], v246 offset:8192
  s_waitcnt lgkmcnt(5)
  v_mfma_f32_16x16x32_bf16 v[8:11], a[220:223], a[60:63], v[8:11]
  ds_read_b64_tr_b16 a[238:239], v246 offset:10240
  buffer_load_dwordx4 a[16:19], v248, s[20:23], s47 offen offset:1024 sc1
  v_mfma_f32_16x16x32_bf16 v[36:39], a[220:223], a[64:67], v[36:39]
  v_mfma_f32_16x16x32_bf16 v[64:67], a[220:223], a[68:71], v[64:67]
  s_waitcnt vmcnt(13)
  s_barrier
  s_cmp_eq_u32 s3, 0
  s_cbranch_scc0 concat_heads__mha_block_cached__mha_block_cached__near_ridge_kernel_sig14
  buffer_atomic_add v250, v249, s[56:59], 0 offen
concat_heads__mha_block_cached__mha_block_cached__near_ridge_kernel_sig14:
  v_add_u32 v240, 0x4000, v240
  ds_read_b64_tr_b16 a[184:185], v240
  s_add_u32 s46, s68, 0x7800
  v_mfma_f32_16x16x32_bf16 v[12:15], a[224:227], a[60:63], v[12:15]
  ds_read_b64_tr_b16 a[186:187], v240 offset:2048
  s_add_u32 m0, s33, 0
  v_mfma_f32_16x16x32_bf16 v[40:43], a[224:227], a[64:67], v[40:43]
  v_add_u32 v241, 0x4000, v241
  ds_read_b64_tr_b16 a[188:189], v241
  s_waitcnt lgkmcnt(5)
  v_mfma_f32_16x16x32_bf16 v[68:71], a[224:227], a[68:71], v[68:71]
  ds_read_b64_tr_b16 a[190:191], v241 offset:2048
  s_add_u32 s75, s73, 0x1c000
  v_mfma_f32_16x16x32_bf16 v[16:19], a[228:231], a[60:63], v[16:19]
  buffer_load_dwordx4 v222, s[16:19], s75 offen lds
  v_mfma_f32_16x16x32_bf16 v[44:47], a[228:231], a[64:67], v[44:47]
  v_add_u32 v242, 0x4000, v242
  ds_read_b64_tr_b16 a[192:193], v242
  v_mfma_f32_16x16x32_bf16 v[20:23], a[232:235], a[60:63], v[20:23]
  ds_read_b64_tr_b16 a[194:195], v242 offset:2048
  s_add_u32 s74, s73, 0x1ca00
  buffer_load_dwordx4 a[20:23], v248, s[20:23], s46 offen sc1
  v_mfma_f32_16x16x32_bf16 v[48:51], a[232:235], a[64:67], v[48:51]
  buffer_load_dwordx4 v223, s[16:19], s74 offen offset:1024 lds
  s_waitcnt vmcnt(15) lgkmcnt(4)
  v_mfma_f32_16x16x32_bf16 v[24:27], a[236:239], a[60:63], v[24:27]
  v_add_u32 v243, 0x4000, v243
  ds_read_b64_tr_b16 a[196:197], v243
  v_mfma_f32_16x16x32_bf16 v[52:55], a[236:239], a[64:67], v[52:55]
  ds_read_b64_tr_b16 a[198:199], v243 offset:2048
  s_add_u32 s75, s73, 0x1d400
  v_mfma_f32_16x16x32_bf16 v[0:3], a[184:187], a[72:75], v[0:3]
  buffer_load_dwordx4 v222, s[16:19], s75 offen offset:2048 lds
  v_mfma_f32_16x16x32_bf16 v[28:31], a[184:187], a[76:79], v[28:31]
  v_add_u32 v244, 0x4000, v244
  ds_read_b64_tr_b16 a[200:201], v244
  v_mfma_f32_16x16x32_bf16 v[56:59], a[184:187], a[80:83], v[56:59]
  ds_read_b64_tr_b16 a[202:203], v244 offset:2048
  s_add_u32 s74, s73, 0x1de00
  s_waitcnt lgkmcnt(4)
  v_mfma_f32_16x16x32_bf16 v[4:7], a[188:191], a[72:75], v[4:7]
  v_add_u32 v245, 0x4000, v245
  ds_read_b64_tr_b16 a[204:205], v245
  v_mfma_f32_16x16x32_bf16 v[32:35], a[188:191], a[76:79], v[32:35]
  ds_read_b64_tr_b16 a[206:207], v245 offset:2048
  buffer_load_dwordx4 v223, s[16:19], s74 offen offset:3072 lds
  v_mfma_f32_16x16x32_bf16 v[60:63], a[188:191], a[80:83], v[60:63]
  v_add_u32 v246, 0x4000, v246
  ds_read_b64_tr_b16 a[208:209], v246
  v_mfma_f32_16x16x32_bf16 v[8:11], a[192:195], a[72:75], v[8:11]
  ds_read_b64_tr_b16 a[210:211], v246 offset:2048
  s_add_u32 s47, s53, 0x5000
  v_mfma_f32_16x16x32_bf16 v[36:39], a[192:195], a[76:79], v[36:39]
  ds_read_b64_tr_b16 a[212:213], v240 offset:8192
  s_waitcnt lgkmcnt(5)
  v_mfma_f32_16x16x32_bf16 v[64:67], a[192:195], a[80:83], v[64:67]
  ds_read_b64_tr_b16 a[214:215], v240 offset:10240
  v_mfma_f32_16x16x32_bf16 v[12:15], a[196:199], a[72:75], v[12:15]
  buffer_load_dwordx4 a[24:27], v248, s[20:23], s47 offen sc1
  v_mfma_f32_16x16x32_bf16 v[40:43], a[196:199], a[76:79], v[40:43]
  ds_read_b64_tr_b16 a[216:217], v241 offset:8192
  buffer_load_dwordx4 a[28:31], v248, s[20:23], s47 offen offset:1024 sc1
  v_mfma_f32_16x16x32_bf16 v[68:71], a[196:199], a[80:83], v[68:71]
  ds_read_b64_tr_b16 a[218:219], v241 offset:10240
  v_mfma_f32_16x16x32_bf16 v[16:19], a[200:203], a[72:75], v[16:19]
  s_add_u32 s46, s69, 0x5000
  s_waitcnt lgkmcnt(4)
  v_mfma_f32_16x16x32_bf16 v[44:47], a[200:203], a[76:79], v[44:47]
  ds_read_b64_tr_b16 a[220:221], v242 offset:8192
  v_mfma_f32_16x16x32_bf16 v[20:23], a[204:207], a[72:75], v[20:23]
  ds_read_b64_tr_b16 a[222:223], v242 offset:10240
  v_mfma_f32_16x16x32_bf16 v[48:51], a[204:207], a[76:79], v[48:51]
  buffer_load_dwordx4 a[32:35], v248, s[20:23], s46 offen sc1
  v_mfma_f32_16x16x32_bf16 v[24:27], a[208:211], a[72:75], v[24:27]
  ds_read_b64_tr_b16 a[224:225], v243 offset:8192
  v_mfma_f32_16x16x32_bf16 v[52:55], a[208:211], a[76:79], v[52:55]
  ds_read_b64_tr_b16 a[226:227], v243 offset:10240
  s_waitcnt vmcnt(16) lgkmcnt(4)
  v_mfma_f32_16x16x32_bf16 v[0:3], a[212:215], a[84:87], v[0:3]
  v_mfma_f32_16x16x32_bf16 v[28:31], a[212:215], a[88:91], v[28:31]
  ds_read_b64_tr_b16 a[228:229], v244 offset:8192
  v_mfma_f32_16x16x32_bf16 v[56:59], a[212:215], a[92:95], v[56:59]
  ds_read_b64_tr_b16 a[230:231], v244 offset:10240
  s_add_u32 s47, s53, 0x7800
  v_mfma_f32_16x16x32_bf16 v[4:7], a[216:219], a[84:87], v[4:7]
  ds_read_b64_tr_b16 a[232:233], v245 offset:8192
  v_mfma_f32_16x16x32_bf16 v[32:35], a[216:219], a[88:91], v[32:35]
  ds_read_b64_tr_b16 a[234:235], v245 offset:10240
  s_waitcnt lgkmcnt(4)
  v_mfma_f32_16x16x32_bf16 v[60:63], a[216:219], a[92:95], v[60:63]
  ds_read_b64_tr_b16 a[236:237], v246 offset:8192
  buffer_load_dwordx4 a[36:39], v248, s[20:23], s47 offen sc1
  v_mfma_f32_16x16x32_bf16 v[8:11], a[220:223], a[84:87], v[8:11]
  ds_read_b64_tr_b16 a[238:239], v246 offset:10240
  v_mfma_f32_16x16x32_bf16 v[36:39], a[220:223], a[88:91], v[36:39]
  buffer_load_dwordx4 a[40:43], v248, s[20:23], s47 offen offset:1024 sc1
  v_mfma_f32_16x16x32_bf16 v[64:67], a[220:223], a[92:95], v[64:67]
  s_barrier
  v_add_u32 v240, 0xfffe0000, v240
  ds_read_b64_tr_b16 a[184:185], v240
  v_mfma_f32_16x16x32_bf16 v[12:15], a[224:227], a[84:87], v[12:15]
  ds_read_b64_tr_b16 a[186:187], v240 offset:2048
  s_waitcnt lgkmcnt(4)
  v_mfma_f32_16x16x32_bf16 v[40:43], a[224:227], a[88:91], v[40:43]
  v_add_u32 v241, 0xfffe0000, v241
  ds_read_b64_tr_b16 a[188:189], v241
  v_mfma_f32_16x16x32_bf16 v[68:71], a[224:227], a[92:95], v[68:71]
  ds_read_b64_tr_b16 a[190:191], v241 offset:2048
  v_mfma_f32_16x16x32_bf16 v[16:19], a[228:231], a[84:87], v[16:19]
  s_add_u32 s46, s69, 0x7800
  v_mfma_f32_16x16x32_bf16 v[44:47], a[228:231], a[88:91], v[44:47]
  v_add_u32 v242, 0xfffe0000, v242
  ds_read_b64_tr_b16 a[192:193], v242
  v_mfma_f32_16x16x32_bf16 v[20:23], a[232:235], a[84:87], v[20:23]
  ds_read_b64_tr_b16 a[194:195], v242 offset:2048
  s_waitcnt vmcnt(13) lgkmcnt(4)
  v_mfma_f32_16x16x32_bf16 v[48:51], a[232:235], a[88:91], v[48:51]
  buffer_load_dwordx4 a[44:47], v248, s[20:23], s46 offen sc1
  v_mfma_f32_16x16x32_bf16 v[24:27], a[236:239], a[84:87], v[24:27]
  v_add_u32 v243, 0xfffe0000, v243
  ds_read_b64_tr_b16 a[196:197], v243
  v_mfma_f32_16x16x32_bf16 v[52:55], a[236:239], a[88:91], v[52:55]
  ds_read_b64_tr_b16 a[198:199], v243 offset:2048
  v_mfma_f32_16x16x32_bf16 v[0:3], a[184:187], a[0:3], v[0:3]
  v_mfma_f32_16x16x32_bf16 v[28:31], a[184:187], a[4:7], v[28:31]
  v_add_u32 v244, 0xfffe0000, v244
  ds_read_b64_tr_b16 a[200:201], v244
  s_waitcnt vmcnt(13) lgkmcnt(3)
  v_mfma_f32_16x16x32_bf16 v[56:59], a[184:187], a[8:11], v[56:59]
  ds_read_b64_tr_b16 a[202:203], v244 offset:2048
  v_mfma_f32_16x16x32_bf16 v[4:7], a[188:191], a[0:3], v[4:7]
  v_add_u32 v245, 0xfffe0000, v245
  ds_read_b64_tr_b16 a[204:205], v245
  v_mfma_f32_16x16x32_bf16 v[32:35], a[188:191], a[4:7], v[32:35]
  ds_read_b64_tr_b16 a[206:207], v245 offset:2048
  s_add_u32 s47, s54, 0x5000
  v_mfma_f32_16x16x32_bf16 v[60:63], a[188:191], a[8:11], v[60:63]
  v_add_u32 v246, 0xfffe0000, v246
  ds_read_b64_tr_b16 a[208:209], v246
  v_mfma_f32_16x16x32_bf16 v[8:11], a[192:195], a[0:3], v[8:11]
  ds_read_b64_tr_b16 a[210:211], v246 offset:2048
  s_waitcnt lgkmcnt(6)
  v_mfma_f32_16x16x32_bf16 v[36:39], a[192:195], a[4:7], v[36:39]
  ds_read_b64_tr_b16 a[212:213], v240 offset:8192
  buffer_load_dwordx4 a[48:51], v248, s[20:23], s47 offen sc1
  v_mfma_f32_16x16x32_bf16 v[64:67], a[192:195], a[8:11], v[64:67]
  ds_read_b64_tr_b16 a[214:215], v240 offset:10240
  v_mfma_f32_16x16x32_bf16 v[12:15], a[196:199], a[0:3], v[12:15]
  v_mfma_f32_16x16x32_bf16 v[40:43], a[196:199], a[4:7], v[40:43]
  ds_read_b64_tr_b16 a[216:217], v241 offset:8192
  buffer_load_dwordx4 a[52:55], v248, s[20:23], s47 offen offset:1024 sc1
  v_mfma_f32_16x16x32_bf16 v[68:71], a[196:199], a[8:11], v[68:71]
  ds_read_b64_tr_b16 a[218:219], v241 offset:10240
  s_waitcnt lgkmcnt(4)
  v_mfma_f32_16x16x32_bf16 v[16:19], a[200:203], a[0:3], v[16:19]
  s_add_u32 s46, s70, 0x5000
  v_mfma_f32_16x16x32_bf16 v[44:47], a[200:203], a[4:7], v[44:47]
  ds_read_b64_tr_b16 a[220:221], v242 offset:8192
  v_mfma_f32_16x16x32_bf16 v[20:23], a[204:207], a[0:3], v[20:23]
  ds_read_b64_tr_b16 a[222:223], v242 offset:10240
  v_mfma_f32_16x16x32_bf16 v[48:51], a[204:207], a[4:7], v[48:51]
  buffer_load_dwordx4 a[56:59], v248, s[20:23], s46 offen sc1
  v_mfma_f32_16x16x32_bf16 v[24:27], a[208:211], a[0:3], v[24:27]
  ds_read_b64_tr_b16 a[224:225], v243 offset:8192
  s_waitcnt vmcnt(12) lgkmcnt(3)
  v_mfma_f32_16x16x32_bf16 v[52:55], a[208:211], a[4:7], v[52:55]
  ds_read_b64_tr_b16 a[226:227], v243 offset:10240
  v_mfma_f32_16x16x32_bf16 v[0:3], a[212:215], a[12:15], v[0:3]
  v_mfma_f32_16x16x32_bf16 v[28:31], a[212:215], a[16:19], v[28:31]
  ds_read_b64_tr_b16 a[228:229], v244 offset:8192
  v_mfma_f32_16x16x32_bf16 v[56:59], a[212:215], a[20:23], v[56:59]
  ds_read_b64_tr_b16 a[230:231], v244 offset:10240
  s_add_u32 s47, s54, 0x7800
  v_mfma_f32_16x16x32_bf16 v[4:7], a[216:219], a[12:15], v[4:7]
  ds_read_b64_tr_b16 a[232:233], v245 offset:8192
  s_waitcnt lgkmcnt(5)
  v_mfma_f32_16x16x32_bf16 v[32:35], a[216:219], a[16:19], v[32:35]
  ds_read_b64_tr_b16 a[234:235], v245 offset:10240
  buffer_load_dwordx4 a[60:63], v248, s[20:23], s47 offen sc1
  v_mfma_f32_16x16x32_bf16 v[60:63], a[216:219], a[20:23], v[60:63]
  ds_read_b64_tr_b16 a[236:237], v246 offset:8192
  v_mfma_f32_16x16x32_bf16 v[8:11], a[220:223], a[12:15], v[8:11]
  ds_read_b64_tr_b16 a[238:239], v246 offset:10240
  buffer_load_dwordx4 a[64:67], v248, s[20:23], s47 offen offset:1024 sc1
  v_mfma_f32_16x16x32_bf16 v[36:39], a[220:223], a[16:19], v[36:39]
  v_mfma_f32_16x16x32_bf16 v[64:67], a[220:223], a[20:23], v[64:67]
  s_barrier
  v_add_u32 v240, 0x14000, v240
  ds_read_b64_tr_b16 a[184:185], v240
  s_add_u32 s46, s70, 0x7800
  s_waitcnt lgkmcnt(5)
  v_mfma_f32_16x16x32_bf16 v[12:15], a[224:227], a[12:15], v[12:15]
  ds_read_b64_tr_b16 a[186:187], v240 offset:2048
  s_add_u32 m0, s33, 0x14000
  v_mfma_f32_16x16x32_bf16 v[40:43], a[224:227], a[16:19], v[40:43]
  v_add_u32 v241, 0x14000, v241
  ds_read_b64_tr_b16 a[188:189], v241
  v_mfma_f32_16x16x32_bf16 v[68:71], a[224:227], a[20:23], v[68:71]
  ds_read_b64_tr_b16 a[190:191], v241 offset:2048
  s_add_u32 s75, s35, 0x1c000
  v_mfma_f32_16x16x32_bf16 v[16:19], a[228:231], a[12:15], v[16:19]
  buffer_load_dwordx4 v222, s[16:19], s75 offen lds
  v_mfma_f32_16x16x32_bf16 v[44:47], a[228:231], a[16:19], v[44:47]
  v_add_u32 v242, 0x14000, v242
  ds_read_b64_tr_b16 a[192:193], v242
  s_waitcnt vmcnt(11) lgkmcnt(3)
  v_mfma_f32_16x16x32_bf16 v[20:23], a[232:235], a[12:15], v[20:23]
  ds_read_b64_tr_b16 a[194:195], v242 offset:2048
  s_add_u32 s74, s35, 0x1ca00
  buffer_load_dwordx4 a[68:71], v248, s[20:23], s46 offen sc1
  v_mfma_f32_16x16x32_bf16 v[48:51], a[232:235], a[16:19], v[48:51]
  buffer_load_dwordx4 v223, s[16:19], s74 offen offset:1024 lds
  v_mfma_f32_16x16x32_bf16 v[24:27], a[236:239], a[12:15], v[24:27]
  v_add_u32 v243, 0x14000, v243
  ds_read_b64_tr_b16 a[196:197], v243
  v_mfma_f32_16x16x32_bf16 v[52:55], a[236:239], a[16:19], v[52:55]
  ds_read_b64_tr_b16 a[198:199], v243 offset:2048
  s_add_u32 s75, s35, 0x1d400
  v_mfma_f32_16x16x32_bf16 v[0:3], a[184:187], a[24:27], v[0:3]
  buffer_load_dwordx4 v222, s[16:19], s75 offen offset:2048 lds
  s_waitcnt vmcnt(12) lgkmcnt(4)
  v_mfma_f32_16x16x32_bf16 v[28:31], a[184:187], a[28:31], v[28:31]
  v_add_u32 v244, 0x14000, v244
  ds_read_b64_tr_b16 a[200:201], v244
  v_mfma_f32_16x16x32_bf16 v[56:59], a[184:187], a[32:35], v[56:59]
  ds_read_b64_tr_b16 a[202:203], v244 offset:2048
  s_add_u32 s74, s35, 0x1de00
  v_mfma_f32_16x16x32_bf16 v[4:7], a[188:191], a[24:27], v[4:7]
  v_add_u32 v245, 0x14000, v245
  ds_read_b64_tr_b16 a[204:205], v245
  v_mfma_f32_16x16x32_bf16 v[32:35], a[188:191], a[28:31], v[32:35]
  ds_read_b64_tr_b16 a[206:207], v245 offset:2048
  buffer_load_dwordx4 v223, s[16:19], s74 offen offset:3072 lds
  v_mfma_f32_16x16x32_bf16 v[60:63], a[188:191], a[32:35], v[60:63]
  v_add_u32 v246, 0x14000, v246
  ds_read_b64_tr_b16 a[208:209], v246
  s_waitcnt lgkmcnt(5)
  v_mfma_f32_16x16x32_bf16 v[8:11], a[192:195], a[24:27], v[8:11]
  ds_read_b64_tr_b16 a[210:211], v246 offset:2048
  s_add_u32 s47, s55, 0x5000
  v_mfma_f32_16x16x32_bf16 v[36:39], a[192:195], a[28:31], v[36:39]
  ds_read_b64_tr_b16 a[212:213], v240 offset:8192
  v_mfma_f32_16x16x32_bf16 v[64:67], a[192:195], a[32:35], v[64:67]
  ds_read_b64_tr_b16 a[214:215], v240 offset:10240
  v_mfma_f32_16x16x32_bf16 v[12:15], a[196:199], a[24:27], v[12:15]
  buffer_load_dwordx4 a[72:75], v248, s[20:23], s47 offen sc1
  v_mfma_f32_16x16x32_bf16 v[40:43], a[196:199], a[28:31], v[40:43]
  ds_read_b64_tr_b16 a[216:217], v241 offset:8192
  buffer_load_dwordx4 a[76:79], v248, s[20:23], s47 offen offset:1024 sc1
  s_waitcnt lgkmcnt(5)
  v_mfma_f32_16x16x32_bf16 v[68:71], a[196:199], a[32:35], v[68:71]
  ds_read_b64_tr_b16 a[218:219], v241 offset:10240
  v_mfma_f32_16x16x32_bf16 v[16:19], a[200:203], a[24:27], v[16:19]
  s_add_u32 s46, s71, 0x5000
  v_mfma_f32_16x16x32_bf16 v[44:47], a[200:203], a[28:31], v[44:47]
  ds_read_b64_tr_b16 a[220:221], v242 offset:8192
  v_mfma_f32_16x16x32_bf16 v[20:23], a[204:207], a[24:27], v[20:23]
  ds_read_b64_tr_b16 a[222:223], v242 offset:10240
  v_mfma_f32_16x16x32_bf16 v[48:51], a[204:207], a[28:31], v[48:51]
  buffer_load_dwordx4 a[80:83], v248, s[20:23], s46 offen sc1
  s_waitcnt vmcnt(13) lgkmcnt(4)
  v_mfma_f32_16x16x32_bf16 v[24:27], a[208:211], a[24:27], v[24:27]
  ds_read_b64_tr_b16 a[224:225], v243 offset:8192
  v_mfma_f32_16x16x32_bf16 v[52:55], a[208:211], a[28:31], v[52:55]
  ds_read_b64_tr_b16 a[226:227], v243 offset:10240
  v_mfma_f32_16x16x32_bf16 v[0:3], a[212:215], a[36:39], v[0:3]
  v_mfma_f32_16x16x32_bf16 v[28:31], a[212:215], a[40:43], v[28:31]
  ds_read_b64_tr_b16 a[228:229], v244 offset:8192
  v_mfma_f32_16x16x32_bf16 v[56:59], a[212:215], a[44:47], v[56:59]
  ds_read_b64_tr_b16 a[230:231], v244 offset:10240
  s_add_u32 s47, s55, 0x7800
  s_waitcnt lgkmcnt(4)
  v_mfma_f32_16x16x32_bf16 v[4:7], a[216:219], a[36:39], v[4:7]
  ds_read_b64_tr_b16 a[232:233], v245 offset:8192
  v_mfma_f32_16x16x32_bf16 v[32:35], a[216:219], a[40:43], v[32:35]
  ds_read_b64_tr_b16 a[234:235], v245 offset:10240
  buffer_load_dwordx4 a[84:87], v248, s[20:23], s47 offen sc1
  v_mfma_f32_16x16x32_bf16 v[60:63], a[216:219], a[44:47], v[60:63]
  ds_read_b64_tr_b16 a[236:237], v246 offset:8192
  v_mfma_f32_16x16x32_bf16 v[8:11], a[220:223], a[36:39], v[8:11]
  ds_read_b64_tr_b16 a[238:239], v246 offset:10240
  buffer_load_dwordx4 a[88:91], v248, s[20:23], s47 offen offset:1024 sc1
  v_mfma_f32_16x16x32_bf16 v[36:39], a[220:223], a[40:43], v[36:39]
  s_waitcnt lgkmcnt(4)
  v_mfma_f32_16x16x32_bf16 v[64:67], a[220:223], a[44:47], v[64:67]
  s_barrier
  v_add_u32 v240, 0x4000, v240
  ds_read_b64_tr_b16 a[184:185], v240
  s_add_u32 s46, s71, 0x7800
  v_mfma_f32_16x16x32_bf16 v[12:15], a[224:227], a[36:39], v[12:15]
  ds_read_b64_tr_b16 a[186:187], v240 offset:2048
  s_add_u32 m0, s33, 0x20000
  v_mfma_f32_16x16x32_bf16 v[40:43], a[224:227], a[40:43], v[40:43]
  v_add_u32 v241, 0x4000, v241
  ds_read_b64_tr_b16 a[188:189], v241
  v_mfma_f32_16x16x32_bf16 v[68:71], a[224:227], a[44:47], v[68:71]
  ds_read_b64_tr_b16 a[190:191], v241 offset:2048
  s_add_u32 s75, s62, 0x2a000
  v_mfma_f32_16x16x32_bf16 v[16:19], a[228:231], a[36:39], v[16:19]
  buffer_load_dwordx4 v222, s[16:19], s75 offen lds
  s_waitcnt lgkmcnt(4)
  v_mfma_f32_16x16x32_bf16 v[44:47], a[228:231], a[40:43], v[44:47]
  v_add_u32 v242, 0x4000, v242
  ds_read_b64_tr_b16 a[192:193], v242
  v_mfma_f32_16x16x32_bf16 v[20:23], a[232:235], a[36:39], v[20:23]
  ds_read_b64_tr_b16 a[194:195], v242 offset:2048
  s_add_u32 s74, s62, 0x2aa00
  buffer_load_dwordx4 a[92:95], v248, s[20:23], s46 offen sc1
  v_mfma_f32_16x16x32_bf16 v[48:51], a[232:235], a[40:43], v[48:51]
  buffer_load_dwordx4 v223, s[16:19], s74 offen offset:1024 lds
  v_mfma_f32_16x16x32_bf16 v[24:27], a[236:239], a[36:39], v[24:27]
  v_add_u32 v243, 0x4000, v243
  ds_read_b64_tr_b16 a[196:197], v243
  v_mfma_f32_16x16x32_bf16 v[52:55], a[236:239], a[40:43], v[52:55]
  ds_read_b64_tr_b16 a[198:199], v243 offset:2048
  s_add_u32 s75, s62, 0x2b400
  s_waitcnt vmcnt(15) lgkmcnt(4)
  v_mfma_f32_16x16x32_bf16 v[0:3], a[184:187], a[48:51], v[0:3]
  buffer_load_dwordx4 v222, s[16:19], s75 offen offset:2048 lds
  buffer_load_dword v251, v249, s[56:59], 0 offen sc1
  v_mfma_f32_16x16x32_bf16 v[28:31], a[184:187], a[52:55], v[28:31]
  v_add_u32 v244, 0x4000, v244
  ds_read_b64_tr_b16 a[200:201], v244
  v_mfma_f32_16x16x32_bf16 v[56:59], a[184:187], a[56:59], v[56:59]
  ds_read_b64_tr_b16 a[202:203], v244 offset:2048
  s_add_u32 s74, s62, 0x2be00
  v_mfma_f32_16x16x32_bf16 v[4:7], a[188:191], a[48:51], v[4:7]
  v_add_u32 v245, 0x4000, v245
  ds_read_b64_tr_b16 a[204:205], v245
  v_mfma_f32_16x16x32_bf16 v[32:35], a[188:191], a[52:55], v[32:35]
  ds_read_b64_tr_b16 a[206:207], v245 offset:2048
  buffer_load_dwordx4 v223, s[16:19], s74 offen offset:3072 lds
  s_waitcnt lgkmcnt(4)
  v_mfma_f32_16x16x32_bf16 v[60:63], a[188:191], a[56:59], v[60:63]
  v_add_u32 v246, 0x4000, v246
  ds_read_b64_tr_b16 a[208:209], v246
  v_mfma_f32_16x16x32_bf16 v[8:11], a[192:195], a[48:51], v[8:11]
  ds_read_b64_tr_b16 a[210:211], v246 offset:2048
  s_add_u32 s47, s52, 0xa000
  v_mfma_f32_16x16x32_bf16 v[36:39], a[192:195], a[52:55], v[36:39]
  ds_read_b64_tr_b16 a[212:213], v240 offset:8192
  v_mfma_f32_16x16x32_bf16 v[64:67], a[192:195], a[56:59], v[64:67]
  ds_read_b64_tr_b16 a[214:215], v240 offset:10240
  v_mfma_f32_16x16x32_bf16 v[12:15], a[196:199], a[48:51], v[12:15]
  buffer_load_dwordx4 a[0:3], v248, s[20:23], s47 offen sc1
  s_waitcnt lgkmcnt(4)
  v_mfma_f32_16x16x32_bf16 v[40:43], a[196:199], a[52:55], v[40:43]
  ds_read_b64_tr_b16 a[216:217], v241 offset:8192
  buffer_load_dwordx4 a[4:7], v248, s[20:23], s47 offen offset:1024 sc1
  v_mfma_f32_16x16x32_bf16 v[68:71], a[196:199], a[56:59], v[68:71]
  ds_read_b64_tr_b16 a[218:219], v241 offset:10240
  v_mfma_f32_16x16x32_bf16 v[16:19], a[200:203], a[48:51], v[16:19]
  s_add_u32 s46, s68, 0xa000
  v_mfma_f32_16x16x32_bf16 v[44:47], a[200:203], a[52:55], v[44:47]
  ds_read_b64_tr_b16 a[220:221], v242 offset:8192
  v_mfma_f32_16x16x32_bf16 v[20:23], a[204:207], a[48:51], v[20:23]
  ds_read_b64_tr_b16 a[222:223], v242 offset:10240
  s_waitcnt vmcnt(18) lgkmcnt(4)
  v_mfma_f32_16x16x32_bf16 v[48:51], a[204:207], a[52:55], v[48:51]
  buffer_load_dwordx4 a[8:11], v248, s[20:23], s46 offen sc1
  v_mfma_f32_16x16x32_bf16 v[24:27], a[208:211], a[48:51], v[24:27]
  ds_read_b64_tr_b16 a[224:225], v243 offset:8192
  v_mfma_f32_16x16x32_bf16 v[52:55], a[208:211], a[52:55], v[52:55]
  ds_read_b64_tr_b16 a[226:227], v243 offset:10240
  v_mfma_f32_16x16x32_bf16 v[0:3], a[212:215], a[60:63], v[0:3]
  v_mfma_f32_16x16x32_bf16 v[28:31], a[212:215], a[64:67], v[28:31]
  ds_read_b64_tr_b16 a[228:229], v244 offset:8192
  s_waitcnt vmcnt(17) lgkmcnt(3)
  v_mfma_f32_16x16x32_bf16 v[56:59], a[212:215], a[68:71], v[56:59]
  ds_read_b64_tr_b16 a[230:231], v244 offset:10240
  s_add_u32 s47, s52, 0xc800
  v_mfma_f32_16x16x32_bf16 v[4:7], a[216:219], a[60:63], v[4:7]
  ds_read_b64_tr_b16 a[232:233], v245 offset:8192
  v_mfma_f32_16x16x32_bf16 v[32:35], a[216:219], a[64:67], v[32:35]
  ds_read_b64_tr_b16 a[234:235], v245 offset:10240
  v_mfma_f32_16x16x32_bf16 v[60:63], a[216:219], a[68:71], v[60:63]
  ds_read_b64_tr_b16 a[236:237], v246 offset:8192
  buffer_load_dwordx4 a[12:15], v248, s[20:23], s47 offen sc1
  v_mfma_f32_16x16x32_bf16 v[8:11], a[220:223], a[60:63], v[8:11]
  ds_read_b64_tr_b16 a[238:239], v246 offset:10240
  s_waitcnt lgkmcnt(6)
  v_mfma_f32_16x16x32_bf16 v[36:39], a[220:223], a[64:67], v[36:39]
  buffer_load_dwordx4 a[16:19], v248, s[20:23], s47 offen offset:1024 sc1
  v_mfma_f32_16x16x32_bf16 v[64:67], a[220:223], a[68:71], v[64:67]
  s_barrier
  v_add_u32 v240, 0xfffec000, v240
  ds_read_b64_tr_b16 a[184:185], v240
  v_mfma_f32_16x16x32_bf16 v[12:15], a[224:227], a[60:63], v[12:15]
  ds_read_b64_tr_b16 a[186:187], v240 offset:2048
  v_mfma_f32_16x16x32_bf16 v[40:43], a[224:227], a[64:67], v[40:43]
  v_add_u32 v241, 0xfffec000, v241
  ds_read_b64_tr_b16 a[188:189], v241
  v_mfma_f32_16x16x32_bf16 v[68:71], a[224:227], a[68:71], v[68:71]
  ds_read_b64_tr_b16 a[190:191], v241 offset:2048
  s_waitcnt lgkmcnt(4)
  v_mfma_f32_16x16x32_bf16 v[16:19], a[228:231], a[60:63], v[16:19]
  s_add_u32 s46, s68, 0xc800
  v_mfma_f32_16x16x32_bf16 v[44:47], a[228:231], a[64:67], v[44:47]
  v_add_u32 v242, 0xfffec000, v242
  ds_read_b64_tr_b16 a[192:193], v242
  v_mfma_f32_16x16x32_bf16 v[20:23], a[232:235], a[60:63], v[20:23]
  ds_read_b64_tr_b16 a[194:195], v242 offset:2048
  v_mfma_f32_16x16x32_bf16 v[48:51], a[232:235], a[64:67], v[48:51]
  buffer_load_dwordx4 a[20:23], v248, s[20:23], s46 offen sc1
  v_mfma_f32_16x16x32_bf16 v[24:27], a[236:239], a[60:63], v[24:27]
  v_add_u32 v243, 0xfffec000, v243
  ds_read_b64_tr_b16 a[196:197], v243
  s_waitcnt vmcnt(14) lgkmcnt(3)
  v_mfma_f32_16x16x32_bf16 v[52:55], a[236:239], a[64:67], v[52:55]
  ds_read_b64_tr_b16 a[198:199], v243 offset:2048
  v_mfma_f32_16x16x32_bf16 v[0:3], a[184:187], a[72:75], v[0:3]
  v_mfma_f32_16x16x32_bf16 v[28:31], a[184:187], a[76:79], v[28:31]
  v_add_u32 v244, 0xfffec000, v244
  ds_read_b64_tr_b16 a[200:201], v244
  v_mfma_f32_16x16x32_bf16 v[56:59], a[184:187], a[80:83], v[56:59]
  ds_read_b64_tr_b16 a[202:203], v244 offset:2048
  v_mfma_f32_16x16x32_bf16 v[4:7], a[188:191], a[72:75], v[4:7]
  v_add_u32 v245, 0xfffec000, v245
  ds_read_b64_tr_b16 a[204:205], v245
  s_waitcnt lgkmcnt(5)
  v_mfma_f32_16x16x32_bf16 v[32:35], a[188:191], a[76:79], v[32:35]
  ds_read_b64_tr_b16 a[206:207], v245 offset:2048
  s_add_u32 s47, s53, 0xa000
  v_mfma_f32_16x16x32_bf16 v[60:63], a[188:191], a[80:83], v[60:63]
  v_add_u32 v246, 0xfffec000, v246
  ds_read_b64_tr_b16 a[208:209], v246
  v_mfma_f32_16x16x32_bf16 v[8:11], a[192:195], a[72:75], v[8:11]
  ds_read_b64_tr_b16 a[210:211], v246 offset:2048
  v_mfma_f32_16x16x32_bf16 v[36:39], a[192:195], a[76:79], v[36:39]
  ds_read_b64_tr_b16 a[212:213], v240 offset:8192
  buffer_load_dwordx4 a[24:27], v248, s[20:23], s47 offen sc1
  v_mfma_f32_16x16x32_bf16 v[64:67], a[192:195], a[80:83], v[64:67]
  ds_read_b64_tr_b16 a[214:215], v240 offset:10240
  s_waitcnt lgkmcnt(6)
  v_mfma_f32_16x16x32_bf16 v[12:15], a[196:199], a[72:75], v[12:15]
  v_mfma_f32_16x16x32_bf16 v[40:43], a[196:199], a[76:79], v[40:43]
  ds_read_b64_tr_b16 a[216:217], v241 offset:8192
  buffer_load_dwordx4 a[28:31], v248, s[20:23], s47 offen offset:1024 sc1
  v_mfma_f32_16x16x32_bf16 v[68:71], a[196:199], a[80:83], v[68:71]
  ds_read_b64_tr_b16 a[218:219], v241 offset:10240
  v_mfma_f32_16x16x32_bf16 v[16:19], a[200:203], a[72:75], v[16:19]
  s_add_u32 s46, s69, 0xa000
  v_mfma_f32_16x16x32_bf16 v[44:47], a[200:203], a[76:79], v[44:47]
  ds_read_b64_tr_b16 a[220:221], v242 offset:8192
  s_waitcnt vmcnt(15) lgkmcnt(3)
  v_mfma_f32_16x16x32_bf16 v[20:23], a[204:207], a[72:75], v[20:23]
  ds_read_b64_tr_b16 a[222:223], v242 offset:10240
  v_mfma_f32_16x16x32_bf16 v[48:51], a[204:207], a[76:79], v[48:51]
  buffer_load_dwordx4 a[32:35], v248, s[20:23], s46 offen sc1
  v_mfma_f32_16x16x32_bf16 v[24:27], a[208:211], a[72:75], v[24:27]
  ds_read_b64_tr_b16 a[224:225], v243 offset:8192
  v_mfma_f32_16x16x32_bf16 v[52:55], a[208:211], a[76:79], v[52:55]
  ds_read_b64_tr_b16 a[226:227], v243 offset:10240
  v_mfma_f32_16x16x32_bf16 v[0:3], a[212:215], a[84:87], v[0:3]
  s_waitcnt vmcnt(10)
  v_readfirstlane_b32 s44, v251
  s_nop 1
  s_and_b32 s44, s44, 0xf0f0f0f
  s_add_u32 s44, s44, 0x7c7c7c7c
  s_and_b32 s44, s44, 0x80808080
  s_cmp_eq_u32 s44, 0x80808080
  s_cbranch_scc0 concat_heads__mha_block_cached__mha_block_cached__near_ridge_kernel_spin16
concat_heads__mha_block_cached__mha_block_cached__near_ridge_kernel_go16:
  s_waitcnt lgkmcnt(4)
  v_mfma_f32_16x16x32_bf16 v[28:31], a[212:215], a[88:91], v[28:31]
  ds_read_b64_tr_b16 a[228:229], v244 offset:8192
  s_add_u32 s47, s53, 0xc800
  v_mfma_f32_16x16x32_bf16 v[56:59], a[212:215], a[92:95], v[56:59]
  ds_read_b64_tr_b16 a[230:231], v244 offset:10240
  buffer_load_dwordx4 a[36:39], v248, s[20:23], s47 offen sc1
  v_mfma_f32_16x16x32_bf16 v[4:7], a[216:219], a[84:87], v[4:7]
  ds_read_b64_tr_b16 a[232:233], v245 offset:8192
  buffer_load_dwordx4 a[40:43], v248, s[20:23], s47 offen offset:1024 sc1
  v_mfma_f32_16x16x32_bf16 v[32:35], a[216:219], a[88:91], v[32:35]
  ds_read_b64_tr_b16 a[234:235], v245 offset:10240
  v_mfma_f32_16x16x32_bf16 v[60:63], a[216:219], a[92:95], v[60:63]
  ds_read_b64_tr_b16 a[236:237], v246 offset:8192
  s_add_u32 s46, s69, 0xc800
  s_waitcnt lgkmcnt(5)
  v_mfma_f32_16x16x32_bf16 v[8:11], a[220:223], a[84:87], v[8:11]
  ds_read_b64_tr_b16 a[238:239], v246 offset:10240
  buffer_load_dwordx4 a[44:47], v248, s[20:23], s46 offen sc1
  v_mfma_f32_16x16x32_bf16 v[36:39], a[220:223], a[88:91], v[36:39]
  s_add_u32 s47, s52, 0xf000
  buffer_load_dwordx4 a[96:99], v248, s[20:23], s47 offen sc1
  v_mfma_f32_16x16x32_bf16 v[64:67], a[220:223], a[92:95], v[64:67]
  s_barrier
  v_add_u32 v240, 0x4000, v240
  ds_read_b64_tr_b16 a[184:185], v240
  v_mfma_f32_16x16x32_bf16 v[12:15], a[224:227], a[84:87], v[12:15]
  ds_read_b64_tr_b16 a[186:187], v240 offset:2048
  s_add_u32 m0, s33, 0x24000
  v_mfma_f32_16x16x32_bf16 v[40:43], a[224:227], a[88:91], v[40:43]
  v_add_u32 v241, 0x4000, v241
  ds_read_b64_tr_b16 a[188:189], v241
  buffer_load_dwordx4 a[100:103], v248, s[20:23], s47 offen offset:1024 sc1
  s_waitcnt lgkmcnt(5)
  v_mfma_f32_16x16x32_bf16 v[68:71], a[224:227], a[92:95], v[68:71]
  ds_read_b64_tr_b16 a[190:191], v241 offset:2048
  s_add_u32 s75, s63, 0x2a000
  v_mfma_f32_16x16x32_bf16 v[16:19], a[228:231], a[84:87], v[16:19]
  buffer_load_dwordx4 v222, s[16:19], s75 offen lds
  s_add_u32 s46, s68, 0xf000
  v_mfma_f32_16x16x32_bf16 v[44:47], a[228:231], a[88:91], v[44:47]
  v_add_u32 v242, 0x4000, v242
  ds_read_b64_tr_b16 a[192:193], v242
  v_mfma_f32_16x16x32_bf16 v[20:23], a[232:235], a[84:87], v[20:23]
  ds_read_b64_tr_b16 a[194:195], v242 offset:2048
  s_add_u32 s74, s63, 0x2aa00
  v_mfma_f32_16x16x32_bf16 v[48:51], a[232:235], a[88:91], v[48:51]
  buffer_load_dwordx4 v223, s[16:19], s74 offen offset:1024 lds
  buffer_load_dwordx4 a[104:107], v248, s[20:23], s46 offen sc1
  s_waitcnt vmcnt(14) lgkmcnt(4)
  v_mfma_f32_16x16x32_bf16 v[24:27], a[236:239], a[84:87], v[24:27]
  v_add_u32 v243, 0x4000, v243
  ds_read_b64_tr_b16 a[196:197], v243
  v_mfma_f32_16x16x32_bf16 v[52:55], a[236:239], a[88:91], v[52:55]
  ds_read_b64_tr_b16 a[198:199], v243 offset:2048
  s_add_u32 s75, s63, 0x2b400
  v_mfma_f32_16x16x32_bf16 v[0:3], a[184:187], a[0:3], v[0:3]
  buffer_load_dwordx4 v222, s[16:19], s75 offen offset:2048 lds
  v_mfma_f32_16x16x32_bf16 v[28:31], a[184:187], a[4:7], v[28:31]
  v_add_u32 v244, 0x4000, v244
  ds_read_b64_tr_b16 a[200:201], v244
  v_mfma_f32_16x16x32_bf16 v[56:59], a[184:187], a[8:11], v[56:59]
  ds_read_b64_tr_b16 a[202:203], v244 offset:2048
  s_add_u32 s74, s63, 0x2be00
  s_waitcnt lgkmcnt(4)
  v_mfma_f32_16x16x32_bf16 v[4:7], a[188:191], a[0:3], v[4:7]
  v_add_u32 v245, 0x4000, v245
  ds_read_b64_tr_b16 a[204:205], v245
  s_add_u32 s47, s54, 0xa000
  v_mfma_f32_16x16x32_bf16 v[32:35], a[188:191], a[4:7], v[32:35]
  ds_read_b64_tr_b16 a[206:207], v245 offset:2048
  buffer_load_dwordx4 v223, s[16:19], s74 offen offset:3072 lds
  v_mfma_f32_16x16x32_bf16 v[60:63], a[188:191], a[8:11], v[60:63]
  v_add_u32 v246, 0x4000, v246
  ds_read_b64_tr_b16 a[208:209], v246
  v_mfma_f32_16x16x32_bf16 v[8:11], a[192:195], a[0:3], v[8:11]
  ds_read_b64_tr_b16 a[210:211], v246 offset:2048
  buffer_load_dwordx4 a[48:51], v248, s[20:23], s47 offen sc1
  v_mfma_f32_16x16x32_bf16 v[36:39], a[192:195], a[4:7], v[36:39]
  ds_read_b64_tr_b16 a[212:213], v240 offset:8192
  s_waitcnt lgkmcnt(5)
  v_mfma_f32_16x16x32_bf16 v[64:67], a[192:195], a[8:11], v[64:67]
  ds_read_b64_tr_b16 a[214:215], v240 offset:10240
  buffer_load_dwordx4 a[52:55], v248, s[20:23], s47 offen offset:1024 sc1
  v_mfma_f32_16x16x32_bf16 v[12:15], a[196:199], a[0:3], v[12:15]
  s_add_u32 s46, s70, 0xa000
  v_mfma_f32_16x16x32_bf16 v[40:43], a[196:199], a[4:7], v[40:43]
  ds_read_b64_tr_b16 a[216:217], v241 offset:8192
  buffer_load_dwordx4 a[56:59], v248, s[20:23], s46 offen sc1
  v_mfma_f32_16x16x32_bf16 v[68:71], a[196:199], a[8:11], v[68:71]
  ds_read_b64_tr_b16 a[218:219], v241 offset:10240
  s_add_u32 s47, s52, 0x11800
  v_mfma_f32_16x16x32_bf16 v[16:19], a[200:203], a[0:3], v[16:19]
  buffer_load_dwordx4 a[108:111], v248, s[20:23], s47 offen sc1
  s_waitcnt lgkmcnt(4)
  v_mfma_f32_16x16x32_bf16 v[44:47], a[200:203], a[4:7], v[44:47]
  ds_read_b64_tr_b16 a[220:221], v242 offset:8192
  buffer_load_dwordx4 a[112:115], v248, s[20:23], s47 offen offset:1024 sc1
  v_mfma_f32_16x16x32_bf16 v[20:23], a[204:207], a[0:3], v[20:23]
  ds_read_b64_tr_b16 a[222:223], v242 offset:10240
  s_add_u32 s46, s68, 0x11800
  v_mfma_f32_16x16x32_bf16 v[48:51], a[204:207], a[4:7], v[48:51]
  buffer_load_dwordx4 a[116:119], v248, s[20:23], s46 offen sc1
  v_mfma_f32_16x16x32_bf16 v[24:27], a[208:211], a[0:3], v[24:27]
  ds_read_b64_tr_b16 a[224:225], v243 offset:8192
  v_mfma_f32_16x16x32_bf16 v[52:55], a[208:211], a[4:7], v[52:55]
  ds_read_b64_tr_b16 a[226:227], v243 offset:10240
  s_waitcnt vmcnt(19) lgkmcnt(4)
  v_mfma_f32_16x16x32_bf16 v[0:3], a[212:215], a[12:15], v[0:3]
  v_mfma_f32_16x16x32_bf16 v[28:31], a[212:215], a[16:19], v[28:31]
  ds_read_b64_tr_b16 a[228:229], v244 offset:8192
  s_add_u32 s47, s54, 0xc800
  v_mfma_f32_16x16x32_bf16 v[56:59], a[212:215], a[20:23], v[56:59]
  ds_read_b64_tr_b16 a[230:231], v244 offset:10240
  buffer_load_dwordx4 a[60:63], v248, s[20:23], s47 offen sc1
  v_mfma_f32_16x16x32_bf16 v[4:7], a[216:219], a[12:15], v[4:7]
  ds_read_b64_tr_b16 a[232:233], v245 offset:8192
  buffer_load_dwordx4 a[64:67], v248, s[20:23], s47 offen offset:1024 sc1
  v_mfma_f32_16x16x32_bf16 v[32:35], a[216:219], a[16:19], v[32:35]
  ds_read_b64_tr_b16 a[234:235], v245 offset:10240
  s_waitcnt lgkmcnt(4)
  v_mfma_f32_16x16x32_bf16 v[60:63], a[216:219], a[20:23], v[60:63]
  ds_read_b64_tr_b16 a[236:237], v246 offset:8192
  s_add_u32 s46, s70, 0xc800
  v_mfma_f32_16x16x32_bf16 v[8:11], a[220:223], a[12:15], v[8:11]
  ds_read_b64_tr_b16 a[238:239], v246 offset:10240
  buffer_load_dwordx4 a[68:71], v248, s[20:23], s46 offen sc1
  v_mfma_f32_16x16x32_bf16 v[36:39], a[220:223], a[16:19], v[36:39]
  s_add_u32 s47, s53, 0xf000
  buffer_load_dwordx4 a[120:123], v248, s[20:23], s47 offen sc1
  v_mfma_f32_16x16x32_bf16 v[64:67], a[220:223], a[20:23], v[64:67]
  s_barrier
  v_add_u32 v240, 0x4000, v240
  ds_read_b64_tr_b16 a[184:185], v240
  v_mfma_f32_16x16x32_bf16 v[12:15], a[224:227], a[12:15], v[12:15]
  ds_read_b64_tr_b16 a[186:187], v240 offset:2048
  s_add_u32 m0, s33, 0x4000
  s_waitcnt lgkmcnt(4)
  v_mfma_f32_16x16x32_bf16 v[40:43], a[224:227], a[16:19], v[40:43]
  v_add_u32 v241, 0x4000, v241
  ds_read_b64_tr_b16 a[188:189], v241
  buffer_load_dwordx4 a[124:127], v248, s[20:23], s47 offen offset:1024 sc1
  v_mfma_f32_16x16x32_bf16 v[68:71], a[224:227], a[20:23], v[68:71]
  ds_read_b64_tr_b16 a[190:191], v241 offset:2048
  s_add_u32 s75, s73, 0x2a000
  v_mfma_f32_16x16x32_bf16 v[16:19], a[228:231], a[12:15], v[16:19]
  buffer_load_dwordx4 v222, s[16:19], s75 offen lds
  s_add_u32 s46, s69, 0xf000
  v_mfma_f32_16x16x32_bf16 v[44:47], a[228:231], a[16:19], v[44:47]
  v_add_u32 v242, 0x4000, v242
  ds_read_b64_tr_b16 a[192:193], v242
  v_mfma_f32_16x16x32_bf16 v[20:23], a[232:235], a[12:15], v[20:23]
  ds_read_b64_tr_b16 a[194:195], v242 offset:2048
  s_add_u32 s74, s73, 0x2aa00
  s_waitcnt vmcnt(23) lgkmcnt(4)
  v_mfma_f32_16x16x32_bf16 v[48:51], a[232:235], a[16:19], v[48:51]
  buffer_load_dwordx4 v223, s[16:19], s74 offen offset:1024 lds
  buffer_load_dwordx4 a[128:131], v248, s[20:23], s46 offen sc1
  v_mfma_f32_16x16x32_bf16 v[24:27], a[236:239], a[12:15], v[24:27]
  v_add_u32 v243, 0x4000, v243
  ds_read_b64_tr_b16 a[196:197], v243
  v_mfma_f32_16x16x32_bf16 v[52:55], a[236:239], a[16:19], v[52:55]
  ds_read_b64_tr_b16 a[198:199], v243 offset:2048
  s_add_u32 s75, s73, 0x2b400
  v_mfma_f32_16x16x32_bf16 v[0:3], a[184:187], a[24:27], v[0:3]
  buffer_load_dwordx4 v222, s[16:19], s75 offen offset:2048 lds
  v_mfma_f32_16x16x32_bf16 v[28:31], a[184:187], a[28:31], v[28:31]
  v_add_u32 v244, 0x4000, v244
  ds_read_b64_tr_b16 a[200:201], v244
  s_waitcnt vmcnt(25) lgkmcnt(3)
  v_mfma_f32_16x16x32_bf16 v[56:59], a[184:187], a[32:35], v[56:59]
  ds_read_b64_tr_b16 a[202:203], v244 offset:2048
  s_add_u32 s74, s73, 0x2be00
  v_mfma_f32_16x16x32_bf16 v[4:7], a[188:191], a[24:27], v[4:7]
  v_add_u32 v245, 0x4000, v245
  ds_read_b64_tr_b16 a[204:205], v245
  s_add_u32 s47, s55, 0xa000
  v_mfma_f32_16x16x32_bf16 v[32:35], a[188:191], a[28:31], v[32:35]
  ds_read_b64_tr_b16 a[206:207], v245 offset:2048
  buffer_load_dwordx4 v223, s[16:19], s74 offen offset:3072 lds
  v_mfma_f32_16x16x32_bf16 v[60:63], a[188:191], a[32:35], v[60:63]
  v_add_u32 v246, 0x4000, v246
  ds_read_b64_tr_b16 a[208:209], v246
  v_mfma_f32_16x16x32_bf16 v[8:11], a[192:195], a[24:27], v[8:11]
  ds_read_b64_tr_b16 a[210:211], v246 offset:2048
  buffer_load_dwordx4 a[72:75], v248, s[20:23], s47 offen sc1
  s_waitcnt lgkmcnt(6)
  v_mfma_f32_16x16x32_bf16 v[36:39], a[192:195], a[28:31], v[36:39]
  ds_read_b64_tr_b16 a[212:213], v240 offset:8192
  v_mfma_f32_16x16x32_bf16 v[64:67], a[192:195], a[32:35], v[64:67]
  ds_read_b64_tr_b16 a[214:215], v240 offset:10240
  buffer_load_dwordx4 a[76:79], v248, s[20:23], s47 offen offset:1024 sc1
  v_mfma_f32_16x16x32_bf16 v[12:15], a[196:199], a[24:27], v[12:15]
  s_add_u32 s46, s71, 0xa000
  v_mfma_f32_16x16x32_bf16 v[40:43], a[196:199], a[28:31], v[40:43]
  ds_read_b64_tr_b16 a[216:217], v241 offset:8192
  buffer_load_dwordx4 a[80:83], v248, s[20:23], s46 offen sc1
  v_mfma_f32_16x16x32_bf16 v[68:71], a[196:199], a[32:35], v[68:71]
  ds_read_b64_tr_b16 a[218:219], v241 offset:10240
  s_add_u32 s47, s53, 0x11800
  s_waitcnt lgkmcnt(4)
  v_mfma_f32_16x16x32_bf16 v[16:19], a[200:203], a[24:27], v[16:19]
  buffer_load_dwordx4 a[132:135], v248, s[20:23], s47 offen sc1
  v_mfma_f32_16x16x32_bf16 v[44:47], a[200:203], a[28:31], v[44:47]
  ds_read_b64_tr_b16 a[220:221], v242 offset:8192
  buffer_load_dwordx4 a[136:139], v248, s[20:23], s47 offen offset:1024 sc1
  v_mfma_f32_16x16x32_bf16 v[20:23], a[204:207], a[24:27], v[20:23]
  ds_read_b64_tr_b16 a[222:223], v242 offset:10240
  s_add_u32 s46, s69, 0x11800
  v_mfma_f32_16x16x32_bf16 v[48:51], a[204:207], a[28:31], v[48:51]
  buffer_load_dwordx4 a[140:143], v248, s[20:23], s46 offen sc1
  v_mfma_f32_16x16x32_bf16 v[24:27], a[208:211], a[24:27], v[24:27]
  ds_read_b64_tr_b16 a[224:225], v243 offset:8192
  s_waitcnt vmcnt(29) lgkmcnt(3)
  v_mfma_f32_16x16x32_bf16 v[52:55], a[208:211], a[28:31], v[52:55]
  ds_read_b64_tr_b16 a[226:227], v243 offset:10240
  v_mfma_f32_16x16x32_bf16 v[0:3], a[212:215], a[36:39], v[0:3]
  v_mfma_f32_16x16x32_bf16 v[28:31], a[212:215], a[40:43], v[28:31]
  ds_read_b64_tr_b16 a[228:229], v244 offset:8192
  s_add_u32 s47, s55, 0xc800
  v_mfma_f32_16x16x32_bf16 v[56:59], a[212:215], a[44:47], v[56:59]
  ds_read_b64_tr_b16 a[230:231], v244 offset:10240
  buffer_load_dwordx4 a[84:87], v248, s[20:23], s47 offen sc1
  v_mfma_f32_16x16x32_bf16 v[4:7], a[216:219], a[36:39], v[4:7]
  ds_read_b64_tr_b16 a[232:233], v245 offset:8192
  buffer_load_dwordx4 a[88:91], v248, s[20:23], s47 offen offset:1024 sc1
  s_waitcnt lgkmcnt(5)
  v_mfma_f32_16x16x32_bf16 v[32:35], a[216:219], a[40:43], v[32:35]
  ds_read_b64_tr_b16 a[234:235], v245 offset:10240
  v_mfma_f32_16x16x32_bf16 v[60:63], a[216:219], a[44:47], v[60:63]
  ds_read_b64_tr_b16 a[236:237], v246 offset:8192
  s_add_u32 s46, s71, 0xc800
  v_mfma_f32_16x16x32_bf16 v[8:11], a[220:223], a[36:39], v[8:11]
  ds_read_b64_tr_b16 a[238:239], v246 offset:10240
  buffer_load_dwordx4 a[92:95], v248, s[20:23], s46 offen sc1
  v_mfma_f32_16x16x32_bf16 v[36:39], a[220:223], a[40:43], v[36:39]
  s_add_u32 s47, s54, 0xf000
  buffer_load_dwordx4 a[144:147], v248, s[20:23], s47 offen sc1
  v_mfma_f32_16x16x32_bf16 v[64:67], a[220:223], a[44:47], v[64:67]
  s_barrier
  v_add_u32 v240, 0xffff0000, v240
  ds_read_b64_tr_b16 a[184:185], v240
  s_waitcnt lgkmcnt(5)
  v_mfma_f32_16x16x32_bf16 v[12:15], a[224:227], a[36:39], v[12:15]
  ds_read_b64_tr_b16 a[186:187], v240 offset:2048
  s_add_u32 m0, s33, 0x18000
  v_mfma_f32_16x16x32_bf16 v[40:43], a[224:227], a[40:43], v[40:43]
  v_add_u32 v241, 0xffff0000, v241
  ds_read_b64_tr_b16 a[188:189], v241
  buffer_load_dwordx4 a[148:151], v248, s[20:23], s47 offen offset:1024 sc1
  v_mfma_f32_16x16x32_bf16 v[68:71], a[224:227], a[44:47], v[68:71]
  ds_read_b64_tr_b16 a[190:191], v241 offset:2048
  s_add_u32 s75, s35, 0x2a000
  v_mfma_f32_16x16x32_bf16 v[16:19], a[228:231], a[36:39], v[16:19]
  buffer_load_dwordx4 v222, s[16:19], s75 offen lds
  s_add_u32 s46, s70, 0xf000
  v_mfma_f32_16x16x32_bf16 v[44:47], a[228:231], a[40:43], v[44:47]
  v_add_u32 v242, 0xffff0000, v242
  ds_read_b64_tr_b16 a[192:193], v242
  s_waitcnt vmcnt(27) lgkmcnt(3)
  v_mfma_f32_16x16x32_bf16 v[20:23], a[232:235], a[36:39], v[20:23]
  ds_read_b64_tr_b16 a[194:195], v242 offset:2048
  s_add_u32 s74, s35, 0x2aa00
  v_mfma_f32_16x16x32_bf16 v[48:51], a[232:235], a[40:43], v[48:51]
  buffer_load_dwordx4 v223, s[16:19], s74 offen offset:1024 lds
  buffer_load_dwordx4 a[152:155], v248, s[20:23], s46 offen sc1
  v_mfma_f32_16x16x32_bf16 v[24:27], a[236:239], a[36:39], v[24:27]
  v_add_u32 v243, 0xffff0000, v243
  ds_read_b64_tr_b16 a[196:197], v243
  v_mfma_f32_16x16x32_bf16 v[52:55], a[236:239], a[40:43], v[52:55]
  ds_read_b64_tr_b16 a[198:199], v243 offset:2048
  s_add_u32 s75, s35, 0x2b400
  v_mfma_f32_16x16x32_bf16 v[0:3], a[184:187], a[48:51], v[0:3]
  buffer_load_dwordx4 v222, s[16:19], s75 offen offset:2048 lds
  s_waitcnt vmcnt(28) lgkmcnt(4)
  v_mfma_f32_16x16x32_bf16 v[28:31], a[184:187], a[52:55], v[28:31]
  v_add_u32 v244, 0xffff0000, v244
  ds_read_b64_tr_b16 a[200:201], v244
  v_mfma_f32_16x16x32_bf16 v[56:59], a[184:187], a[56:59], v[56:59]
  ds_read_b64_tr_b16 a[202:203], v244 offset:2048
  s_add_u32 s74, s35, 0x2be00
  v_mfma_f32_16x16x32_bf16 v[4:7], a[188:191], a[48:51], v[4:7]
  v_add_u32 v245, 0xffff0000, v245
  ds_read_b64_tr_b16 a[204:205], v245
  v_mfma_f32_16x16x32_bf16 v[32:35], a[188:191], a[52:55], v[32:35]
  ds_read_b64_tr_b16 a[206:207], v245 offset:2048
  buffer_load_dwordx4 v223, s[16:19], s74 offen offset:3072 lds
  v_mfma_f32_16x16x32_bf16 v[60:63], a[188:191], a[56:59], v[60:63]
  v_add_u32 v246, 0xffff0000, v246
  ds_read_b64_tr_b16 a[208:209], v246
  s_waitcnt lgkmcnt(5)
  v_mfma_f32_16x16x32_bf16 v[8:11], a[192:195], a[48:51], v[8:11]
  ds_read_b64_tr_b16 a[210:211], v246 offset:2048
  s_add_u32 s47, s54, 0x11800
  v_mfma_f32_16x16x32_bf16 v[36:39], a[192:195], a[52:55], v[36:39]
  ds_read_b64_tr_b16 a[212:213], v240 offset:8192
  v_mfma_f32_16x16x32_bf16 v[64:67], a[192:195], a[56:59], v[64:67]
  ds_read_b64_tr_b16 a[214:215], v240 offset:10240
  v_mfma_f32_16x16x32_bf16 v[12:15], a[196:199], a[48:51], v[12:15]
  buffer_load_dwordx4 a[156:159], v248, s[20:23], s47 offen sc1
  v_mfma_f32_16x16x32_bf16 v[40:43], a[196:199], a[52:55], v[40:43]
  ds_read_b64_tr_b16 a[216:217], v241 offset:8192
  buffer_load_dwordx4 a[160:163], v248, s[20:23], s47 offen offset:1024 sc1
  s_waitcnt lgkmcnt(5)
  v_mfma_f32_16x16x32_bf16 v[68:71], a[196:199], a[56:59], v[68:71]
  ds_read_b64_tr_b16 a[218:219], v241 offset:10240
  v_mfma_f32_16x16x32_bf16 v[16:19], a[200:203], a[48:51], v[16:19]
  s_add_u32 s46, s70, 0x11800
  v_mfma_f32_16x16x32_bf16 v[44:47], a[200:203], a[52:55], v[44:47]
  ds_read_b64_tr_b16 a[220:221], v242 offset:8192
  v_mfma_f32_16x16x32_bf16 v[20:23], a[204:207], a[48:51], v[20:23]
  ds_read_b64_tr_b16 a[222:223], v242 offset:10240
  v_mfma_f32_16x16x32_bf16 v[48:51], a[204:207], a[52:55], v[48:51]
  buffer_load_dwordx4 a[164:167], v248, s[20:23], s46 offen sc1
  s_waitcnt vmcnt(26) lgkmcnt(4)
  v_mfma_f32_16x16x32_bf16 v[24:27], a[208:211], a[48:51], v[24:27]
  ds_read_b64_tr_b16 a[224:225], v243 offset:8192
  v_mfma_f32_16x16x32_bf16 v[52:55], a[208:211], a[52:55], v[52:55]
  ds_read_b64_tr_b16 a[226:227], v243 offset:10240
  v_mfma_f32_16x16x32_bf16 v[0:3], a[212:215], a[60:63], v[0:3]
  v_mfma_f32_16x16x32_bf16 v[28:31], a[212:215], a[64:67], v[28:31]
  ds_read_b64_tr_b16 a[228:229], v244 offset:8192
  v_mfma_f32_16x16x32_bf16 v[56:59], a[212:215], a[68:71], v[56:59]
  ds_read_b64_tr_b16 a[230:231], v244 offset:10240
  s_add_u32 s47, s55, 0xf000
  s_waitcnt lgkmcnt(4)
  v_mfma_f32_16x16x32_bf16 v[4:7], a[216:219], a[60:63], v[4:7]
  ds_read_b64_tr_b16 a[232:233], v245 offset:8192
  v_mfma_f32_16x16x32_bf16 v[32:35], a[216:219], a[64:67], v[32:35]
  ds_read_b64_tr_b16 a[234:235], v245 offset:10240
  v_mfma_f32_16x16x32_bf16 v[60:63], a[216:219], a[68:71], v[60:63]
  ds_read_b64_tr_b16 a[236:237], v246 offset:8192
  buffer_load_dwordx4 a[168:171], v248, s[20:23], s47 offen sc1
  v_mfma_f32_16x16x32_bf16 v[8:11], a[220:223], a[60:63], v[8:11]
  ds_read_b64_tr_b16 a[238:239], v246 offset:10240
  v_mfma_f32_16x16x32_bf16 v[36:39], a[220:223], a[64:67], v[36:39]
  buffer_load_dwordx4 a[172:175], v248, s[20:23], s47 offen offset:1024 sc1
  s_waitcnt lgkmcnt(4)
  v_mfma_f32_16x16x32_bf16 v[64:67], a[220:223], a[68:71], v[64:67]
  s_barrier
  v_add_u32 v240, 0x14000, v240
  ds_read_b64_tr_b16 a[184:185], v240
  v_mfma_f32_16x16x32_bf16 v[12:15], a[224:227], a[60:63], v[12:15]
  ds_read_b64_tr_b16 a[186:187], v240 offset:2048
  v_mfma_f32_16x16x32_bf16 v[40:43], a[224:227], a[64:67], v[40:43]
  v_add_u32 v241, 0x14000, v241
  ds_read_b64_tr_b16 a[188:189], v241
  v_mfma_f32_16x16x32_bf16 v[68:71], a[224:227], a[68:71], v[68:71]
  ds_read_b64_tr_b16 a[190:191], v241 offset:2048
  v_mfma_f32_16x16x32_bf16 v[16:19], a[228:231], a[60:63], v[16:19]
  s_add_u32 s46, s71, 0xf000
  s_waitcnt lgkmcnt(4)
  v_mfma_f32_16x16x32_bf16 v[44:47], a[228:231], a[64:67], v[44:47]
  v_add_u32 v242, 0x14000, v242
  ds_read_b64_tr_b16 a[192:193], v242
  v_mfma_f32_16x16x32_bf16 v[20:23], a[232:235], a[60:63], v[20:23]
  ds_read_b64_tr_b16 a[194:195], v242 offset:2048
  v_mfma_f32_16x16x32_bf16 v[48:51], a[232:235], a[64:67], v[48:51]
  buffer_load_dwordx4 a[176:179], v248, s[20:23], s46 offen sc1
  v_mfma_f32_16x16x32_bf16 v[24:27], a[236:239], a[60:63], v[24:27]
  v_add_u32 v243, 0x14000, v243
  ds_read_b64_tr_b16 a[196:197], v243
  v_mfma_f32_16x16x32_bf16 v[52:55], a[236:239], a[64:67], v[52:55]
  ds_read_b64_tr_b16 a[198:199], v243 offset:2048
  s_waitcnt vmcnt(19) lgkmcnt(4)
  v_mfma_f32_16x16x32_bf16 v[0:3], a[184:187], a[72:75], v[0:3]
  v_mfma_f32_16x16x32_bf16 v[28:31], a[184:187], a[76:79], v[28:31]
  v_add_u32 v244, 0x14000, v244
  ds_read_b64_tr_b16 a[200:201], v244
  v_mfma_f32_16x16x32_bf16 v[56:59], a[184:187], a[80:83], v[56:59]
  ds_read_b64_tr_b16 a[202:203], v244 offset:2048
  v_mfma_f32_16x16x32_bf16 v[4:7], a[188:191], a[72:75], v[4:7]
  v_add_u32 v245, 0x14000, v245
  ds_read_b64_tr_b16 a[204:205], v245
  v_mfma_f32_16x16x32_bf16 v[32:35], a[188:191], a[76:79], v[32:35]
  ds_read_b64_tr_b16 a[206:207], v245 offset:2048
  s_add_u32 s47, s55, 0x11800
  s_waitcnt lgkmcnt(4)
  v_mfma_f32_16x16x32_bf16 v[60:63], a[188:191], a[80:83], v[60:63]
  v_add_u32 v246, 0x14000, v246
  ds_read_b64_tr_b16 a[208:209], v246
  v_mfma_f32_16x16x32_bf16 v[8:11], a[192:195], a[72:75], v[8:11]
  ds_read_b64_tr_b16 a[210:211], v246 offset:2048
  v_mfma_f32_16x16x32_bf16 v[36:39], a[192:195], a[76:79], v[36:39]
  ds_read_b64_tr_b16 a[212:213], v240 offset:8192
  buffer_load_dwordx4 a[240:243], v248, s[20:23], s47 offen sc1
  v_mfma_f32_16x16x32_bf16 v[64:67], a[192:195], a[80:83], v[64:67]
  ds_read_b64_tr_b16 a[214:215], v240 offset:10240
  v_mfma_f32_16x16x32_bf16 v[12:15], a[196:199], a[72:75], v[12:15]
  s_waitcnt lgkmcnt(4)
  v_mfma_f32_16x16x32_bf16 v[40:43], a[196:199], a[76:79], v[40:43]
  ds_read_b64_tr_b16 a[216:217], v241 offset:8192
  buffer_load_dwordx4 a[244:247], v248, s[20:23], s47 offen offset:1024 sc1
  v_mfma_f32_16x16x32_bf16 v[68:71], a[196:199], a[80:83], v[68:71]
  ds_read_b64_tr_b16 a[218:219], v241 offset:10240
  v_mfma_f32_16x16x32_bf16 v[16:19], a[200:203], a[72:75], v[16:19]
  s_add_u32 s46, s71, 0x11800
  v_mfma_f32_16x16x32_bf16 v[44:47], a[200:203], a[76:79], v[44:47]
  ds_read_b64_tr_b16 a[220:221], v242 offset:8192
  v_mfma_f32_16x16x32_bf16 v[20:23], a[204:207], a[72:75], v[20:23]
  ds_read_b64_tr_b16 a[222:223], v242 offset:10240
  s_waitcnt vmcnt(16) lgkmcnt(4)
  v_mfma_f32_16x16x32_bf16 v[48:51], a[204:207], a[76:79], v[48:51]
  buffer_load_dwordx4 a[248:251], v248, s[20:23], s46 offen sc1
  v_mfma_f32_16x16x32_bf16 v[24:27], a[208:211], a[72:75], v[24:27]
  ds_read_b64_tr_b16 a[224:225], v243 offset:8192
  v_mfma_f32_16x16x32_bf16 v[52:55], a[208:211], a[76:79], v[52:55]
  ds_read_b64_tr_b16 a[226:227], v243 offset:10240
  v_mfma_f32_16x16x32_bf16 v[0:3], a[212:215], a[84:87], v[0:3]
  v_mfma_f32_16x16x32_bf16 v[28:31], a[212:215], a[88:91], v[28:31]
  ds_read_b64_tr_b16 a[228:229], v244 offset:8192
  s_waitcnt vmcnt(16) lgkmcnt(3)
  v_mfma_f32_16x16x32_bf16 v[56:59], a[212:215], a[92:95], v[56:59]
  ds_read_b64_tr_b16 a[230:231], v244 offset:10240
  v_mfma_f32_16x16x32_bf16 v[4:7], a[216:219], a[84:87], v[4:7]
  ds_read_b64_tr_b16 a[232:233], v245 offset:8192
  v_mfma_f32_16x16x32_bf16 v[32:35], a[216:219], a[88:91], v[32:35]
  ds_read_b64_tr_b16 a[234:235], v245 offset:10240
  v_mfma_f32_16x16x32_bf16 v[60:63], a[216:219], a[92:95], v[60:63]
  ds_read_b64_tr_b16 a[236:237], v246 offset:8192
  v_mfma_f32_16x16x32_bf16 v[8:11], a[220:223], a[84:87], v[8:11]
  ds_read_b64_tr_b16 a[238:239], v246 offset:10240
  s_waitcnt lgkmcnt(6)
  v_mfma_f32_16x16x32_bf16 v[36:39], a[220:223], a[88:91], v[36:39]
  v_mfma_f32_16x16x32_bf16 v[64:67], a[220:223], a[92:95], v[64:67]
  s_waitcnt vmcnt(9)
  s_barrier
  v_add_u32 v224, 0xc000, v240
  ds_read_b64_tr_b16 a[184:185], v224
  v_mfma_f32_16x16x32_bf16 v[12:15], a[224:227], a[84:87], v[12:15]
  ds_read_b64_tr_b16 a[186:187], v224 offset:2048
  v_mfma_f32_16x16x32_bf16 v[40:43], a[224:227], a[88:91], v[40:43]
  ds_read_b64_tr_b16 a[188:189], v224 offset:8192
  v_mfma_f32_16x16x32_bf16 v[68:71], a[224:227], a[92:95], v[68:71]
  ds_read_b64_tr_b16 a[190:191], v224 offset:10240
  s_waitcnt lgkmcnt(4)
  v_mfma_f32_16x16x32_bf16 v[16:19], a[228:231], a[84:87], v[16:19]
  v_mfma_f32_16x16x32_bf16 v[44:47], a[228:231], a[88:91], v[44:47]
  v_add_u32 v225, 0x10000, v240
  ds_read_b64_tr_b16 a[192:193], v225
  v_mfma_f32_16x16x32_bf16 v[20:23], a[232:235], a[84:87], v[20:23]
  ds_read_b64_tr_b16 a[194:195], v225 offset:2048
  v_mfma_f32_16x16x32_bf16 v[48:51], a[232:235], a[88:91], v[48:51]
  v_mfma_f32_16x16x32_bf16 v[24:27], a[236:239], a[84:87], v[24:27]
  ds_read_b64_tr_b16 a[196:197], v225 offset:8192
  s_waitcnt lgkmcnt(3)
  v_mfma_f32_16x16x32_bf16 v[52:55], a[236:239], a[88:91], v[52:55]
  ds_read_b64_tr_b16 a[198:199], v225 offset:10240
  v_mfma_f32_16x16x32_bf16 v[0:3], a[184:187], a[96:99], v[0:3]
  v_mfma_f32_16x16x32_bf16 v[28:31], a[184:187], a[100:103], v[28:31]
  v_add_u32 v226, 0xffff0000, v240
  ds_read_b64_tr_b16 a[200:201], v226
  v_mfma_f32_16x16x32_bf16 v[56:59], a[184:187], a[104:107], v[56:59]
  ds_read_b64_tr_b16 a[202:203], v226 offset:2048
  v_mfma_f32_16x16x32_bf16 v[0:3], a[188:191], a[108:111], v[0:3]
  s_waitcnt lgkmcnt(4)
  v_mfma_f32_16x16x32_bf16 v[28:31], a[188:191], a[112:115], v[28:31]
  ds_read_b64_tr_b16 a[204:205], v226 offset:8192
  v_mfma_f32_16x16x32_bf16 v[56:59], a[188:191], a[116:119], v[56:59]
  ds_read_b64_tr_b16 a[206:207], v226 offset:10240
  v_mfma_f32_16x16x32_bf16 v[0:3], a[192:195], a[120:123], v[0:3]
  v_mfma_f32_16x16x32_bf16 v[28:31], a[192:195], a[124:127], v[28:31]
  v_add_u32 v227, 0x4000, v240
  ds_read_b64_tr_b16 a[208:209], v227
  v_mfma_f32_16x16x32_bf16 v[56:59], a[192:195], a[128:131], v[56:59]
  ds_read_b64_tr_b16 a[210:211], v227 offset:2048
  s_waitcnt lgkmcnt(4)
  v_mfma_f32_16x16x32_bf16 v[0:3], a[196:199], a[132:135], v[0:3]
  v_mfma_f32_16x16x32_bf16 v[28:31], a[196:199], a[136:139], v[28:31]
  ds_read_b64_tr_b16 a[212:213], v227 offset:8192
  v_mfma_f32_16x16x32_bf16 v[56:59], a[196:199], a[140:143], v[56:59]
  ds_read_b64_tr_b16 a[214:215], v227 offset:10240
  v_mfma_f32_16x16x32_bf16 v[0:3], a[200:203], a[144:147], v[0:3]
  v_mfma_f32_16x16x32_bf16 v[28:31], a[200:203], a[148:151], v[28:31]
  v_add_u32 v228, 0xc000, v241
  ds_read_b64_tr_b16 a[216:217], v228
  s_waitcnt vmcnt(5) lgkmcnt(3)
  v_mfma_f32_16x16x32_bf16 v[56:59], a[200:203], a[152:155], v[56:59]
  ds_read_b64_tr_b16 a[218:219], v228 offset:2048
  v_mfma_f32_16x16x32_bf16 v[0:3], a[204:207], a[156:159], v[0:3]
  v_mfma_f32_16x16x32_bf16 v[28:31], a[204:207], a[160:163], v[28:31]
  ds_read_b64_tr_b16 a[220:221], v228 offset:8192
  v_mfma_f32_16x16x32_bf16 v[56:59], a[204:207], a[164:167], v[56:59]
  ds_read_b64_tr_b16 a[222:223], v228 offset:10240
  v_mfma_f32_16x16x32_bf16 v[0:3], a[208:211], a[168:171], v[0:3]
  s_waitcnt vmcnt(0) lgkmcnt(4)
  v_mfma_f32_16x16x32_bf16 v[28:31], a[208:211], a[172:175], v[28:31]
  v_add_u32 v229, 0x10000, v241
  ds_read_b64_tr_b16 a[224:225], v229
  v_mfma_f32_16x16x32_bf16 v[56:59], a[208:211], a[176:179], v[56:59]
  ds_read_b64_tr_b16 a[226:227], v229 offset:2048
  v_mfma_f32_16x16x32_bf16 v[0:3], a[212:215], a[240:243], v[0:3]
  v_mfma_f32_16x16x32_bf16 v[28:31], a[212:215], a[244:247], v[28:31]
  ds_read_b64_tr_b16 a[228:229], v229 offset:8192
  v_mfma_f32_16x16x32_bf16 v[56:59], a[212:215], a[248:251], v[56:59]
  ds_read_b64_tr_b16 a[230:231], v229 offset:10240
  s_waitcnt lgkmcnt(4)
  v_mfma_f32_16x16x32_bf16 v[4:7], a[216:219], a[96:99], v[4:7]
  v_mfma_f32_16x16x32_bf16 v[32:35], a[216:219], a[100:103], v[32:35]
  v_add_u32 v230, 0xffff0000, v241
  ds_read_b64_tr_b16 a[232:233], v230
  v_mfma_f32_16x16x32_bf16 v[60:63], a[216:219], a[104:107], v[60:63]
  ds_read_b64_tr_b16 a[234:235], v230 offset:2048
  v_mfma_f32_16x16x32_bf16 v[4:7], a[220:223], a[108:111], v[4:7]
  v_mfma_f32_16x16x32_bf16 v[32:35], a[220:223], a[112:115], v[32:35]
  ds_read_b64_tr_b16 a[236:237], v230 offset:8192
  s_cmp_eq_u32 s25, 0
  s_cselect_b32 s29, 0x7ff00000, 0
  s_waitcnt lgkmcnt(3)
  v_mfma_f32_16x16x32_bf16 v[60:63], a[220:223], a[116:119], v[60:63]
  ds_read_b64_tr_b16 a[238:239], v230 offset:10240
  v_mfma_f32_16x16x32_bf16 v[4:7], a[224:227], a[120:123], v[4:7]
  v_add_u32 v83, s29, v248
  s_add_u32 s77, s43, 0
  v_mfma_f32_16x16x32_bf16 v[32:35], a[224:227], a[124:127], v[32:35]
  v_add_u32 v231, 0x4000, v241
  ds_read_b64_tr_b16 a[184:185], v231
  v_mfma_f32_16x16x32_bf16 v[60:63], a[224:227], a[128:131], v[60:63]
  ds_read_b64_tr_b16 a[186:187], v231 offset:2048
  buffer_store_dwordx4 v[0:3], v83, s[12:15], s77 offen sc1
  v_mfma_f32_16x16x32_bf16 v[4:7], a[228:231], a[132:135], v[4:7]
  s_cmp_eq_u32 s25, 2
  s_cselect_b32 s29, 0x7ff00000, 0
  v_add_u32 v82, s29, v248
  s_waitcnt lgkmcnt(4)
  v_mfma_f32_16x16x32_bf16 v[32:35], a[228:231], a[136:139], v[32:35]
  ds_read_b64_tr_b16 a[188:189], v231 offset:8192
  s_add_u32 s76, s43, 0x1c00
  v_mfma_f32_16x16x32_bf16 v[60:63], a[228:231], a[140:143], v[60:63]
  ds_read_b64_tr_b16 a[190:191], v231 offset:10240
  buffer_store_dwordx4 v[28:31], v82, s[12:15], s76 offen sc1
  v_mfma_f32_16x16x32_bf16 v[4:7], a[232:235], a[144:147], v[4:7]
  s_cmp_eq_u32 s25, 0
  s_cselect_b32 s29, 0x7ff00000, 0
  v_mfma_f32_16x16x32_bf16 v[32:35], a[232:235], a[148:151], v[32:35]
  v_add_u32 v224, 0xc000, v242
  ds_read_b64_tr_b16 a[192:193], v224
  v_mfma_f32_16x16x32_bf16 v[60:63], a[232:235], a[152:155], v[60:63]
  ds_read_b64_tr_b16 a[194:195], v224 offset:2048
  v_add_u32 v83, s29, v248
  s_waitcnt lgkmcnt(4)
  v_mfma_f32_16x16x32_bf16 v[4:7], a[236:239], a[156:159], v[4:7]
  s_add_u32 s77, s43, 0x3800
  buffer_store_dwordx4 v[56:59], v83, s[12:15], s77 offen sc1
  v_mfma_f32_16x16x32_bf16 v[32:35], a[236:239], a[160:163], v[32:35]
  ds_read_b64_tr_b16 a[196:197], v224 offset:8192
  v_mfma_f32_16x16x32_bf16 v[60:63], a[236:239], a[164:167], v[60:63]
  ds_read_b64_tr_b16 a[198:199], v224 offset:10240
  v_mfma_f32_16x16x32_bf16 v[4:7], a[184:187], a[168:171], v[4:7]
  v_mfma_f32_16x16x32_bf16 v[32:35], a[184:187], a[172:175], v[32:35]
  v_add_u32 v225, 0x10000, v242
  ds_read_b64_tr_b16 a[200:201], v225
  s_waitcnt lgkmcnt(3)
  v_mfma_f32_16x16x32_bf16 v[60:63], a[184:187], a[176:179], v[60:63]
  ds_read_b64_tr_b16 a[202:203], v225 offset:2048
  v_mfma_f32_16x16x32_bf16 v[4:7], a[188:191], a[240:243], v[4:7]
  v_mfma_f32_16x16x32_bf16 v[32:35], a[188:191], a[244:247], v[32:35]
  ds_read_b64_tr_b16 a[204:205], v225 offset:8192
  v_mfma_f32_16x16x32_bf16 v[60:63], a[188:191], a[248:251], v[60:63]
  ds_read_b64_tr_b16 a[206:207], v225 offset:10240
  v_mfma_f32_16x16x32_bf16 v[8:11], a[192:195], a[96:99], v[8:11]
  s_waitcnt lgkmcnt(4)
  v_mfma_f32_16x16x32_bf16 v[36:39], a[192:195], a[100:103], v[36:39]
  v_add_u32 v226, 0xffff0000, v242
  ds_read_b64_tr_b16 a[208:209], v226
  v_mfma_f32_16x16x32_bf16 v[64:67], a[192:195], a[104:107], v[64:67]
  ds_read_b64_tr_b16 a[210:211], v226 offset:2048
  v_mfma_f32_16x16x32_bf16 v[8:11], a[196:199], a[108:111], v[8:11]
  v_mfma_f32_16x16x32_bf16 v[36:39], a[196:199], a[112:115], v[36:39]
  ds_read_b64_tr_b16 a[212:213], v226 offset:8192
  s_cmp_eq_u32 s25, 0
  s_cselect_b32 s29, 0x7ff00000, 0
  v_mfma_f32_16x16x32_bf16 v[64:67], a[196:199], a[116:119], v[64:67]
  ds_read_b64_tr_b16 a[214:215], v226 offset:10240
  s_waitcnt lgkmcnt(4)
  v_mfma_f32_16x16x32_bf16 v[8:11], a[200:203], a[120:123], v[8:11]
  v_add_u32 v82, s29, v248
  s_add_u32 s76, s43, 0x400
  v_mfma_f32_16x16x32_bf16 v[36:39], a[200:203], a[124:127], v[36:39]
  v_add_u32 v227, 0x4000, v242
  ds_read_b64_tr_b16 a[216:217], v227
  v_mfma_f32_16x16x32_bf16 v[64:67], a[200:203], a[128:131], v[64:67]
  ds_read_b64_tr_b16 a[218:219], v227 offset:2048
  buffer_store_dwordx4 v[4:7], v82, s[12:15], s76 offen sc1
  v_mfma_f32_16x16x32_bf16 v[8:11], a[204:207], a[132:135], v[8:11]
  s_cmp_eq_u32 s25, 2
  s_cselect_b32 s29, 0x7ff00000, 0
  v_add_u32 v83, s29, v248
  v_mfma_f32_16x16x32_bf16 v[36:39], a[204:207], a[136:139], v[36:39]
  ds_read_b64_tr_b16 a[220:221], v227 offset:8192
  s_add_u32 s77, s43, 0x2000
  s_waitcnt lgkmcnt(3)
  v_mfma_f32_16x16x32_bf16 v[64:67], a[204:207], a[140:143], v[64:67]
  ds_read_b64_tr_b16 a[222:223], v227 offset:10240
  buffer_store_dwordx4 v[32:35], v83, s[12:15], s77 offen sc1
  v_mfma_f32_16x16x32_bf16 v[8:11], a[208:211], a[144:147], v[8:11]
  s_cmp_eq_u32 s25, 1
  s_cselect_b32 s29, 0x7ff00000, 0
  v_mfma_f32_16x16x32_bf16 v[36:39], a[208:211], a[148:151], v[36:39]
  v_add_u32 v228, 0xc000, v243
  ds_read_b64_tr_b16 a[224:225], v228
  v_mfma_f32_16x16x32_bf16 v[64:67], a[208:211], a[152:155], v[64:67]
  ds_read_b64_tr_b16 a[226:227], v228 offset:2048
  v_add_u32 v82, s29, v248
  v_mfma_f32_16x16x32_bf16 v[8:11], a[212:215], a[156:159], v[8:11]
  s_add_u32 s76, s43, 0x3c00
  buffer_store_dwordx4 v[60:63], v82, s[12:15], s76 offen sc1
  s_waitcnt lgkmcnt(4)
  v_mfma_f32_16x16x32_bf16 v[36:39], a[212:215], a[160:163], v[36:39]
  ds_read_b64_tr_b16 a[228:229], v228 offset:8192
  v_mfma_f32_16x16x32_bf16 v[64:67], a[212:215], a[164:167], v[64:67]
  ds_read_b64_tr_b16 a[230:231], v228 offset:10240
  v_mfma_f32_16x16x32_bf16 v[8:11], a[216:219], a[168:171], v[8:11]
  v_mfma_f32_16x16x32_bf16 v[36:39], a[216:219], a[172:175], v[36:39]
  v_add_u32 v229, 0x10000, v243
  ds_read_b64_tr_b16 a[232:233], v229
  v_mfma_f32_16x16x32_bf16 v[64:67], a[216:219], a[176:179], v[64:67]
  ds_read_b64_tr_b16 a[234:235], v229 offset:2048
  s_waitcnt lgkmcnt(4)
  v_mfma_f32_16x16x32_bf16 v[8:11], a[220:223], a[240:243], v[8:11]
  v_mfma_f32_16x16x32_bf16 v[36:39], a[220:223], a[244:247], v[36:39]
  ds_read_b64_tr_b16 a[236:237], v229 offset:8192
  v_mfma_f32_16x16x32_bf16 v[64:67], a[220:223], a[248:251], v[64:67]
  ds_read_b64_tr_b16 a[238:239], v229 offset:10240
  v_mfma_f32_16x16x32_bf16 v[12:15], a[224:227], a[96:99], v[12:15]
  v_mfma_f32_16x16x32_bf16 v[40:43], a[224:227], a[100:103], v[40:43]
  v_add_u32 v230, 0xffff0000, v243
  ds_read_b64_tr_b16 a[184:185], v230
  s_waitcnt lgkmcnt(3)
  v_mfma_f32_16x16x32_bf16 v[68:71], a[224:227], a[104:107], v[68:71]
  ds_read_b64_tr_b16 a[186:187], v230 offset:2048
  v_mfma_f32_16x16x32_bf16 v[12:15], a[228:231], a[108:111], v[12:15]
  v_mfma_f32_16x16x32_bf16 v[40:43], a[228:231], a[112:115], v[40:43]
  ds_read_b64_tr_b16 a[188:189], v230 offset:8192
  s_cmp_eq_u32 s25, 0
  s_cselect_b32 s29, 0x7ff00000, 0
  v_mfma_f32_16x16x32_bf16 v[68:71], a[228:231], a[116:119], v[68:71]
  ds_read_b64_tr_b16 a[190:191], v230 offset:10240
  v_mfma_f32_16x16x32_bf16 v[12:15], a[232:235], a[120:123], v[12:15]
  v_add_u32 v83, s29, v248
  s_add_u32 s77, s43, 0x800
  s_waitcnt lgkmcnt(4)
  v_mfma_f32_16x16x32_bf16 v[40:43], a[232:235], a[124:127], v[40:43]
  v_add_u32 v231, 0x4000, v243
  ds_read_b64_tr_b16 a[192:193], v231
  buffer_store_dwordx4 v[8:11], v83, s[12:15], s77 offen sc1
  v_mfma_f32_16x16x32_bf16 v[68:71], a[232:235], a[128:131], v[68:71]
  ds_read_b64_tr_b16 a[194:195], v231 offset:2048
  v_mfma_f32_16x16x32_bf16 v[12:15], a[236:239], a[132:135], v[12:15]
  s_cmp_eq_u32 s25, 2
  s_cselect_b32 s29, 0x7ff00000, 0
  v_add_u32 v82, s29, v248
  v_mfma_f32_16x16x32_bf16 v[40:43], a[236:239], a[136:139], v[40:43]
  ds_read_b64_tr_b16 a[196:197], v231 offset:8192
  s_add_u32 s76, s43, 0x2400
  v_mfma_f32_16x16x32_bf16 v[68:71], a[236:239], a[140:143], v[68:71]
  ds_read_b64_tr_b16 a[198:199], v231 offset:10240
  buffer_store_dwordx4 v[36:39], v82, s[12:15], s76 offen sc1
  s_waitcnt lgkmcnt(4)
  v_mfma_f32_16x16x32_bf16 v[12:15], a[184:187], a[144:147], v[12:15]
  s_cmp_eq_u32 s25, 2
  s_cselect_b32 s29, 0x7ff00000, 0
  v_add_u32 v83, s29, v248
  v_mfma_f32_16x16x32_bf16 v[40:43], a[184:187], a[148:151], v[40:43]
  v_add_u32 v224, 0xc000, v244
  ds_read_b64_tr_b16 a[200:201], v224
  v_mfma_f32_16x16x32_bf16 v[68:71], a[184:187], a[152:155], v[68:71]
  ds_read_b64_tr_b16 a[202:203], v224 offset:2048
  s_add_u32 s77, s43, 0x4000
  v_mfma_f32_16x16x32_bf16 v[12:15], a[188:191], a[156:159], v[12:15]
  ds_read_b64_tr_b16 a[204:205], v224 offset:8192
  buffer_store_dwordx4 v[64:67], v83, s[12:15], s77 offen sc1
  v_mfma_f32_16x16x32_bf16 v[40:43], a[188:191], a[160:163], v[40:43]
  ds_read_b64_tr_b16 a[206:207], v224 offset:10240
  s_waitcnt lgkmcnt(4)
  v_mfma_f32_16x16x32_bf16 v[68:71], a[188:191], a[164:167], v[68:71]
  v_add_u32 v225, 0x10000, v244
  ds_read_b64_tr_b16 a[208:209], v225
  v_mfma_f32_16x16x32_bf16 v[12:15], a[192:195], a[168:171], v[12:15]
  ds_read_b64_tr_b16 a[210:211], v225 offset:2048
  v_mfma_f32_16x16x32_bf16 v[40:43], a[192:195], a[172:175], v[40:43]
  ds_read_b64_tr_b16 a[212:213], v225 offset:8192
  v_mfma_f32_16x16x32_bf16 v[68:71], a[192:195], a[176:179], v[68:71]
  ds_read_b64_tr_b16 a[214:215], v225 offset:10240
  v_mfma_f32_16x16x32_bf16 v[12:15], a[196:199], a[240:243], v[12:15]
  v_add_u32 v226, 0xffff0000, v244
  ds_read_b64_tr_b16 a[216:217], v226
  s_waitcnt lgkmcnt(5)
  v_mfma_f32_16x16x32_bf16 v[40:43], a[196:199], a[244:247], v[40:43]
  ds_read_b64_tr_b16 a[218:219], v226 offset:2048
  v_mfma_f32_16x16x32_bf16 v[68:71], a[196:199], a[248:251], v[68:71]
  ds_read_b64_tr_b16 a[220:221], v226 offset:8192
  v_mfma_f32_16x16x32_bf16 v[16:19], a[200:203], a[96:99], v[16:19]
  ds_read_b64_tr_b16 a[222:223], v226 offset:10240
  v_mfma_f32_16x16x32_bf16 v[44:47], a[200:203], a[100:103], v[44:47]
  v_add_u32 v227, 0x4000, v244
  ds_read_b64_tr_b16 a[224:225], v227
  v_mfma_f32_16x16x32_bf16 v[16:19], a[204:207], a[108:111], v[16:19]
  ds_read_b64_tr_b16 a[226:227], v227 offset:2048
  s_waitcnt lgkmcnt(6)
  v_mfma_f32_16x16x32_bf16 v[44:47], a[204:207], a[112:115], v[44:47]
  ds_read_b64_tr_b16 a[228:229], v227 offset:8192
  v_mfma_f32_16x16x32_bf16 v[16:19], a[208:211], a[120:123], v[16:19]
  ds_read_b64_tr_b16 a[230:231], v227 offset:10240
  s_cmp_eq_u32 s25, 0
  s_cselect_b32 s29, 0x7ff00000, 0
  v_mfma_f32_16x16x32_bf16 v[44:47], a[208:211], a[124:127], v[44:47]
  v_add_u32 v228, 0xc000, v245
  ds_read_b64_tr_b16 a[232:233], v228
  v_mfma_f32_16x16x32_bf16 v[16:19], a[212:215], a[132:135], v[16:19]
  ds_read_b64_tr_b16 a[234:235], v228 offset:2048
  v_add_u32 v82, s29, v248
  v_mfma_f32_16x16x32_bf16 v[44:47], a[212:215], a[136:139], v[44:47]
  ds_read_b64_tr_b16 a[236:237], v228 offset:8192
  s_add_u32 s76, s43, 0xc00
  buffer_store_dwordx4 v[12:15], v82, s[12:15], s76 offen sc1
  s_waitcnt lgkmcnt(5)
  v_mfma_f32_16x16x32_bf16 v[16:19], a[216:219], a[144:147], v[16:19]
  ds_read_b64_tr_b16 a[238:239], v228 offset:10240
  s_cmp_eq_u32 s25, 2
  s_cselect_b32 s29, 0x7ff00000, 0
  v_mfma_f32_16x16x32_bf16 v[44:47], a[216:219], a[148:151], v[44:47]
  v_add_u32 v229, 0x10000, v245
  ds_read_b64_tr_b16 a[184:185], v229
  v_mfma_f32_16x16x32_bf16 v[16:19], a[220:223], a[156:159], v[16:19]
  ds_read_b64_tr_b16 a[186:187], v229 offset:2048
  v_add_u32 v83, s29, v248
  v_mfma_f32_16x16x32_bf16 v[44:47], a[220:223], a[160:163], v[44:47]
  ds_read_b64_tr_b16 a[188:189], v229 offset:8192
  s_add_u32 s77, s43, 0x2800
  buffer_store_dwordx4 v[40:43], v83, s[12:15], s77 offen sc1
  v_mfma_f32_16x16x32_bf16 v[16:19], a[224:227], a[168:171], v[16:19]
  ds_read_b64_tr_b16 a[190:191], v229 offset:10240
  s_cmp_eq_u32 s25, 3
  s_cselect_b32 s29, 0x7ff00000, 0
  s_waitcnt lgkmcnt(6)
  v_mfma_f32_16x16x32_bf16 v[44:47], a[224:227], a[172:175], v[44:47]
  v_add_u32 v230, 0xffff0000, v245
  ds_read_b64_tr_b16 a[192:193], v230
  v_mfma_f32_16x16x32_bf16 v[16:19], a[228:231], a[240:243], v[16:19]
  ds_read_b64_tr_b16 a[194:195], v230 offset:2048
  v_add_u32 v82, s29, v248
  v_mfma_f32_16x16x32_bf16 v[44:47], a[228:231], a[244:247], v[44:47]
  ds_read_b64_tr_b16 a[196:197], v230 offset:8192
  s_add_u32 s76, s43, 0x4400
  buffer_store_dwordx4 v[68:71], v82, s[12:15], s76 offen sc1
  v_mfma_f32_16x16x32_bf16 v[20:23], a[232:235], a[96:99], v[20:23]
  ds_read_b64_tr_b16 a[198:199], v230 offset:10240
  v_mfma_f32_16x16x32_bf16 v[48:51], a[232:235], a[100:103], v[48:51]
  v_add_u32 v231, 0x4000, v245
  ds_read_b64_tr_b16 a[200:201], v231
  s_waitcnt lgkmcnt(5)
  v_mfma_f32_16x16x32_bf16 v[20:23], a[236:239], a[108:111], v[20:23]
  ds_read_b64_tr_b16 a[202:203], v231 offset:2048
  v_mfma_f32_16x16x32_bf16 v[48:51], a[236:239], a[112:115], v[48:51]
  ds_read_b64_tr_b16 a[204:205], v231 offset:8192
  v_mfma_f32_16x16x32_bf16 v[20:23], a[184:187], a[120:123], v[20:23]
  ds_read_b64_tr_b16 a[206:207], v231 offset:10240
  s_cmp_eq_u32 s25, 1
  s_cselect_b32 s29, 0x7ff00000, 0
  v_mfma_f32_16x16x32_bf16 v[48:51], a[184:187], a[124:127], v[48:51]
  v_add_u32 v224, 0xc000, v246
  ds_read_b64_tr_b16 a[208:209], v224
  v_mfma_f32_16x16x32_bf16 v[20:23], a[188:191], a[132:135], v[20:23]
  ds_read_b64_tr_b16 a[210:211], v224 offset:2048
  s_waitcnt lgkmcnt(6)
  v_mfma_f32_16x16x32_bf16 v[48:51], a[188:191], a[136:139], v[48:51]
  ds_read_b64_tr_b16 a[212:213], v224 offset:8192
  v_add_u32 v83, s29, v248
  v_mfma_f32_16x16x32_bf16 v[20:23], a[192:195], a[144:147], v[20:23]
  ds_read_b64_tr_b16 a[214:215], v224 offset:10240
  s_add_u32 s77, s43, 0x1000
  v_mfma_f32_16x16x32_bf16 v[48:51], a[192:195], a[148:151], v[48:51]
  v_add_u32 v225, 0x10000, v246
  ds_read_b64_tr_b16 a[216:217], v225
  buffer_store_dwordx4 v[16:19], v83, s[12:15], s77 offen sc1
  v_mfma_f32_16x16x32_bf16 v[20:23], a[196:199], a[156:159], v[20:23]
  ds_read_b64_tr_b16 a[218:219], v225 offset:2048
  v_mfma_f32_16x16x32_bf16 v[48:51], a[196:199], a[160:163], v[48:51]
  ds_read_b64_tr_b16 a[220:221], v225 offset:8192
  s_cmp_eq_u32 s25, 3
  s_cselect_b32 s29, 0x7ff00000, 0
  s_waitcnt lgkmcnt(5)
  v_mfma_f32_16x16x32_bf16 v[20:23], a[200:203], a[168:171], v[20:23]
  ds_read_b64_tr_b16 a[222:223], v225 offset:10240
  v_add_u32 v82, s29, v248
  v_mfma_f32_16x16x32_bf16 v[48:51], a[200:203], a[172:175], v[48:51]
  v_add_u32 v226, 0xffff0000, v246
  ds_read_b64_tr_b16 a[224:225], v226
  v_mfma_f32_16x16x32_bf16 v[20:23], a[204:207], a[240:243], v[20:23]
  ds_read_b64_tr_b16 a[226:227], v226 offset:2048
  s_add_u32 s76, s43, 0x2c00
  v_mfma_f32_16x16x32_bf16 v[48:51], a[204:207], a[244:247], v[48:51]
  ds_read_b64_tr_b16 a[228:229], v226 offset:8192
  buffer_store_dwordx4 v[44:47], v82, s[12:15], s76 offen sc1
  v_mfma_f32_16x16x32_bf16 v[24:27], a[208:211], a[96:99], v[24:27]
  ds_read_b64_tr_b16 a[230:231], v226 offset:10240
  s_waitcnt lgkmcnt(6)
  v_mfma_f32_16x16x32_bf16 v[52:55], a[208:211], a[100:103], v[52:55]
  v_add_u32 v227, 0x4000, v246
  ds_read_b64_tr_b16 a[232:233], v227
  v_mfma_f32_16x16x32_bf16 v[24:27], a[212:215], a[108:111], v[24:27]
  ds_read_b64_tr_b16 a[234:235], v227 offset:2048
  v_mfma_f32_16x16x32_bf16 v[52:55], a[212:215], a[112:115], v[52:55]
  ds_read_b64_tr_b16 a[236:237], v227 offset:8192
  v_mfma_f32_16x16x32_bf16 v[24:27], a[216:219], a[120:123], v[24:27]
  ds_read_b64_tr_b16 a[238:239], v227 offset:10240
  v_mfma_f32_16x16x32_bf16 v[52:55], a[216:219], a[124:127], v[52:55]
  s_cmp_eq_u32 s25, 1
  s_cselect_b32 s29, 0x7ff00000, 0
  s_waitcnt lgkmcnt(4)
  v_mfma_f32_16x16x32_bf16 v[24:27], a[220:223], a[132:135], v[24:27]
  v_mfma_f32_16x16x32_bf16 v[52:55], a[220:223], a[136:139], v[52:55]
  v_add_u32 v83, s29, v248
  v_mfma_f32_16x16x32_bf16 v[24:27], a[224:227], a[144:147], v[24:27]
  s_add_u32 s77, s43, 0x1400
  v_mfma_f32_16x16x32_bf16 v[52:55], a[224:227], a[148:151], v[52:55]
  buffer_store_dwordx4 v[20:23], v83, s[12:15], s77 offen sc1
  v_mfma_f32_16x16x32_bf16 v[24:27], a[228:231], a[156:159], v[24:27]
  s_waitcnt lgkmcnt(0)
  v_mfma_f32_16x16x32_bf16 v[52:55], a[228:231], a[160:163], v[52:55]
  s_cmp_eq_u32 s25, 3
  s_cselect_b32 s29, 0x7ff00000, 0
  v_mfma_f32_16x16x32_bf16 v[24:27], a[232:235], a[168:171], v[24:27]
  v_mfma_f32_16x16x32_bf16 v[52:55], a[232:235], a[172:175], v[52:55]
  v_add_u32 v82, s29, v248
  v_mfma_f32_16x16x32_bf16 v[24:27], a[236:239], a[240:243], v[24:27]
  s_add_u32 s76, s43, 0x3000
  v_mfma_f32_16x16x32_bf16 v[52:55], a[236:239], a[244:247], v[52:55]
  buffer_store_dwordx4 v[48:51], v82, s[12:15], s76 offen sc1
  s_nop 7
  s_cmp_eq_u32 s25, 1
  s_cselect_b32 s29, 0x7ff00000, 0
  v_add_u32 v83, s29, v248
  s_add_u32 s77, s43, 0x1800
  buffer_store_dwordx4 v[24:27], v83, s[12:15], s77 offen sc1
  s_cmp_eq_u32 s25, 3
  s_cselect_b32 s29, 0x7ff00000, 0
  v_add_u32 v82, s29, v248
  s_add_u32 s76, s43, 0x3400
  buffer_store_dwordx4 v[52:55], v82, s[12:15], s76 offen sc1
  v_and_b32 v80, 15, v255
  v_mul_u32_u24 v80, 0x700, v80
  v_lshrrev_b32 v81, 4, v255
  v_lshl_add_u32 v80, v81, 3, v80
  s_mul_i32 s46, s26, 0x46000
  s_mul_i32 s29, s24, 0x380
  s_add_u32 s46, s46, s29
  s_mul_i32 s29, s27, 0xe0
  s_add_u32 s46, s46, s29
  s_mul_i32 s29, s3, 0xe000
  s_add_u32 s48, s46, s29
  s_add_u32 s49, s48, 0x7000
  s_lshr_b32 s29, s3, 1
  s_add_u32 s29, s29, 8
  s_mul_i32 s29, s29, 0x7000
  s_add_u32 s50, s46, s29
  s_mul_i32 s32, s25, 0x12000
  s_sub_u32 s47, s43, s32
  s_waitcnt vmcnt(0)
  s_barrier
  s_cmp_eq_u32 s3, 0
  s_cbranch_scc0 concat_heads__mha_block_cached__mha_block_cached__near_ridge_kernel_sig17
  buffer_atomic_add v254, v253, s[56:59], 0 offen
concat_heads__mha_block_cached__mha_block_cached__near_ridge_kernel_sig17:
  buffer_load_dword v251, v253, s[56:59], 0 offen sc1
  s_waitcnt vmcnt(0)
  v_readfirstlane_b32 s44, v251
  s_nop 1
  s_lshr_b32 s44, s44, 4
  s_and_b32 s44, s44, 0xf0f0f0f
  s_add_u32 s44, s44, 0x7f7f7f7f
  s_and_b32 s44, s44, 0x80808080
  s_cmp_eq_u32 s44, 0x80808080
  s_cbranch_scc0 concat_heads__mha_block_cached__mha_block_cached__near_ridge_kernel_spin18
concat_heads__mha_block_cached__mha_block_cached__near_ridge_kernel_go18:
  s_cmp_eq_u32 s25, 1
  s_cbranch_scc1 concat_heads__mha_block_cached__mha_block_cached__near_ridge_kernel_fin1
  s_cmp_eq_u32 s25, 2
  s_cbranch_scc1 concat_heads__mha_block_cached__mha_block_cached__near_ridge_kernel_fin2
  s_cmp_eq_u32 s25, 3
  s_cbranch_scc1 concat_heads__mha_block_cached__mha_block_cached__near_ridge_kernel_fin3
concat_heads__mha_block_cached__mha_block_cached__near_ridge_kernel_fin0:
  s_add_u32 s77, s47, 0x12000
  buffer_load_dwordx4 v[96:99], v248, s[12:15], s77 offen sc1
  s_add_u32 s76, s47, 0x24000
  buffer_load_dwordx4 v[100:103], v248, s[12:15], s76 offen sc1
  s_add_u32 s77, s47, 0x36000
  buffer_load_dwordx4 v[104:107], v248, s[12:15], s77 offen sc1
  s_add_u32 s76, s47, 0x12400
  buffer_load_dwordx4 v[108:111], v248, s[12:15], s76 offen sc1
  s_add_u32 s77, s47, 0x24400
  buffer_load_dwordx4 v[112:115], v248, s[12:15], s77 offen sc1
  s_add_u32 s76, s47, 0x36400
  buffer_load_dwordx4 v[116:119], v248, s[12:15], s76 offen sc1
  s_add_u32 s77, s47, 0x12800
  buffer_load_dwordx4 v[120:123], v248, s[12:15], s77 offen sc1
  s_add_u32 s76, s47, 0x24800
  buffer_load_dwordx4 v[124:127], v248, s[12:15], s76 offen sc1
  s_add_u32 s77, s47, 0x36800
  buffer_load_dwordx4 v[128:131], v248, s[12:15], s77 offen sc1
  s_add_u32 s76, s47, 0x12c00
  buffer_load_dwordx4 v[132:135], v248, s[12:15], s76 offen sc1
  s_add_u32 s77, s47, 0x24c00
  buffer_load_dwordx4 v[136:139], v248, s[12:15], s77 offen sc1
  s_add_u32 s76, s47, 0x36c00
  buffer_load_dwordx4 v[140:143], v248, s[12:15], s76 offen sc1
  s_add_u32 s77, s47, 0x15800
  buffer_load_dwordx4 v[144:147], v248, s[12:15], s77 offen sc1
  s_add_u32 s76, s47, 0x27800
  buffer_load_dwordx4 v[148:151], v248, s[12:15], s76 offen sc1
  s_add_u32 s77, s47, 0x39800
  buffer_load_dwordx4 v[152:155], v248, s[12:15], s77 offen sc1
  s_waitcnt vmcnt(14)
  v_add_f32 v0, v0, v96
  s_waitcnt vmcnt(12)
  v_add_f32 v100, v100, v104
  v_add_f32 v1, v1, v97
  v_add_f32 v101, v101, v105
  v_add_f32 v2, v2, v98
  v_add_f32 v102, v102, v106
  v_add_f32 v3, v3, v99
  v_add_f32 v103, v103, v107
  v_add_f32 v0, v0, v100
  v_add_f32 v1, v1, v101
  v_add_f32 v2, v2, v102
  v_add_f32 v3, v3, v103
  v_cvt_pk_bf16_f32 v160, v0, v1
  v_cvt_pk_bf16_f32 v161, v2, v3
  s_lshr_b32 s76, s36, 5
  s_add_u32 s76, s76, s48
  buffer_store_dwordx2 v[160:161], v80, s[4:7], s76 offen sc1
  s_waitcnt vmcnt(12)
  v_add_f32 v4, v4, v108
  s_waitcnt vmcnt(10)
  v_add_f32 v112, v112, v116
  v_add_f32 v5, v5, v109
  v_add_f32 v113, v113, v117
  v_add_f32 v6, v6, v110
  v_add_f32 v114, v114, v118
  v_add_f32 v7, v7, v111
  v_add_f32 v115, v115, v119
  v_add_f32 v4, v4, v112
  v_add_f32 v5, v5, v113
  v_add_f32 v6, v6, v114
  v_add_f32 v7, v7, v115
  v_cvt_pk_bf16_f32 v162, v4, v5
  v_cvt_pk_bf16_f32 v163, v6, v7
  s_lshr_b32 s77, s37, 5
  s_add_u32 s77, s77, s48
  buffer_store_dwordx2 v[162:163], v80, s[4:7], s77 offen sc1
  s_waitcnt vmcnt(10)
  v_add_f32 v8, v8, v120
  s_waitcnt vmcnt(8)
  v_add_f32 v124, v124, v128
  v_add_f32 v9, v9, v121
  v_add_f32 v125, v125, v129
  v_add_f32 v10, v10, v122
  v_add_f32 v126, v126, v130
  v_add_f32 v11, v11, v123
  v_add_f32 v127, v127, v131
  v_add_f32 v8, v8, v124
  v_add_f32 v9, v9, v125
  v_add_f32 v10, v10, v126
  v_add_f32 v11, v11, v127
  v_cvt_pk_bf16_f32 v164, v8, v9
  v_cvt_pk_bf16_f32 v165, v10, v11
  s_lshr_b32 s76, s38, 5
  s_add_u32 s76, s76, s48
  buffer_store_dwordx2 v[164:165], v80, s[4:7], s76 offen sc1
  s_waitcnt vmcnt(8)
  v_add_f32 v12, v12, v132
  s_waitcnt vmcnt(6)
  v_add_f32 v136, v136, v140
  v_add_f32 v13, v13, v133
  v_add_f32 v137, v137, v141
  v_add_f32 v14, v14, v134
  v_add_f32 v138, v138, v142
  v_add_f32 v15, v15, v135
  v_add_f32 v139, v139, v143
  v_add_f32 v12, v12, v136
  v_add_f32 v13, v13, v137
  v_add_f32 v14, v14, v138
  v_add_f32 v15, v15, v139
  v_cvt_pk_bf16_f32 v166, v12, v13
  v_cvt_pk_bf16_f32 v167, v14, v15
  s_lshr_b32 s77, s39, 5
  s_add_u32 s77, s77, s48
  buffer_store_dwordx2 v[166:167], v80, s[4:7], s77 offen sc1
  s_waitcnt vmcnt(6)
  v_add_f32 v56, v56, v144
  s_waitcnt vmcnt(4)
  v_add_f32 v148, v148, v152
  v_add_f32 v57, v57, v145
  v_add_f32 v149, v149, v153
  v_add_f32 v58, v58, v146
  v_add_f32 v150, v150, v154
  v_add_f32 v59, v59, v147
  v_add_f32 v151, v151, v155
  v_add_f32 v56, v56, v148
  v_add_f32 v57, v57, v149
  v_add_f32 v58, v58, v150
  v_add_f32 v59, v59, v151
  v_cvt_pk_bf16_f32 v168, v56, v57
  v_cvt_pk_bf16_f32 v169, v58, v59
  s_lshr_b32 s76, s36, 5
  s_add_u32 s76, s76, s50
  buffer_store_dwordx2 v[168:169], v80, s[4:7], s76 offen sc1
  s_branch concat_heads__mha_block_cached__mha_block_cached__near_ridge_kernel_end
concat_heads__mha_block_cached__mha_block_cached__near_ridge_kernel_fin1:
  s_add_u32 s77, s47, 0x1000
  buffer_load_dwordx4 v[96:99], v248, s[12:15], s77 offen sc1
  s_add_u32 s76, s47, 0x25000
  buffer_load_dwordx4 v[100:103], v248, s[12:15], s76 offen sc1
  s_add_u32 s77, s47, 0x37000
  buffer_load_dwordx4 v[104:107], v248, s[12:15], s77 offen sc1
  s_add_u32 s76, s47, 0x1400
  buffer_load_dwordx4 v[108:111], v248, s[12:15], s76 offen sc1
  s_add_u32 s77, s47, 0x25400
  buffer_load_dwordx4 v[112:115], v248, s[12:15], s77 offen sc1
  s_add_u32 s76, s47, 0x37400
  buffer_load_dwordx4 v[116:119], v248, s[12:15], s76 offen sc1
  s_add_u32 s77, s47, 0x1800
  buffer_load_dwordx4 v[120:123], v248, s[12:15], s77 offen sc1
  s_add_u32 s76, s47, 0x25800
  buffer_load_dwordx4 v[124:127], v248, s[12:15], s76 offen sc1
  s_add_u32 s77, s47, 0x37800
  buffer_load_dwordx4 v[128:131], v248, s[12:15], s77 offen sc1
  s_add_u32 s76, s47, 0x3c00
  buffer_load_dwordx4 v[132:135], v248, s[12:15], s76 offen sc1
  s_add_u32 s77, s47, 0x27c00
  buffer_load_dwordx4 v[136:139], v248, s[12:15], s77 offen sc1
  s_add_u32 s76, s47, 0x39c00
  buffer_load_dwordx4 v[140:143], v248, s[12:15], s76 offen sc1
  s_waitcnt vmcnt(11)
  v_add_f32 v96, v96, v16
  s_waitcnt vmcnt(9)
  v_add_f32 v100, v100, v104
  v_add_f32 v97, v97, v17
  v_add_f32 v101, v101, v105
  v_add_f32 v98, v98, v18
  v_add_f32 v102, v102, v106
  v_add_f32 v99, v99, v19
  v_add_f32 v103, v103, v107
  v_add_f32 v96, v96, v100
  v_add_f32 v97, v97, v101
  v_add_f32 v98, v98, v102
  v_add_f32 v99, v99, v103
  v_cvt_pk_bf16_f32 v160, v96, v97
  v_cvt_pk_bf16_f32 v161, v98, v99
  s_lshr_b32 s77, s40, 5
  s_add_u32 s77, s77, s48
  buffer_store_dwordx2 v[160:161], v80, s[4:7], s77 offen sc1
  s_waitcnt vmcnt(9)
  v_add_f32 v108, v108, v20
  s_waitcnt vmcnt(7)
  v_add_f32 v112, v112, v116
  v_add_f32 v109, v109, v21
  v_add_f32 v113, v113, v117
  v_add_f32 v110, v110, v22
  v_add_f32 v114, v114, v118
  v_add_f32 v111, v111, v23
  v_add_f32 v115, v115, v119
  v_add_f32 v108, v108, v112
  v_add_f32 v109, v109, v113
  v_add_f32 v110, v110, v114
  v_add_f32 v111, v111, v115
  v_cvt_pk_bf16_f32 v162, v108, v109
  v_cvt_pk_bf16_f32 v163, v110, v111
  s_lshr_b32 s76, s41, 5
  s_add_u32 s76, s76, s48
  buffer_store_dwordx2 v[162:163], v80, s[4:7], s76 offen sc1
  s_waitcnt vmcnt(7)
  v_add_f32 v120, v120, v24
  s_waitcnt vmcnt(5)
  v_add_f32 v124, v124, v128
  v_add_f32 v121, v121, v25
  v_add_f32 v125, v125, v129
  v_add_f32 v122, v122, v26
  v_add_f32 v126, v126, v130
  v_add_f32 v123, v123, v27
  v_add_f32 v127, v127, v131
  v_add_f32 v120, v120, v124
  v_add_f32 v121, v121, v125
  v_add_f32 v122, v122, v126
  v_add_f32 v123, v123, v127
  v_cvt_pk_bf16_f32 v164, v120, v121
  v_cvt_pk_bf16_f32 v165, v122, v123
  s_lshr_b32 s77, s42, 5
  s_add_u32 s77, s77, s48
  buffer_store_dwordx2 v[164:165], v80, s[4:7], s77 offen sc1
  s_waitcnt vmcnt(5)
  v_add_f32 v132, v132, v60
  s_waitcnt vmcnt(3)
  v_add_f32 v136, v136, v140
  v_add_f32 v133, v133, v61
  v_add_f32 v137, v137, v141
  v_add_f32 v134, v134, v62
  v_add_f32 v138, v138, v142
  v_add_f32 v135, v135, v63
  v_add_f32 v139, v139, v143
  v_add_f32 v132, v132, v136
  v_add_f32 v133, v133, v137
  v_add_f32 v134, v134, v138
  v_add_f32 v135, v135, v139
  v_cvt_pk_bf16_f32 v166, v132, v133
  v_cvt_pk_bf16_f32 v167, v134, v135
  s_lshr_b32 s76, s37, 5
  s_add_u32 s76, s76, s50
  buffer_store_dwordx2 v[166:167], v80, s[4:7], s76 offen sc1
  s_branch concat_heads__mha_block_cached__mha_block_cached__near_ridge_kernel_end
concat_heads__mha_block_cached__mha_block_cached__near_ridge_kernel_fin2:
  s_add_u32 s77, s47, 0x1c00
  buffer_load_dwordx4 v[96:99], v248, s[12:15], s77 offen sc1
  s_add_u32 s76, s47, 0x13c00
  buffer_load_dwordx4 v[100:103], v248, s[12:15], s76 offen sc1
  s_add_u32 s77, s47, 0x37c00
  buffer_load_dwordx4 v[104:107], v248, s[12:15], s77 offen sc1
  s_add_u32 s76, s47, 0x2000
  buffer_load_dwordx4 v[108:111], v248, s[12:15], s76 offen sc1
  s_add_u32 s77, s47, 0x14000
  buffer_load_dwordx4 v[112:115], v248, s[12:15], s77 offen sc1
  s_add_u32 s76, s47, 0x38000
  buffer_load_dwordx4 v[116:119], v248, s[12:15], s76 offen sc1
  s_add_u32 s77, s47, 0x2400
  buffer_load_dwordx4 v[120:123], v248, s[12:15], s77 offen sc1
  s_add_u32 s76, s47, 0x14400
  buffer_load_dwordx4 v[124:127], v248, s[12:15], s76 offen sc1
  s_add_u32 s77, s47, 0x38400
  buffer_load_dwordx4 v[128:131], v248, s[12:15], s77 offen sc1
  s_add_u32 s76, s47, 0x2800
  buffer_load_dwordx4 v[132:135], v248, s[12:15], s76 offen sc1
  s_add_u32 s77, s47, 0x14800
  buffer_load_dwordx4 v[136:139], v248, s[12:15], s77 offen sc1
  s_add_u32 s76, s47, 0x38800
  buffer_load_dwordx4 v[140:143], v248, s[12:15], s76 offen sc1
  s_add_u32 s77, s47, 0x4000
  buffer_load_dwordx4 v[144:147], v248, s[12:15], s77 offen sc1
  s_add_u32 s76, s47, 0x16000
  buffer_load_dwordx4 v[148:151], v248, s[12:15], s76 offen sc1
  s_add_u32 s77, s47, 0x3a000
  buffer_load_dwordx4 v[152:155], v248, s[12:15], s77 offen sc1
  s_waitcnt vmcnt(13)
  v_add_f32 v96, v96, v100
  s_waitcnt vmcnt(12)
  v_add_f32 v28, v28, v104
  v_add_f32 v97, v97, v101
  v_add_f32 v29, v29, v105
  v_add_f32 v98, v98, v102
  v_add_f32 v30, v30, v106
  v_add_f32 v99, v99, v103
  v_add_f32 v31, v31, v107
  v_add_f32 v96, v96, v28
  v_add_f32 v97, v97, v29
  v_add_f32 v98, v98, v30
  v_add_f32 v99, v99, v31
  v_cvt_pk_bf16_f32 v160, v96, v97
  v_cvt_pk_bf16_f32 v161, v98, v99
  s_lshr_b32 s76, s36, 5
  s_add_u32 s76, s76, s49
  buffer_store_dwordx2 v[160:161], v80, s[4:7], s76 offen sc1
  s_waitcnt vmcnt(11)
  v_add_f32 v108, v108, v112
  s_waitcnt vmcnt(10)
  v_add_f32 v32, v32, v116
  v_add_f32 v109, v109, v113
  v_add_f32 v33, v33, v117
  v_add_f32 v110, v110, v114
  v_add_f32 v34, v34, v118
  v_add_f32 v111, v111, v115
  v_add_f32 v35, v35, v119
  v_add_f32 v108, v108, v32
  v_add_f32 v109, v109, v33
  v_add_f32 v110, v110, v34
  v_add_f32 v111, v111, v35
  v_cvt_pk_bf16_f32 v162, v108, v109
  v_cvt_pk_bf16_f32 v163, v110, v111
  s_lshr_b32 s77, s37, 5
  s_add_u32 s77, s77, s49
  buffer_store_dwordx2 v[162:163], v80, s[4:7], s77 offen sc1
  s_waitcnt vmcnt(9)
  v_add_f32 v120, v120, v124
  s_waitcnt vmcnt(8)
  v_add_f32 v36, v36, v128
  v_add_f32 v121, v121, v125
  v_add_f32 v37, v37, v129
  v_add_f32 v122, v122, v126
  v_add_f32 v38, v38, v130
  v_add_f32 v123, v123, v127
  v_add_f32 v39, v39, v131
  v_add_f32 v120, v120, v36
  v_add_f32 v121, v121, v37
  v_add_f32 v122, v122, v38
  v_add_f32 v123, v123, v39
  v_cvt_pk_bf16_f32 v164, v120, v121
  v_cvt_pk_bf16_f32 v165, v122, v123
  s_lshr_b32 s76, s38, 5
  s_add_u32 s76, s76, s49
  buffer_store_dwordx2 v[164:165], v80, s[4:7], s76 offen sc1
  s_waitcnt vmcnt(7)
  v_add_f32 v132, v132, v136
  s_waitcnt vmcnt(6)
  v_add_f32 v40, v40, v140
  v_add_f32 v133, v133, v137
  v_add_f32 v41, v41, v141
  v_add_f32 v134, v134, v138
  v_add_f32 v42, v42, v142
  v_add_f32 v135, v135, v139
  v_add_f32 v43, v43, v143
  v_add_f32 v132, v132, v40
  v_add_f32 v133, v133, v41
  v_add_f32 v134, v134, v42
  v_add_f32 v135, v135, v43
  v_cvt_pk_bf16_f32 v166, v132, v133
  v_cvt_pk_bf16_f32 v167, v134, v135
  s_lshr_b32 s77, s39, 5
  s_add_u32 s77, s77, s49
  buffer_store_dwordx2 v[166:167], v80, s[4:7], s77 offen sc1
  s_waitcnt vmcnt(5)
  v_add_f32 v144, v144, v148
  s_waitcnt vmcnt(4)
  v_add_f32 v64, v64, v152
  v_add_f32 v145, v145, v149
  v_add_f32 v65, v65, v153
  v_add_f32 v146, v146, v150
  v_add_f32 v66, v66, v154
  v_add_f32 v147, v147, v151
  v_add_f32 v67, v67, v155
  v_add_f32 v144, v144, v64
  v_add_f32 v145, v145, v65
  v_add_f32 v146, v146, v66
  v_add_f32 v147, v147, v67
  v_cvt_pk_bf16_f32 v168, v144, v145
  v_cvt_pk_bf16_f32 v169, v146, v147
  s_lshr_b32 s76, s38, 5
  s_add_u32 s76, s76, s50
  buffer_store_dwordx2 v[168:169], v80, s[4:7], s76 offen sc1
  s_branch concat_heads__mha_block_cached__mha_block_cached__near_ridge_kernel_end
concat_heads__mha_block_cached__mha_block_cached__near_ridge_kernel_fin3:
  s_add_u32 s77, s47, 0x2c00
  buffer_load_dwordx4 v[96:99], v248, s[12:15], s77 offen sc1
  s_add_u32 s76, s47, 0x14c00
  buffer_load_dwordx4 v[100:103], v248, s[12:15], s76 offen sc1
  s_add_u32 s77, s47, 0x26c00
  buffer_load_dwordx4 v[104:107], v248, s[12:15], s77 offen sc1
  s_add_u32 s76, s47, 0x3000
  buffer_load_dwordx4 v[108:111], v248, s[12:15], s76 offen sc1
  s_add_u32 s77, s47, 0x15000
  buffer_load_dwordx4 v[112:115], v248, s[12:15], s77 offen sc1
  s_add_u32 s76, s47, 0x27000
  buffer_load_dwordx4 v[116:119], v248, s[12:15], s76 offen sc1
  s_add_u32 s77, s47, 0x3400
  buffer_load_dwordx4 v[120:123], v248, s[12:15], s77 offen sc1
  s_add_u32 s76, s47, 0x15400
  buffer_load_dwordx4 v[124:127], v248, s[12:15], s76 offen sc1
  s_add_u32 s77, s47, 0x27400
  buffer_load_dwordx4 v[128:131], v248, s[12:15], s77 offen sc1
  s_add_u32 s76, s47, 0x4400
  buffer_load_dwordx4 v[132:135], v248, s[12:15], s76 offen sc1
  s_add_u32 s77, s47, 0x16400
  buffer_load_dwordx4 v[136:139], v248, s[12:15], s77 offen sc1
  s_add_u32 s76, s47, 0x28400
  buffer_load_dwordx4 v[140:143], v248, s[12:15], s76 offen sc1
  s_waitcnt vmcnt(10)
  v_add_f32 v96, v96, v100
  s_waitcnt vmcnt(9)
  v_add_f32 v104, v104, v44
  v_add_f32 v97, v97, v101
  v_add_f32 v105, v105, v45
  v_add_f32 v98, v98, v102
  v_add_f32 v106, v106, v46
  v_add_f32 v99, v99, v103
  v_add_f32 v107, v107, v47
  v_add_f32 v96, v96, v104
  v_add_f32 v97, v97, v105
  v_add_f32 v98, v98, v106
  v_add_f32 v99, v99, v107
  v_cvt_pk_bf16_f32 v160, v96, v97
  v_cvt_pk_bf16_f32 v161, v98, v99
  s_lshr_b32 s77, s40, 5
  s_add_u32 s77, s77, s49
  buffer_store_dwordx2 v[160:161], v80, s[4:7], s77 offen sc1
  s_waitcnt vmcnt(8)
  v_add_f32 v108, v108, v112
  s_waitcnt vmcnt(7)
  v_add_f32 v116, v116, v48
  v_add_f32 v109, v109, v113
  v_add_f32 v117, v117, v49
  v_add_f32 v110, v110, v114
  v_add_f32 v118, v118, v50
  v_add_f32 v111, v111, v115
  v_add_f32 v119, v119, v51
  v_add_f32 v108, v108, v116
  v_add_f32 v109, v109, v117
  v_add_f32 v110, v110, v118
  v_add_f32 v111, v111, v119
  v_cvt_pk_bf16_f32 v162, v108, v109
  v_cvt_pk_bf16_f32 v163, v110, v111
  s_lshr_b32 s76, s41, 5
  s_add_u32 s76, s76, s49
  buffer_store_dwordx2 v[162:163], v80, s[4:7], s76 offen sc1
  s_waitcnt vmcnt(6)
  v_add_f32 v120, v120, v124
  s_waitcnt vmcnt(5)
  v_add_f32 v128, v128, v52
  v_add_f32 v121, v121, v125
  v_add_f32 v129, v129, v53
  v_add_f32 v122, v122, v126
  v_add_f32 v130, v130, v54
  v_add_f32 v123, v123, v127
  v_add_f32 v131, v131, v55
  v_add_f32 v120, v120, v128
  v_add_f32 v121, v121, v129
  v_add_f32 v122, v122, v130
  v_add_f32 v123, v123, v131
  v_cvt_pk_bf16_f32 v164, v120, v121
  v_cvt_pk_bf16_f32 v165, v122, v123
  s_lshr_b32 s77, s42, 5
  s_add_u32 s77, s77, s49
  buffer_store_dwordx2 v[164:165], v80, s[4:7], s77 offen sc1
  s_waitcnt vmcnt(4)
  v_add_f32 v132, v132, v136
  s_waitcnt vmcnt(3)
  v_add_f32 v140, v140, v68
  v_add_f32 v133, v133, v137
  v_add_f32 v141, v141, v69
  v_add_f32 v134, v134, v138
  v_add_f32 v142, v142, v70
  v_add_f32 v135, v135, v139
  v_add_f32 v143, v143, v71
  v_add_f32 v132, v132, v140
  v_add_f32 v133, v133, v141
  v_add_f32 v134, v134, v142
  v_add_f32 v135, v135, v143
  v_cvt_pk_bf16_f32 v166, v132, v133
  v_cvt_pk_bf16_f32 v167, v134, v135
  s_lshr_b32 s76, s39, 5
  s_add_u32 s76, s76, s50
  s_and_b32 s29, s3, 1
  s_mul_i32 s29, s29, 0x7ff00000
  v_add_u32 v81, s29, v80
  buffer_store_dwordx2 v[166:167], v81, s[4:7], s76 offen sc1
  s_branch concat_heads__mha_block_cached__mha_block_cached__near_ridge_kernel_end
concat_heads__mha_block_cached__mha_block_cached__near_ridge_kernel_end:
  s_waitcnt vmcnt(0)
  s_branch concat_heads__mha_block_cached__mha_block_cached__near_ridge_kernel_done
concat_heads__mha_block_cached__mha_block_cached__near_ridge_kernel_restart:
  v_mov_b32 v253, v248
  s_nop 1
  v_permlane32_swap_b32 v248, v253
  v_max_f32 v248, v248, v253
  v_ceil_f32 v248, v248
  v_sub_f32 v250, v248, v192
  v_mov_b32 v253, v249
  s_nop 1
  v_permlane32_swap_b32 v249, v253
  v_max_f32 v249, v249, v253
  v_ceil_f32 v249, v249
  v_sub_f32 v251, v249, v208
  s_mov_b32 s63, 1
  s_mov_b32 s35, 0
  s_waitcnt vmcnt(0)
  s_waitcnt lgkmcnt(0)
  s_barrier
  s_add_u32 m0, s33, 0x8000
  s_add_u32 s75, s33, 0
  buffer_load_dwordx4 v240, s[4:7], s75 offen nt lds
  buffer_load_dwordx4 v241, s[4:7], s75 offen offset:1024 nt lds
  buffer_load_dwordx4 v242, s[4:7], s75 offen offset:2048 nt lds
  buffer_load_dwordx4 v243, s[4:7], s75 offen offset:3072 nt lds
  s_add_u32 m0, s33, 0xc000
  s_add_u32 s74, s33, 0x4000
  buffer_load_dwordx4 v240, s[4:7], s74 offen nt lds
  buffer_load_dwordx4 v241, s[4:7], s74 offen offset:1024 nt lds
  buffer_load_dwordx4 v242, s[4:7], s74 offen offset:2048 nt lds
  buffer_load_dwordx4 v243, s[4:7], s74 offen offset:3072 nt lds
  s_add_u32 m0, s33, 0x10000
  s_add_u32 s75, s33, 0x8000
  buffer_load_dwordx4 v240, s[4:7], s75 offen nt lds
  buffer_load_dwordx4 v241, s[4:7], s75 offen offset:1024 nt lds
  buffer_load_dwordx4 v242, s[4:7], s75 offen offset:2048 nt lds
  buffer_load_dwordx4 v243, s[4:7], s75 offen offset:3072 nt lds
  s_add_u32 m0, s33, 0x14000
  s_add_u32 s74, s33, 0xc000
  buffer_load_dwordx4 v240, s[4:7], s74 offen nt lds
  buffer_load_dwordx4 v241, s[4:7], s74 offen offset:1024 nt lds
  buffer_load_dwordx4 v242, s[4:7], s74 offen offset:2048 nt lds
  buffer_load_dwordx4 v243, s[4:7], s74 offen offset:3072 nt lds
  s_add_u32 m0, s33, 0x24000
  s_add_u32 s75, s33, 0x10000
  buffer_load_dwordx4 v240, s[4:7], s75 offen nt lds
  buffer_load_dwordx4 v241, s[4:7], s75 offen offset:1024 nt lds
  buffer_load_dwordx4 v242, s[4:7], s75 offen offset:2048 nt lds
  buffer_load_dwordx4 v243, s[4:7], s75 offen offset:3072 nt lds
  s_add_u32 m0, s33, 0
  s_add_u32 s74, s33, 0x14000
  buffer_load_dwordx4 v240, s[4:7], s74 offen nt lds
  buffer_load_dwordx4 v241, s[4:7], s74 offen offset:1024 nt lds
  buffer_load_dwordx4 v242, s[4:7], s74 offen offset:2048 nt lds
  buffer_load_dwordx4 v243, s[4:7], s74 offen offset:3072 nt lds
  s_add_u32 m0, s33, 0x4000
  s_add_u32 s75, s33, 0x18000
  buffer_load_dwordx4 v240, s[4:7], s75 offen nt lds
  buffer_load_dwordx4 v241, s[4:7], s75 offen offset:1024 nt lds
  buffer_load_dwordx4 v242, s[4:7], s75 offen offset:2048 nt lds
  buffer_load_dwordx4 v243, s[4:7], s75 offen offset:3072 nt lds
  v_and_b32 v198, 31, v255
  v_lshrrev_b32 v199, 5, v255
  v_lshrrev_b32 v200, 4, v255
  v_and_b32 v201, 15, v255
  v_lshrrev_b32 v202, 2, v201
  v_and_b32 v203, 3, v255
  v_and_b32 v204, 1, v200
  v_and_b32 v186, 15, v198
  v_lshlrev_b32 v187, 9, v198
  s_xor_b32 s29, s3, 0
  s_lshl_b32 s29, s29, 2
  v_add_u32 v188, 0, v199
  v_add_u32 v188, s29, v188
  v_xor_b32 v188, v188, v186
  v_lshl_add_u32 v232, v188, 4, v187
  v_add_u32 v188, 2, v199
  v_add_u32 v188, s29, v188
  v_xor_b32 v188, v188, v186
  v_lshl_add_u32 v233, v188, 4, v187
  s_xor_b32 s29, s3, 1
  s_lshl_b32 s29, s29, 2
  v_add_u32 v188, 0, v199
  v_add_u32 v188, s29, v188
  v_xor_b32 v188, v188, v186
  v_lshl_add_u32 v234, v188, 4, v187
  v_add_u32 v188, 2, v199
  v_add_u32 v188, s29, v188
  v_xor_b32 v188, v188, v186
  v_lshl_add_u32 v235, v188, 4, v187
  s_xor_b32 s29, s3, 2
  s_lshl_b32 s29, s29, 2
  v_add_u32 v188, 0, v199
  v_add_u32 v188, s29, v188
  v_xor_b32 v188, v188, v186
  v_lshl_add_u32 v236, v188, 4, v187
  v_add_u32 v188, 2, v199
  v_add_u32 v188, s29, v188
  v_xor_b32 v188, v188, v186
  v_lshl_add_u32 v237, v188, 4, v187
  s_xor_b32 s29, s3, 3
  s_lshl_b32 s29, s29, 2
  v_add_u32 v188, 0, v199
  v_add_u32 v188, s29, v188
  v_xor_b32 v188, v188, v186
  v_lshl_add_u32 v238, v188, 4, v187
  v_add_u32 v188, 2, v199
  v_add_u32 v188, s29, v188
  v_xor_b32 v188, v188, v186
  v_lshl_add_u32 v239, v188, 4, v187
  s_waitcnt vmcnt(0)
  s_barrier
  v_add_u32 v232, s36, v232
  v_add_u32 v233, s36, v233
  v_add_u32 v234, s36, v234
  v_add_u32 v235, s36, v235
  v_add_u32 v236, s36, v236
  v_add_u32 v237, s36, v237
  v_add_u32 v238, s36, v238
  v_add_u32 v239, s36, v239
  ds_read_b128 a[128:131], v232
  ds_read_b128 a[132:135], v233
  ds_read_b128 a[136:139], v234
  ds_read_b128 a[140:143], v235
  ds_read_b128 a[144:147], v236
  ds_read_b128 a[148:151], v237
  ds_read_b128 a[152:155], v238
  ds_read_b128 a[156:159], v239
  ds_read_b128 a[160:163], v232 offset:256
  ds_read_b128 a[164:167], v233 offset:256
  ds_read_b128 a[168:171], v234 offset:256
  ds_read_b128 a[172:175], v235 offset:256
  ds_read_b128 a[176:179], v236 offset:256
  ds_read_b128 a[180:183], v237 offset:256
  ds_read_b128 a[184:187], v238 offset:256
  ds_read_b128 a[188:191], v239 offset:256
  v_mov_b32 v244, 0
  v_mov_b32 v245, 0
  v_mov_b32 v248, 0
  v_mov_b32 v249, 0
  s_waitcnt lgkmcnt(0)
  v_mfma_f32_32x32x16_bf16 v[160:175], a[128:131], a[0:3], 0
  v_mfma_f32_32x32x16_bf16 v[160:175], a[132:135], a[4:7], v[160:175]
  v_mfma_f32_32x32x16_bf16 v[160:175], a[136:139], a[8:11], v[160:175]
  v_mfma_f32_32x32x16_bf16 v[160:175], a[140:143], a[12:15], v[160:175]
  v_mfma_f32_32x32x16_bf16 v[160:175], a[144:147], a[16:19], v[160:175]
  v_mfma_f32_32x32x16_bf16 v[160:175], a[148:151], a[20:23], v[160:175]
  v_mfma_f32_32x32x16_bf16 v[160:175], a[152:155], a[24:27], v[160:175]
  v_mfma_f32_32x32x16_bf16 v[160:175], a[156:159], a[28:31], v[160:175]
  v_mfma_f32_32x32x16_bf16 v[160:175], a[160:163], a[32:35], v[160:175]
  v_mfma_f32_32x32x16_bf16 v[160:175], a[164:167], a[36:39], v[160:175]
  v_mfma_f32_32x32x16_bf16 v[160:175], a[168:171], a[40:43], v[160:175]
  v_mfma_f32_32x32x16_bf16 v[160:175], a[172:175], a[44:47], v[160:175]
  v_mfma_f32_32x32x16_bf16 v[160:175], a[176:179], a[48:51], v[160:175]
  v_mfma_f32_32x32x16_bf16 v[160:175], a[180:183], a[52:55], v[160:175]
  v_mfma_f32_32x32x16_bf16 v[160:175], a[184:187], a[56:59], v[160:175]
  v_mfma_f32_32x32x16_bf16 v[160:175], a[188:191], a[60:63], v[160:175]
  s_nop 7
  s_nop 7
  s_branch concat_heads__mha_block_cached__mha_block_cached__near_ridge_kernel_ph1
concat_heads__mha_block_cached__mha_block_cached__near_ridge_kernel_rare0:
  s_nop 3
  v_max3_f32 v248, v248, v160, v161
  v_max3_f32 v248, v248, v162, v163
  v_max3_f32 v248, v248, v164, v165
  v_max3_f32 v248, v248, v166, v167
  v_max3_f32 v248, v248, v168, v169
  v_max3_f32 v248, v248, v170, v171
  v_max3_f32 v248, v248, v172, v173
  v_max3_f32 v248, v248, v174, v175
  s_mov_b32 s35, 1
  s_branch concat_heads__mha_block_cached__mha_block_cached__near_ridge_kernel_back0
concat_heads__mha_block_cached__mha_block_cached__near_ridge_kernel_rare1:
  s_nop 3
  v_max3_f32 v249, v249, v176, v177
  v_max3_f32 v249, v249, v178, v179
  v_max3_f32 v249, v249, v180, v181
  v_max3_f32 v249, v249, v182, v183
  v_max3_f32 v249, v249, v184, v185
  v_max3_f32 v249, v249, v186, v187
  v_max3_f32 v249, v249, v188, v189
  v_max3_f32 v249, v249, v190, v191
  s_mov_b32 s35, 1
  s_branch concat_heads__mha_block_cached__mha_block_cached__near_ridge_kernel_back1
concat_heads__mha_block_cached__mha_block_cached__near_ridge_kernel_rare2:
  s_nop 3
  v_max3_f32 v248, v248, v160, v161
  v_max3_f32 v248, v248, v162, v163
  v_max3_f32 v248, v248, v164, v165
  v_max3_f32 v248, v248, v166, v167
  v_max3_f32 v248, v248, v168, v169
  v_max3_f32 v248, v248, v170, v171
  v_max3_f32 v248, v248, v172, v173
  v_max3_f32 v248, v248, v174, v175
  s_mov_b32 s35, 1
  s_branch concat_heads__mha_block_cached__mha_block_cached__near_ridge_kernel_back2
concat_heads__mha_block_cached__mha_block_cached__near_ridge_kernel_rare3:
  s_nop 3
  v_max3_f32 v248, v248, v176, v177
  v_max3_f32 v248, v248, v178, v179
  v_max3_f32 v248, v248, v180, v181
  v_max3_f32 v248, v248, v182, v183
  v_max3_f32 v248, v248, v184, v185
  v_max3_f32 v248, v248, v186, v187
  v_max3_f32 v248, v248, v188, v189
  v_max3_f32 v248, v248, v190, v191
  s_mov_b32 s35, 1
  s_branch concat_heads__mha_block_cached__mha_block_cached__near_ridge_kernel_back3
concat_heads__mha_block_cached__mha_block_cached__near_ridge_kernel_rare4:
  s_nop 3
  v_max3_f32 v248, v248, v160, v161
  v_max3_f32 v248, v248, v162, v163
  v_max3_f32 v248, v248, v164, v165
  v_max3_f32 v248, v248, v166, v167
  v_max3_f32 v248, v248, v168, v169
  v_max3_f32 v248, v248, v170, v171
  v_max3_f32 v248, v248, v172, v173
  v_max3_f32 v248, v248, v174, v175
  s_mov_b32 s35, 1
  s_branch concat_heads__mha_block_cached__mha_block_cached__near_ridge_kernel_back4
concat_heads__mha_block_cached__mha_block_cached__near_ridge_kernel_rare5:
  s_nop 3
  v_max3_f32 v248, v248, v176, v177
  v_max3_f32 v248, v248, v178, v179
  v_max3_f32 v248, v248, v180, v181
  v_max3_f32 v248, v248, v182, v183
  v_max3_f32 v248, v248, v184, v185
  v_max3_f32 v248, v248, v186, v187
  v_max3_f32 v248, v248, v188, v189
  v_max3_f32 v248, v248, v190, v191
  s_mov_b32 s35, 1
  s_branch concat_heads__mha_block_cached__mha_block_cached__near_ridge_kernel_back5
concat_heads__mha_block_cached__mha_block_cached__near_ridge_kernel_rare6:
  s_nop 3
  v_max3_f32 v249, v249, v160, v161
  v_max3_f32 v249, v249, v162, v163
  v_max3_f32 v249, v249, v164, v165
  v_max3_f32 v249, v249, v166, v167
  v_max3_f32 v249, v249, v168, v169
  v_max3_f32 v249, v249, v170, v171
  v_max3_f32 v249, v249, v172, v173
  v_max3_f32 v249, v249, v174, v175
  s_mov_b32 s35, 1
  s_branch concat_heads__mha_block_cached__mha_block_cached__near_ridge_kernel_back6
concat_heads__mha_block_cached__mha_block_cached__near_ridge_kernel_rare7:
  s_nop 3
  v_max3_f32 v248, v248, v176, v177
  v_max3_f32 v248, v248, v178, v179
  v_max3_f32 v248, v248, v180, v181
  v_max3_f32 v248, v248, v182, v183
  v_max3_f32 v248, v248, v184, v185
  v_max3_f32 v248, v248, v186, v187
  v_max3_f32 v248, v248, v188, v189
  v_max3_f32 v248, v248, v190, v191
  s_mov_b32 s35, 1
  s_branch concat_heads__mha_block_cached__mha_block_cached__near_ridge_kernel_back7
concat_heads__mha_block_cached__mha_block_cached__near_ridge_kernel_rare8:
  s_nop 3
  v_max3_f32 v248, v248, v160, v161
  v_max3_f32 v248, v248, v162, v163
  v_max3_f32 v248, v248, v164, v165
  v_max3_f32 v248, v248, v166, v167
  v_max3_f32 v248, v248, v168, v169
  v_max3_f32 v248, v248, v170, v171
  v_max3_f32 v248, v248, v172, v173
  v_max3_f32 v248, v248, v174, v175
  s_mov_b32 s35, 1
  s_branch concat_heads__mha_block_cached__mha_block_cached__near_ridge_kernel_back8
concat_heads__mha_block_cached__mha_block_cached__near_ridge_kernel_rare9:
  s_nop 3
  v_max3_f32 v248, v248, v176, v177
  v_max3_f32 v248, v248, v178, v179
  v_max3_f32 v248, v248, v180, v181
  v_max3_f32 v248, v248, v182, v183
  v_max3_f32 v248, v248, v184, v185
  v_max3_f32 v248, v248, v186, v187
  v_max3_f32 v248, v248, v188, v189
  v_max3_f32 v248, v248, v190, v191
  s_mov_b32 s35, 1
  s_branch concat_heads__mha_block_cached__mha_block_cached__near_ridge_kernel_back9
concat_heads__mha_block_cached__mha_block_cached__near_ridge_kernel_rare10:
  s_nop 3
  v_max3_f32 v248, v248, v160, v161
  v_max3_f32 v248, v248, v162, v163
  v_max3_f32 v248, v248, v164, v165
  v_max3_f32 v248, v248, v166, v167
  v_max3_f32 v248, v248, v168, v169
  v_max3_f32 v248, v248, v170, v171
  v_max3_f32 v248, v248, v172, v173
  v_max3_f32 v248, v248, v174, v175
  s_mov_b32 s35, 1
  s_branch concat_heads__mha_block_cached__mha_block_cached__near_ridge_kernel_back10
concat_heads__mha_block_cached__mha_block_cached__near_ridge_kernel_rare11:
  s_nop 3
  v_max3_f32 v249, v249, v176, v177
  v_max3_f32 v249, v249, v178, v179
  v_max3_f32 v249, v249, v180, v181
  v_max3_f32 v249, v249, v182, v183
  v_max3_f32 v249, v249, v184, v185
  v_max3_f32 v249, v249, v186, v187
  v_max3_f32 v249, v249, v188, v189
  v_max3_f32 v249, v249, v190, v191
  s_mov_b32 s35, 1
  s_branch concat_heads__mha_block_cached__mha_block_cached__near_ridge_kernel_back11
concat_heads__mha_block_cached__mha_block_cached__near_ridge_kernel_rare12:
  s_nop 3
  v_max3_f32 v248, v248, v160, v161
  v_max3_f32 v248, v248, v162, v163
  v_max3_f32 v248, v248, v164, v165
  v_max3_f32 v248, v248, v166, v167
  v_max3_f32 v248, v248, v168, v169
  v_max3_f32 v248, v248, v170, v171
  v_max3_f32 v248, v248, v172, v173
  v_max3_f32 v248, v248, v174, v175
  s_mov_b32 s35, 1
  s_branch concat_heads__mha_block_cached__mha_block_cached__near_ridge_kernel_back12
concat_heads__mha_block_cached__mha_block_cached__near_ridge_kernel_rare13:
  s_nop 3
  v_max3_f32 v248, v248, v176, v177
  v_max3_f32 v248, v248, v178, v179
  v_max3_f32 v248, v248, v180, v181
  v_max3_f32 v248, v248, v182, v183
  v_max3_f32 v248, v248, v184, v185
  v_max3_f32 v248, v248, v186, v187
  v_max3_f32 v248, v248, v188, v189
  v_max3_f32 v248, v248, v190, v191
  s_mov_b32 s35, 1
  s_branch concat_heads__mha_block_cached__mha_block_cached__near_ridge_kernel_back13
concat_heads__mha_block_cached__mha_block_cached__near_ridge_kernel_rare14:
  s_nop 3
  v_max3_f32 v248, v248, v160, v161
  v_max3_f32 v248, v248, v162, v163
  v_max3_f32 v248, v248, v164, v165
  v_max3_f32 v248, v248, v166, v167
  v_max3_f32 v248, v248, v168, v169
  v_max3_f32 v248, v248, v170, v171
  v_max3_f32 v248, v248, v172, v173
  v_max3_f32 v248, v248, v174, v175
  s_mov_b32 s35, 1
  s_branch concat_heads__mha_block_cached__mha_block_cached__near_ridge_kernel_back14
concat_heads__mha_block_cached__mha_block_cached__near_ridge_kernel_rare15:
  s_nop 3
  v_max3_f32 v248, v248, v176, v177
  v_max3_f32 v248, v248, v178, v179
  v_max3_f32 v248, v248, v180, v181
  v_max3_f32 v248, v248, v182, v183
  v_max3_f32 v248, v248, v184, v185
  v_max3_f32 v248, v248, v186, v187
  v_max3_f32 v248, v248, v188, v189
  v_max3_f32 v248, v248, v190, v191
  s_mov_b32 s35, 1
  s_branch concat_heads__mha_block_cached__mha_block_cached__near_ridge_kernel_back15
concat_heads__mha_block_cached__mha_block_cached__near_ridge_kernel_rare16:
  s_nop 3
  v_max3_f32 v249, v249, v160, v161
  v_max3_f32 v249, v249, v162, v163
  v_max3_f32 v249, v249, v164, v165
  v_max3_f32 v249, v249, v166, v167
  v_max3_f32 v249, v249, v168, v169
  v_max3_f32 v249, v249, v170, v171
  v_max3_f32 v249, v249, v172, v173
  v_max3_f32 v249, v249, v174, v175
  s_mov_b32 s35, 1
  s_branch concat_heads__mha_block_cached__mha_block_cached__near_ridge_kernel_back16
concat_heads__mha_block_cached__mha_block_cached__near_ridge_kernel_rare17:
  s_nop 3
  v_max3_f32 v248, v248, v176, v177
  v_max3_f32 v248, v248, v178, v179
  v_max3_f32 v248, v248, v180, v181
  v_max3_f32 v248, v248, v182, v183
  v_max3_f32 v248, v248, v184, v185
  v_max3_f32 v248, v248, v186, v187
  v_max3_f32 v248, v248, v188, v189
  v_max3_f32 v248, v248, v190, v191
  s_mov_b32 s35, 1
  s_branch concat_heads__mha_block_cached__mha_block_cached__near_ridge_kernel_back17
concat_heads__mha_block_cached__mha_block_cached__near_ridge_kernel_rare18:
  s_nop 3
  v_max3_f32 v248, v248, v160, v161
  v_max3_f32 v248, v248, v162, v163
  v_max3_f32 v248, v248, v164, v165
  v_max3_f32 v248, v248, v166, v167
  v_max3_f32 v248, v248, v168, v169
  v_max3_f32 v248, v248, v170, v171
  v_max3_f32 v248, v248, v172, v173
  v_max3_f32 v248, v248, v174, v175
  s_mov_b32 s35, 1
  s_branch concat_heads__mha_block_cached__mha_block_cached__near_ridge_kernel_back18
concat_heads__mha_block_cached__mha_block_cached__near_ridge_kernel_rare19:
  s_nop 3
  v_max3_f32 v248, v248, v176, v177
  v_max3_f32 v248, v248, v178, v179
  v_max3_f32 v248, v248, v180, v181
  v_max3_f32 v248, v248, v182, v183
  v_max3_f32 v248, v248, v184, v185
  v_max3_f32 v248, v248, v186, v187
  v_max3_f32 v248, v248, v188, v189
  v_max3_f32 v248, v248, v190, v191
  s_mov_b32 s35, 1
  s_branch concat_heads__mha_block_cached__mha_block_cached__near_ridge_kernel_back19
concat_heads__mha_block_cached__mha_block_cached__near_ridge_kernel_spin10:
  s_mov_b32 s30, 0
concat_heads__mha_block_cached__mha_block_cached__near_ridge_kernel_spinl10:
  buffer_load_dword v207, v206, s[96:99], 0 offen sc1
  s_waitcnt vmcnt(0)
  v_readfirstlane_b32 s29, v207
  s_nop 1
  s_cmp_ge_u32 s29, 0x100
  s_cbranch_scc1 concat_heads__mha_block_cached__mha_block_cached__near_ridge_kernel_go10
  s_add_u32 s30, s30, 1
  s_cmp_lt_u32 s30, 0x61a80
  s_cbranch_scc1 concat_heads__mha_block_cached__mha_block_cached__near_ridge_kernel_spinl10
  s_branch concat_heads__mha_block_cached__mha_block_cached__near_ridge_kernel_go10
concat_heads__mha_block_cached__mha_block_cached__near_ridge_kernel_spin13:
  s_mov_b32 s45, 0
concat_heads__mha_block_cached__mha_block_cached__near_ridge_kernel_spinl13:
  buffer_load_dword v251, v249, s[56:59], 0 offen sc1
  s_waitcnt vmcnt(0)
  v_readfirstlane_b32 s44, v251
  s_nop 1
  s_and_b32 s44, s44, 0xf0f0f0f
  s_add_u32 s44, s44, 0x7f7f7f7f
  s_and_b32 s44, s44, 0x80808080
  s_cmp_eq_u32 s44, 0x80808080
  s_cbranch_scc1 concat_heads__mha_block_cached__mha_block_cached__near_ridge_kernel_go13
  s_add_u32 s45, s45, 1
  s_cmp_lt_u32 s45, 0x61a80
  s_cbranch_scc1 concat_heads__mha_block_cached__mha_block_cached__near_ridge_kernel_spinl13
  s_branch concat_heads__mha_block_cached__mha_block_cached__near_ridge_kernel_go13
concat_heads__mha_block_cached__mha_block_cached__near_ridge_kernel_spin15:
  s_mov_b32 s45, 0
concat_heads__mha_block_cached__mha_block_cached__near_ridge_kernel_spinl15:
  buffer_load_dword v251, v249, s[56:59], 0 offen sc1
  s_waitcnt vmcnt(0)
  v_readfirstlane_b32 s44, v251
  s_nop 1
  s_and_b32 s44, s44, 0xf0f0f0f
  s_add_u32 s44, s44, 0x7d7d7d7d
  s_and_b32 s44, s44, 0x80808080
  s_cmp_eq_u32 s44, 0x80808080
  s_cbranch_scc1 concat_heads__mha_block_cached__mha_block_cached__near_ridge_kernel_go15
  s_add_u32 s45, s45, 1
  s_cmp_lt_u32 s45, 0x61a80
  s_cbranch_scc1 concat_heads__mha_block_cached__mha_block_cached__near_ridge_kernel_spinl15
  s_branch concat_heads__mha_block_cached__mha_block_cached__near_ridge_kernel_go15
concat_heads__mha_block_cached__mha_block_cached__near_ridge_kernel_spin16:
  s_mov_b32 s45, 0
concat_heads__mha_block_cached__mha_block_cached__near_ridge_kernel_spinl16:
  buffer_load_dword v251, v249, s[56:59], 0 offen sc1
  s_waitcnt vmcnt(0)
  v_readfirstlane_b32 s44, v251
  s_nop 1
  s_and_b32 s44, s44, 0xf0f0f0f
  s_add_u32 s44, s44, 0x7c7c7c7c
  s_and_b32 s44, s44, 0x80808080
  s_cmp_eq_u32 s44, 0x80808080
  s_cbranch_scc1 concat_heads__mha_block_cached__mha_block_cached__near_ridge_kernel_go16
  s_add_u32 s45, s45, 1
  s_cmp_lt_u32 s45, 0x61a80
  s_cbranch_scc1 concat_heads__mha_block_cached__mha_block_cached__near_ridge_kernel_spinl16
  s_branch concat_heads__mha_block_cached__mha_block_cached__near_ridge_kernel_go16
concat_heads__mha_block_cached__mha_block_cached__near_ridge_kernel_spin18:
  s_mov_b32 s45, 0
concat_heads__mha_block_cached__mha_block_cached__near_ridge_kernel_spinl18:
  buffer_load_dword v251, v253, s[56:59], 0 offen sc1
  s_waitcnt vmcnt(0)
  v_readfirstlane_b32 s44, v251
  s_nop 1
  s_lshr_b32 s44, s44, 4
  s_and_b32 s44, s44, 0xf0f0f0f
  s_add_u32 s44, s44, 0x7f7f7f7f
  s_and_b32 s44, s44, 0x80808080
  s_cmp_eq_u32 s44, 0x80808080
  s_cbranch_scc1 concat_heads__mha_block_cached__mha_block_cached__near_ridge_kernel_go18
  s_add_u32 s45, s45, 1
  s_cmp_lt_u32 s45, 0x61a80
  s_cbranch_scc1 concat_heads__mha_block_cached__mha_block_cached__near_ridge_kernel_spinl18
  s_branch concat_heads__mha_block_cached__mha_block_cached__near_ridge_kernel_go18
concat_heads__mha_block_cached__mha_block_cached__near_ridge_kernel_done:
  s_endpgm

.section .rodata,"a"
.p2align 6
.amdhsa_kernel concat_heads__mha_block_cached__mha_block_cached__near_ridge_kernel
  .amdhsa_next_free_vgpr 512
  .amdhsa_next_free_sgpr 102
  .amdhsa_accum_offset 256
  .amdhsa_group_segment_fixed_size 0
  .amdhsa_kernarg_size 104
  .amdhsa_user_sgpr_count 2
  .amdhsa_user_sgpr_kernarg_segment_ptr 1
  .amdhsa_system_sgpr_workgroup_id_x 1
.end_amdhsa_kernel
```
